```python
import torch

def _softmax(x, axis=-1):
    return torch.softmax(x, dim=axis)
def _gelu(x):
    return torch.nn.functional.gelu(x, approximate="tanh")
def _silu(x):
    return torch.nn.functional.silu(x)
def _sigmoid(x):
    return torch.sigmoid(x)
def _layernorm(x, axis=-1, eps=1e-5):
    m = x.mean(dim=axis, keepdim=True)
    v = x.var(dim=axis, keepdim=True, unbiased=False)
    return (x - m) / torch.sqrt(v + eps)
def _scatter_add(tgt, idx, src, axis=0):
    return tgt.clone().index_add_(axis, idx, src)
def _segment_sum(src, seg, n):
    out = torch.zeros((n,) + src.shape[1:], dtype=src.dtype)
    return out.index_add_(0, seg, src)
def _pad(x, pw):
    flat = tuple(v for pair in reversed(pw) for v in pair)
    return torch.nn.functional.pad(x, flat)

kernel_name = 'interleave_layers__sliding_local_dilated__ssm_conv_h3__prompt'

def setup_inputs():

    _w = (lambda a: (lambda t: t.to(torch.bfloat16) if t.is_floating_point() else t)(torch.as_tensor(a)))
    def _A_setup():
        B, S, D = 1, 2048, 576
        return {
            "x": _w((lambda *s: torch.randn(*s, dtype=torch.bfloat16) * 0.05)(B, S, D)),
            "wqkv": _w((lambda *s: torch.randn(*s, dtype=torch.bfloat16) * 0.05)(D, 3 * D)),
            "wo": _w((lambda *s: torch.randn(*s, dtype=torch.bfloat16) * 0.05)(D, D)),
        }
    _A_in = _A_setup()

    def _B_setup():
        B, S, D = 1, 2048, 576
        ks = 4
        return {
            "q": _w((lambda *s: torch.randn(*s, dtype=torch.bfloat16) * 0.05)(B, S, D)),
            "k": _w((lambda *s: torch.randn(*s, dtype=torch.bfloat16) * 0.4)(B, S, D)),
            "v": _w((lambda *s: torch.randn(*s, dtype=torch.bfloat16) * 0.4)(B, S, D)),
            "shift_k": _w((lambda *s: torch.randn(*s, dtype=torch.bfloat16) * 0.4)(D, ks) * 0.5),
            "ssm_k": _w((lambda *s: torch.randn(*s, dtype=torch.bfloat16) * 0.8)(D, S) * (1.0 / S ** 0.5)),
            "ssm_D": _w((lambda *s: torch.randn(*s, dtype=torch.bfloat16) * 0.4)(D)),
        }
    _B_in = _B_setup()

    return {
        "A_x": _A_in["x"],
        "A_wqkv": _A_in["wqkv"],
        "A_wo": _A_in["wo"],
        "B_q": _B_in["q"],
        "B_k": _B_in["k"],
        "B_v": _B_in["v"],
        "B_shift_k": _B_in["shift_k"],
        "B_ssm_k": _B_in["ssm_k"],
        "B_ssm_D": _B_in["ssm_D"],
    }

def reference(A_x, A_wqkv, A_wo, B_q, B_k, B_v, B_shift_k, B_ssm_k, B_ssm_D):
    def _A_ref(x, wqkv, wo):
        B, S, D = x.shape
        H = 32; Dh = D // H
        W, dil = 8, 2
        qkv = (lambda x, *d: x.permute(*d))((x @ wqkv).reshape(B, S, 3, H, Dh), 2, 0, 3, 1, 4)
        q, k, v = qkv[0], qkv[1], qkv[2]
        scale = Dh ** -0.5
        pos = torch.arange(S)
        off = torch.arange(W) * dil
        idx = pos[:, None] - off[None, :]
        mask = idx >= 0
        idx_c = torch.where(mask, idx, 0).reshape(-1)
        kg = k[:, :, idx_c, :].reshape(B, H, S, W, Dh)
        vg = v[:, :, idx_c, :].reshape(B, H, S, W, Dh)
        logits = torch.einsum("bhsd,bhswd->bhsw", q, kg) * scale
        logits = torch.where(mask[None, None, :, :], logits, -1e9)
        attn = _softmax(logits, axis=-1)
        o = torch.einsum("bhsw,bhswd->bhsd", attn, vg)
        return (lambda x, *d: x.permute(*d))(o, 0, 2, 1, 3).reshape(B, S, D) @ wo

    def _B_ref(q, k, v, shift_k, ssm_k, ssm_D):
        B, S, D = q.shape
        ks = shift_k.shape[-1]
        k_pad = _pad(k, ((0, 0), (ks - 1, 0), (0, 0)))
        k_shift = torch.zeros_like(k)
        for t in range(ks):
            k_shift = k_shift + k_pad[:, t:t + S, :] * shift_k[:, ks - 1 - t][None, None, :]
        kv = k_shift * v
        L = 2 * S
        kv_pad = _pad(kv, ((0, 0), (0, S), (0, 0)))
        kf_pad = _pad(ssm_k, ((0, 0), (0, S)))
        kv_f = (lambda x, axes=(-2,-1): torch.fft.rfft2(x.float(), dim=axes))(kv_pad[:, None, :, :], axes=(1, 2))
        kf_f = (lambda x, axes=(-2,-1): torch.fft.rfft2(x.float(), dim=axes))(kf_pad[:, None, :], axes=(1, 2))
        kf_f = (lambda x, *d: x.permute(*d))(kf_f, 1, 2, 0)
        y_f = kv_f * kf_f[None, :, :, :]
        y = (lambda x, s, axes=(-2,-1): torch.fft.irfft2(x, s=s, dim=axes).to(torch.bfloat16))(y_f, (1, L), axes=(1, 2))[:, 0, :S, :]
        y = y + kv * ssm_D[None, None, :]
        return q * y

    x = A_x
    x = x + _A_ref(_layernorm(x, axis=-1), A_wqkv, A_wo)
    x = x + _B_ref(_layernorm(x, axis=-1), B_k, B_v, B_shift_k, B_ssm_k, B_ssm_D)
    x = x + _A_ref(_layernorm(x, axis=-1), A_wqkv, A_wo)
    x = x + _B_ref(_layernorm(x, axis=-1), B_k, B_v, B_shift_k, B_ssm_k, B_ssm_D)
    return x
```

```asm
; @launch grid=(256,1,1) block=(256,1,1) lds=163840
.amdgcn_target "amdgcn-amd-amdhsa--gfx950"
.text
.globl interleave_layers__sliding_local_dilated__ssm_conv_h3__prompt_kernel
.p2align 8
.type interleave_layers__sliding_local_dilated__ssm_conv_h3__prompt_kernel,@function
interleave_layers__sliding_local_dilated__ssm_conv_h3__prompt_kernel:
    s_cmp_ge_u32 s2, 256
    s_cbranch_scc1 L_end
    s_load_dwordx16 s[16:31], s[0:1], 0
    s_load_dwordx8 s[32:39], s[0:1], 64
    v_and_b32 v1, 63, v0
    v_lshrrev_b32 v2, 6, v0
    s_nop 0
    v_readfirstlane_b32 s3, v2
    s_getpc_b64 s[8:9]
L_pc:
    s_bfe_u32 s10, s2, 0x50003
    s_lshl_b32 s10, s10, 10
    v_lshrrev_b32 v254, 5, v0
    v_lshlrev_b32 v254, 7, v254
    v_add_u32 v254, s10, v254
    v_min_u32 v254, L_tail_n-L_pc, v254
    global_load_dword v254, v254, s[8:9]
    v_and_b32 v2, 31, v0
    v_and_b32 v3, 15, v1
    v_lshrrev_b32 v4, 4, v1
    v_mov_b32 v255, 0
    v_mov_b32 v63, 0x40000000
    s_and_b32 s8, s2, 7
    s_lshr_b32 s9, s2, 3
    s_lshr_b32 s4, s9, 4
    s_lshl_b32 s8, s8, 1
    s_add_u32 s4, s4, s8
    s_and_b32 s5, s9, 15
    s_and_b32 s6, s3, 1
    s_lshr_b32 s7, s3, 1
    s_lshl_b32 s11, s2, 8
    v_add_u32 v83, s11, v0
    v_mul_hi_u32_u24 v78, 4971027, v83
    v_mul_u32_u24 v79, 864, v78
    v_sub_u32 v79, v83, v79
    v_mul_u32_u24 v81, 27648, v78
    v_lshl_add_u32 v81, v79, 2, v81
    s_cmp_lt_u32 s2, 243
    s_cselect_b64 s[90:91], -1, 0
    v_cndmask_b32 v81, v63, v81, s[90:91]
    s_lshl_b32 s12, s4, 2
    s_lshr_b32 s13, s5, 2
    s_add_u32 s12, s12, s13
    s_mul_i32 s12, s12, 81
    v_add_u32 v64, s12, v0
    v_mul_u32_u24 v65, 3641, v64
    v_lshrrev_b32 v65, 18, v65
    v_mul_u32_u24 v66, 72, v65
    v_sub_u32 v96, v64, v66
    v_lshrrev_b32 v97, 2, v65
    v_and_b32 v98, 3, v65
    v_mul_u32_u24 v69, 36, v97
    v_lshl_add_u32 v69, v98, 3, v69
    v_and_b32 v71, 2, v98
    v_lshl_add_u32 v69, v71, 1, v69
    v_mul_u32_u24 v71, 288, v97
    v_mul_u32_u24 v72, 72, v98
    v_add_u32 v71, v71, v72
    v_subrev_u32 v71, 4592, v71
    v_cmp_le_u32 vcc, 16, v97
    s_nop 1
    v_cndmask_b32 v69, v69, v71, vcc
    v_cndmask_b32 v72, 0, 1, vcc
    v_mul_u32_u24 v69, 1152, v69
    v_lshl_add_u32 v69, v96, 2, v69
    s_and_b32 s12, s5, 3
    s_mul_i32 s12, s12, 288
    v_add_u32 v69, s12, v69
    v_cmp_gt_u32 vcc, 81, v0
    s_nop 1
    v_cndmask_b32 v126, v63, v69, vcc
    s_mov_b32 s12, 36864
    v_mad_u32_u24 v127, v72, s12, v126
    s_lshr_b32 s14, s2, 3
    s_lshl_b32 s14, s14, 6
    s_and_b32 s15, s2, 7
    v_lshrrev_b32 v64, 3, v1
    v_and_b32 v65, 7, v1
    v_mul_u32_u24 v73, 1152, v64
    v_lshl_add_u32 v73, v65, 4, v73
    s_lshl_b32 s12, s3, 4
    s_add_u32 s12, s12, s14
    s_mul_i32 s12, s12, 1152
    s_lshl_b32 s13, s15, 7
    s_add_u32 s12, s12, s13
    s_cmp_eq_u32 s3, 0
    s_cselect_b64 vcc, -1, 0
    v_cndmask_b32 v66, v1, v64, vcc
    v_cndmask_b32 v67, 0, v65, vcc
    s_lshl_b32 s8, s15, 4
    s_add_u32 s8, s8, 1024
    s_cmp_eq_u32 s3, 0
    s_cselect_b32 s13, s13, s8
    s_cselect_b32 s8, 5, 61
    s_mul_i32 s10, s14, 1152
    s_add_u32 s10, s10, s13
    s_cmp_eq_u32 s14, 0
    s_cselect_b32 s8, 64, s8
    s_cselect_b32 s13, 0, 3456
    s_cmp_lt_u32 s3, 2
    s_cselect_b32 s8, s8, 0
    s_cselect_b32 s13, s13, 0
    s_sub_u32 s10, s10, s13
    v_subrev_u32 v66, s8, v66
    v_mul_i32_i24 v75, 1152, v66
    v_lshl_add_u32 v75, v67, 4, v75
    v_cmp_gt_i32 vcc, 0, v66
    s_nop 1
    v_cndmask_b32 v75, v75, v63, vcc
    v_bfe_u32 v74, v0, 1, 2
    v_lshlrev_b32 v74, 4, v74
    s_lshl_b32 s11, s3, 10
    s_add_u32 s11, s11, 18832
    s_cmp_eq_u32 s3, 0
    s_cselect_b32 s11, 0, s11
    s_mul_i32 s9, s3, 2336
    v_lshrrev_b32 v65, 3, v0
    s_lshl_b32 s13, s15, 5
    v_add_u32 v65, s13, v65
    v_lshlrev_b32 v70, 4, v65
    s_waitcnt lgkmcnt(0)
    s_mov_b32 s52, s18
    s_mov_b32 s53, s19
    s_mov_b32 s54, 0x1e6000
    s_mov_b32 s55, 0x00020000
    s_mov_b32 s8, 0
    buffer_load_dword v88, v81, s[52:55], s8 offen offset:0
    buffer_load_dword v89, v81, s[52:55], s8 offen offset:3456
    s_mov_b32 s8, 6912
    buffer_load_dword v90, v81, s[52:55], s8 offen offset:0
    buffer_load_dword v91, v81, s[52:55], s8 offen offset:3456
    s_mov_b32 s8, 13824
    buffer_load_dword v92, v81, s[52:55], s8 offen offset:0
    buffer_load_dword v93, v81, s[52:55], s8 offen offset:3456
    s_mov_b32 s8, 20736
    buffer_load_dword v94, v81, s[52:55], s8 offen offset:0
    buffer_load_dword v95, v81, s[52:55], s8 offen offset:3456
    s_mov_b32 s56, s20
    s_mov_b32 s57, s21
    s_mov_b32 s58, 0xa2000
    s_mov_b32 s59, 0x00020000
    s_mov_b32 s8, 4608
    buffer_load_dword v114, v126, s[56:59], 0 offen offset:0
    buffer_load_dword v115, v126, s[56:59], 0 offen offset:1152
    buffer_load_dword v116, v126, s[56:59], 0 offen offset:2304
    buffer_load_dword v117, v126, s[56:59], 0 offen offset:3456
    buffer_load_dword v118, v127, s[56:59], s8 offen offset:0
    buffer_load_dword v119, v127, s[56:59], s8 offen offset:1152
    buffer_load_dword v120, v127, s[56:59], s8 offen offset:2304
    buffer_load_dword v121, v127, s[56:59], s8 offen offset:3456
    s_mov_b32 s60, s24
    s_mov_b32 s61, s25
    s_mov_b32 s62, 0x240000
    s_mov_b32 s63, 0x00020000
    s_add_u32 m0, s9, 1168
    s_nop 0
    buffer_load_dwordx4 v73, s[60:63], s12 offen lds
    s_mov_b32 s64, s26
    s_mov_b32 s65, s27
    s_mov_b32 s66, 0x240000
    s_mov_b32 s67, 0x00020000
    s_add_u32 m0, s9, 10512
    s_nop 0
    buffer_load_dwordx4 v73, s[64:67], s12 offen lds
    s_add_u32 s12, s12, 9216
    s_add_u32 m0, s9, 2336
    s_nop 0
    buffer_load_dwordx4 v73, s[60:63], s12 offen lds
    s_add_u32 m0, s9, 11680
    s_nop 0
    buffer_load_dwordx4 v73, s[64:67], s12 offen lds
    s_cmp_lt_u32 s3, 3
    s_cselect_b32 s72, s24, s26
    s_cselect_b32 s73, s25, s27
    s_mov_b32 s74, 0x240000
    s_mov_b32 s75, 0x00020000
    s_mov_b32 m0, s11
    s_nop 0
    buffer_load_dwordx4 v75, s[72:75], s10 offen lds
    s_mov_b32 s68, s28
    s_mov_b32 s69, s29
    s_mov_b32 s70, 0x1200
    s_mov_b32 s71, 0x00020000
    s_lshl_b32 s13, s15, 6
    s_add_u32 s13, s13, 4096
    buffer_load_dwordx4 v[152:155], v70, s[68:71], 0 offen
    buffer_load_dwordx4 v[110:113], v74, s[68:71], s13 offen
    s_mov_b32 s40, s38
    s_mov_b32 s41, s39
    s_mov_b32 s42, 0x4000000
    s_mov_b32 s43, 0x00020000
    s_mov_b32 s13, 0x158e000
    buffer_load_dwordx2 v[30:31], off, s[40:43], s13 sc1
    s_mov_b32 s101, 0xffff0000
    s_mov_b32 s100, 0x05040100
    s_mov_b32 s99, 0x07060302
    s_mov_b32 s98, 0
    v_lshlrev_b32 v13, 4, v0
    v_lshlrev_b32 v27, 4, v1
    v_lshlrev_b32 v15, 5, v1
    v_mul_u32_u24 v80, 911, v79
    v_lshrrev_b32 v80, 18, v80
    v_mul_u32_u24 v82, 288, v80
    v_sub_u32 v79, v79, v82
    v_mul_u32_u24 v82, 57, v79
    v_lshrrev_b32 v82, 10, v82
    v_mul_u32_u24 v72, 18, v82
    v_sub_u32 v79, v79, v72
    v_lshrrev_b32 v72, 2, v78
    v_and_b32 v73, 3, v78
    v_mul_u32_u24 v72, 6912, v72
    v_lshlrev_b32 v74, 11, v80
    v_lshl_add_u32 v74, v73, 8, v74
    v_lshl_add_u32 v74, v79, 5, v74
    v_add_u32 v75, 704, v74
    v_cmp_le_u32 vcc, 10, v79
    s_nop 1
    v_cndmask_b32 v74, v74, v75, vcc
    v_mul_u32_u24 v75, 192, v73
    v_lshl_add_u32 v75, v80, 6, v75
    v_lshl_add_u32 v75, v79, 5, v75
    v_add_u32 v75, 5888, v75
    v_lshrrev_b32 v76, 1, v79
    v_cmp_eq_u32 vcc, 4, v76
    s_nop 1
    v_cndmask_b32 v74, v74, v75, vcc
    v_add_u32 v72, v72, v74
    v_mul_u32_u24 v82, 124416, v82
    s_mov_b32 s11, 0x1380000
    v_add3_u32 v72, v72, v82, s11
    v_cndmask_b32 v122, v63, v72, s[90:91]
    v_lshrrev_b32 v84, 1, v1
    v_lshlrev_b32 v84, 2, v84
    v_add_u32 v85, 128, v84
    ds_bpermute_b32 v53, v85, v122
    ds_bpermute_b32 v122, v84, v122
    s_lshl_b32 s8, s3, 11
    s_add_u32 s8, s8, 23040
    v_add_u32 v57, s8, v15
    v_add_u32 v58, s8, v27
    v_and_b32 v86, 1, v1
    v_lshlrev_b32 v86, 4, v86
    v_and_b32 v64, 7, v0
    v_lshl_add_u32 v66, v64, 3, s14
    v_mul_u32_u24 v196, 1168, v64
    v_lshrrev_b32 v67, 3, v0
    v_lshl_add_u32 v196, v67, 2, v196
    v_add_u32 v197, 1168, v196
    v_add_u32 v198, 10512, v196
    v_and_b32 v72, 1, v0
    v_lshl_add_u32 v109, v67, 1, v72
    v_bfe_u32 v71, v0, 1, 2
    v_lshlrev_b32 v108, 2, v71
    v_lshl_add_u32 v108, v109, 4, v108
    v_lshlrev_b32 v129, 13, v65
    v_sub_u32 v66, 2040, v66
    v_lshl_add_u32 v129, v66, 1, v129
    v_add_u32 v128, 4096, v129
    v_lshlrev_b32 v71, 1, v71
    v_sub_u32 v71, v71, v72
    s_lshl_b32 s13, s15, 3
    s_add_u32 s13, s13, 513
    v_add_u32 v71, s13, v71
    v_lshlrev_b32 v124, 12, v71
    s_sub_u32 s13, 2046, s14
    v_lshlrev_b32 v71, 1, v67
    v_sub_u32 v71, s13, v71
    v_lshl_add_u32 v124, v71, 1, v124
    v_mov_b32 v65, v72
    v_mov_b32 v125, 0x03020706
    v_mov_b32 v66, s100
    v_cmp_eq_u32 vcc, 1, v65
    s_nop 1
    v_cndmask_b32 v125, v125, v66, vcc
    s_lshr_b32 s9, s2, 3
    s_lshl_b32 s9, s9, 1
    s_lshl_b32 s10, s15, 6
    s_add_u32 s87, s9, s10
    s_lshr_b32 s9, s2, 5
    s_lshl_b32 s10, s15, 3
    s_add_u32 s9, s9, s10
    s_add_u32 s88, s9, 512
    s_bfe_u32 s71, s2, 0x20003
    v_add_u32 v77, s87, v1
    v_cmp_eq_u32 s[10:11], 2, v1
    v_mov_b32 v83, s88
    s_nop 0
    v_cndmask_b32 v77, v77, v83, s[10:11]
    v_lshlrev_b32 v77, 1, v77
    v_cmp_gt_u32 s[10:11], 3, v1
    s_nop 1
    v_cndmask_b32 v62, v63, v77, s[10:11]
    s_mov_b32 s72, s30
    s_mov_b32 s73, s31
    s_mov_b32 s74, 0x240000
    s_mov_b32 s75, 0x00020000
    s_mov_b32 s76, s32
    s_mov_b32 s77, s33
    s_mov_b32 s78, 0x480
    s_mov_b32 s79, 0x00020000
    s_waitcnt lgkmcnt(0)
    v_add_u32 v53, v53, v86
    v_add_u32 v122, v122, v86
    s_lshr_b32 s8, s5, 2
    s_lshr_b32 s9, s5, 1
    s_and_b32 s9, s9, 1
    s_and_b32 s10, s5, 1
    v_lshrrev_b32 v70, 5, v0
    s_lshl_b32 s11, s4, 7
    s_lshl_b32 s13, s8, 5
    s_add_u32 s11, s11, s13
    s_lshl_b32 s13, s10, 4
    s_add_u32 s11, s11, s13
    s_add_u32 s11, s11, s9
    v_lshl_add_u32 v77, v70, 1, s11
    v_mul_u32_u24 v77, 1152, v77
    v_lshl_add_u32 v16, v2, 4, v77
    v_lshl_add_u32 v17, v2, 2, v77
    v_add_u32 v17, 1024, v17
    s_mov_b32 s44, s34
    s_mov_b32 s45, s35
    s_mov_b32 s46, 0x240000
    s_mov_b32 s47, 0x00020000
    s_mov_b32 s48, s16
    s_mov_b32 s49, s17
    s_mov_b32 s50, 0x240000
    s_mov_b32 s51, 0x00020000
    s_getreg_b32 s66, hwreg(HW_REG_XCC_ID, 0, 4)
    s_mul_i32 s12, s4, 110592
    s_sub_u32 s68, 0x1680000, s12
    s_sub_u32 s69, s68, 110592
    s_or_b32 s12, s5, 2
    s_cmp_eq_u32 s12, 15
    s_cselect_b32 s70, 1, 0
    s_lshl_b32 s84, s4, 4
    s_add_u32 s84, s84, s5
    s_lshl_b32 s84, s84, 3
    s_add_u32 s64, s84, s3
    s_add_u32 s64, s64, s3
    s_lshl_b32 s64, s64, 2
    v_mul_u32_u24 v65, 1168, v70
    v_lshl_add_u32 v21, v2, 4, v65
    v_add_u32 v21, 124416, v21
    v_lshl_add_u32 v22, v2, 2, v65
    v_add_u32 v22, 125440, v22
    v_and_b32 v65, 7, v0
    v_lshrrev_b32 v66, 3, v0
    v_mul_u32_u24 v23, 1168, v65
    v_lshl_add_u32 v23, v66, 4, v23
    v_add_u32 v23, 124416, v23
    s_lshl_b32 s12, s4, 2
    s_add_u32 s12, s12, s8
    s_lshl_b32 s13, s12, 1
    s_add_u32 s13, s13, s9
    s_mul_i32 s14, s13, 18432
    s_lshl_b32 s15, s10, 7
    s_add_u32 s14, s14, s15
    v_lshlrev_b32 v24, 8, v66
    v_lshl_add_u32 v24, v65, 4, v24
    v_add_u32 v24, s14, v24
    v_cmp_gt_u32 vcc, 64, v0
    s_nop 1
    v_cndmask_b32 v9, v63, v24, vcc
    v_mov_b32 v66, v96
    s_and_b32 s12, s5, 3
    s_mul_i32 s12, s12, 9
    v_mov_b32 v71, s12
    v_lshrrev_b32 v72, 4, v66
    v_lshlrev_b32 v72, 1, v72
    v_bfe_u32 v73, v66, 1, 1
    v_add_u32 v72, v72, v73
    v_bfe_u32 v73, v66, 2, 2
    v_lshlrev_b32 v73, 2, v73
    v_and_b32 v74, 1, v66
    v_lshl_add_u32 v73, v74, 1, v73
    v_subrev_u32 v74, 64, v66
    v_lshlrev_b32 v74, 1, v74
    v_cmp_le_u32 s[12:13], 64, v66
    s_nop 1
    v_cndmask_b32 v72, v72, 8, s[12:13]
    v_cndmask_b32 v73, v73, v74, s[12:13]
    v_add_u32 v71, v71, v72
    v_mul_u32_u24 v71, 18, v71
    v_add_u32 v71, v71, v97
    v_lshlrev_b32 v71, 6, v71
    v_lshl_add_u32 v71, v98, 4, v71
    v_add_u32 v71, v71, v73
    v_lshlrev_b32 v71, 4, v71
    v_add_u32 v71, 0x1280000, v71
    v_cmp_gt_u32 vcc, 81, v0
    s_nop 1
    v_cndmask_b32 v123, v63, v71, vcc
    ds_bpermute_b32 v56, v85, v123
    ds_bpermute_b32 v123, v84, v123
    s_waitcnt lgkmcnt(0)
    v_add_u32 v56, v56, v86
    v_add_u32 v123, v123, v86
    s_waitcnt vmcnt(16)
    v_perm_b32 v232, v89, v88, s100
    v_perm_b32 v236, v89, v88, s99
    v_perm_b32 v233, v91, v90, s100
    v_perm_b32 v237, v91, v90, s99
    v_perm_b32 v234, v93, v92, s100
    v_perm_b32 v238, v93, v92, s99
    v_perm_b32 v235, v95, v94, s100
    v_perm_b32 v239, v95, v94, s99
    ds_write_b128 v57, v[232:235]
    ds_write_b128 v57, v[236:239] offset:16
    ds_read_b128 v[224:227], v58
    ds_read_b128 v[228:231], v58 offset:1024
    s_waitcnt lgkmcnt(0)
    buffer_store_dwordx4 v[224:227], v122, s[40:43], 0 offen sc1
    buffer_store_dwordx4 v[228:231], v53, s[40:43], 0 offen sc1
    s_waitcnt vmcnt(10)
    v_perm_b32 v232, v115, v114, s100
    v_perm_b32 v236, v115, v114, s99
    v_perm_b32 v233, v117, v116, s100
    v_perm_b32 v237, v117, v116, s99
    v_perm_b32 v234, v119, v118, s100
    v_perm_b32 v238, v119, v118, s99
    v_perm_b32 v235, v121, v120, s100
    v_perm_b32 v239, v121, v120, s99
    ds_write_b128 v57, v[232:235]
    ds_write_b128 v57, v[236:239] offset:16
    ds_read_b128 v[224:227], v58
    ds_read_b128 v[228:231], v58 offset:1024
    s_waitcnt lgkmcnt(0)
    buffer_store_dwordx4 v[224:227], v123, s[40:43], 0 offen sc1
    buffer_store_dwordx4 v[228:231], v56, s[40:43], 0 offen sc1
    s_lshr_b32 s8, s5, 2
    s_lshr_b32 s9, s5, 1
    s_and_b32 s9, s9, 1
    s_and_b32 s10, s5, 1
    v_lshrrev_b32 v70, 5, v0
    s_lshl_b32 s57, s4, 4
    s_add_u32 s57, s57, s5
    s_mul_i32 s57, s57, 36864
    s_add_u32 s57, s57, 0x480000
    s_lshl_b32 s12, s4, 2
    s_add_u32 s12, s12, s8
    s_lshl_b32 s14, s12, 2
    s_mul_i32 s14, s14, 36864
    s_mul_i32 s15, s9, 4608
    s_add_u32 s14, s14, s15
    s_add_u32 s14, s14, 0x482400
    s_lshl_b32 s15, s10, 3
    v_add_u32 v64, s15, v70
    v_mov_b32 v65, v2
    v_mul_u32_u24 v66, 57, v65
    v_lshrrev_b32 v66, 10, v66
    v_mul_u32_u24 v67, 18, v66
    v_sub_u32 v65, v65, v67
    v_mul_u32_u24 v66, 36864, v66
    v_lshrrev_b32 v67, 2, v65
    v_lshlrev_b32 v67, 10, v67
    v_lshl_add_u32 v67, v64, 6, v67
    v_and_b32 v68, 3, v65
    v_lshl_add_u32 v67, v68, 4, v67
    v_lshlrev_b32 v68, 5, v64
    v_lshl_add_u32 v68, v65, 4, v68
    v_add_u32 v68, 3840, v68
    v_cmp_le_u32 vcc, 16, v65
    s_nop 1
    v_cndmask_b32 v67, v67, v68, vcc
    v_add_u32 v18, v66, v67
    v_add_u32 v18, s14, v18
    v_add_u32 v65, 32, v2
    v_mul_u32_u24 v66, 57, v65
    v_lshrrev_b32 v66, 10, v66
    v_mul_u32_u24 v67, 18, v66
    v_sub_u32 v65, v65, v67
    v_mul_u32_u24 v66, 36864, v66
    v_lshrrev_b32 v67, 2, v65
    v_lshlrev_b32 v67, 10, v67
    v_lshl_add_u32 v67, v64, 6, v67
    v_and_b32 v68, 3, v65
    v_lshl_add_u32 v67, v68, 4, v67
    v_lshlrev_b32 v68, 5, v64
    v_lshl_add_u32 v68, v65, 4, v68
    v_add_u32 v68, 3840, v68
    v_cmp_le_u32 vcc, 16, v65
    s_nop 1
    v_cndmask_b32 v67, v67, v68, vcc
    v_add_u32 v19, v66, v67
    v_add_u32 v19, s14, v19
    v_lshrrev_b32 v65, 2, v2
    v_add_u32 v65, 64, v65
    v_mul_u32_u24 v66, 57, v65
    v_lshrrev_b32 v66, 10, v66
    v_mul_u32_u24 v67, 18, v66
    v_sub_u32 v65, v65, v67
    v_mul_u32_u24 v66, 36864, v66
    v_lshrrev_b32 v67, 2, v65
    v_lshlrev_b32 v67, 10, v67
    v_lshl_add_u32 v67, v64, 6, v67
    v_and_b32 v68, 3, v65
    v_lshl_add_u32 v67, v68, 4, v67
    v_lshlrev_b32 v68, 5, v64
    v_lshl_add_u32 v68, v65, 4, v68
    v_add_u32 v68, 3840, v68
    v_cmp_le_u32 vcc, 16, v65
    s_nop 1
    v_cndmask_b32 v67, v67, v68, vcc
    v_add_u32 v20, v66, v67
    v_add_u32 v20, s14, v20
    v_and_b32 v65, 3, v2
    v_lshl_add_u32 v20, v65, 2, v20
    s_lshl_b32 s86, s12, 1
    s_add_u32 s86, s86, s10
    s_lshl_b32 s86, s86, 5
    s_lshl_b32 s14, s9, 4
    s_add_u32 s86, s86, s14
    s_add_u32 s86, s86, 0x1040000
    s_lshl_b32 s8, s4, 2
    s_lshl_b32 s9, s7, 1
    s_add_u32 s9, s9, s8
    s_lshl_b32 s9, s9, 1
    s_add_u32 s9, s9, s6
    s_mul_i32 s9, s9, 18432
    v_add_u32 v5, s9, v27
    s_sub_u32 s9, s8, 1
    s_lshl_b32 s9, s9, 1
    v_lshrrev_b32 v64, 3, v3
    v_add_u32 v64, s9, v64
    v_mul_u32_u24 v64, 18432, v64
    v_lshl_add_u32 v64, v4, 8, v64
    v_and_b32 v65, 7, v3
    v_lshl_add_u32 v64, v65, 4, v64
    v_add_u32 v6, 128, v64
    s_cmp_eq_u32 s4, 0
    s_cselect_b64 vcc, -1, 0
    v_cndmask_b32 v6, v6, v63, vcc
    s_cmp_ge_u32 s3, 2
    s_cselect_b64 vcc, -1, 0
    v_cndmask_b32 v10, v6, v63, vcc
    v_min_u32 v64, 11, v3
    v_mul_u32_u24 v65, 192, v4
    v_lshl_add_u32 v8, v64, 4, v65
    v_add_u32 v8, 6144, v8
    s_mul_i32 s8, s3, 5
    s_cmp_eq_u32 s3, 3
    s_cselect_b32 s8, 14, s8
    s_lshl_b32 s56, s8, 10
    s_add_u32 s9, s8, 0
    s_sub_u32 s10, s9, 18
    s_cmp_ge_u32 s9, 18
    s_cselect_b32 s9, s10, s9
    s_mul_i32 s52, s9, 6912
    s_add_u32 s9, s8, 4
    s_sub_u32 s10, s9, 18
    s_cmp_ge_u32 s9, 18
    s_cselect_b32 s9, s10, s9
    s_mul_i32 s53, s9, 6912
    s_add_u32 s9, s8, 8
    s_sub_u32 s10, s9, 18
    s_cmp_ge_u32 s9, 18
    s_cselect_b32 s9, s10, s9
    s_mul_i32 s54, s9, 6912
    s_add_u32 s9, s8, 13
    s_sub_u32 s10, s9, 18
    s_cmp_ge_u32 s9, 18
    s_cselect_b32 s9, s10, s9
    s_mul_i32 s55, s9, 6912
    v_bfe_u32 v64, v3, 2, 1
    v_lshlrev_b32 v64, 3, v64
    v_and_b32 v65, 3, v3
    v_lshl_add_u32 v64, v65, 1, v64
    v_lshrrev_b32 v65, 3, v3
    v_add_u32 v64, v64, v65
    v_add_u32 v64, 1, v64
    v_lshrrev_b32 v64, 1, v64
    v_lshl_add_u32 v64, v4, 2, v64
    v_lshlrev_b32 v64, 2, v64
    v_cmp_eq_u32 vcc, 0, v65
    v_mov_b32 v66, 4160
    s_nop 0
    v_cndmask_b32 v66, 0, v66, vcc
    v_add_u32 v64, v64, v66
    v_lshlrev_b32 v65, 5, v3
    v_sub_u32 v65, 8800, v65
    v_lshl_add_u32 v65, v4, 4, v65
    s_mul_i32 s8, s7, 12896
    s_lshl_b32 s9, s6, 6
    s_add_u32 s8, s8, s9
    s_add_u32 s8, s8, 124416
    v_add_u32 v68, s8, v64
    v_add_u32 v69, 1024, v68
    v_add_u32 v70, 2048, v68
    v_add_u32 v71, 3072, v68
    v_add_u32 v72, s8, v65
    s_lshl_b32 s9, s3, 6
    s_add_u32 s9, s9, 150208
    v_add_u32 v73, s9, v64
    v_add_u32 v74, s9, v65
    v_add_u32 v75, 1024, v73
    v_add_u32 v76, 2048, v73
    v_add_u32 v77, 3072, v73
    v_lshlrev_b32 v64, 4, v3
    v_and_b32 v65, 1, v4
    v_lshl_add_u32 v64, v65, 3, v64
    v_lshlrev_b32 v66, 1, v64
    s_mul_i32 s8, s7, 12896
    s_lshl_b32 s9, s6, 11
    s_sub_u32 s8, s8, s9
    s_add_u32 s8, s8, 135280
    v_sub_u32 v59, s8, v66
    s_sub_u32 s11, 7, s71
    s_cmp_eq_u32 s6, 0
    s_cselect_b32 s11, s71, s11
    s_lshl_b32 s11, s11, 9
    s_sub_u32 s11, 162608, s11
    v_sub_u32 v60, s11, v66
    v_add_u32 v64, 124416, v13
    v_mov_b32 v240, 0
    v_mov_b32 v241, 0
    v_mov_b32 v242, 0
    v_mov_b32 v243, 0
    v_cmp_gt_u32 vcc, 30, v0
    s_nop 0
    s_and_saveexec_b64 s[8:9], vcc
    ds_write_b128 v64, v[240:243] offset:12416
    ds_write_b128 v64, v[240:243] offset:25312
    ds_write_b128 v64, v[240:243] offset:38208
    s_mov_b64 exec, s[8:9]
    v_cmp_eq_u32 vcc, 2, v0
    v_mov_b32 v65, 128576
    s_nop 0
    v_cndmask_b32 v64, v64, v65, vcc
    v_cmp_gt_u32 vcc, 3, v0
    s_nop 0
    s_and_saveexec_b64 s[8:9], vcc
    ds_write_b128 v64, v[240:243] offset:0
    ds_write_b128 v64, v[240:243] offset:12896
    ds_write_b128 v64, v[240:243] offset:25792
    s_mov_b64 exec, s[8:9]
    s_lshr_b32 s8, s5, 2
    s_lshl_b32 s9, s8, 5
    v_add_u32 v64, s9, v3
    s_lshl_b32 s10, s8, 11
    v_add_u32 v25, s10, v27
    s_lshl_b32 s9, s4, 4
    s_lshl_b32 s10, s3, 2
    s_add_u32 s10, s10, s9
    s_mul_i32 s10, s10, 36864
    s_add_u32 s10, s10, 0x480000
    v_add_u32 v25, s10, v25
    s_lshl_b32 s10, s6, 4
    v_add_u32 v64, s10, v64
    v_lshlrev_b32 v26, 3, v64
    v_mul_u32_u24 v65, 73728, v4
    v_add_u32 v26, v26, v65
    s_lshl_b32 s10, s7, 3
    s_add_u32 s10, s10, s9
    s_mul_i32 s10, s10, 36864
    s_add_u32 s10, s10, 0x482000
    v_add_u32 v26, s10, v26
    s_mul_i32 s9, s6, 4608
    s_add_u32 s9, s9, s57
    s_add_u32 s9, s9, 9216
    s_lshl_b32 s10, s3, 10
    v_lshlrev_b32 v28, 6, v3
    v_lshl_add_u32 v28, v4, 4, v28
    v_add_u32 v28, s10, v28
    s_sub_u32 s10, 1, s6
    s_mul_i32 s10, s10, 4608
    s_add_u32 s10, s10, s57
    s_add_u32 s10, s10, 9216
    v_add_u32 v11, s10, v28
    v_add_u32 v28, s9, v28
    s_add_u32 s10, s9, 4096
    v_lshlrev_b32 v29, 5, v3
    v_lshl_add_u32 v29, v4, 3, v29
    v_add_u32 v29, s10, v29
    s_and_b32 s10, s5, 3
    s_mul_i32 s10, s10, 9
    s_lshl_b32 s11, s3, 1
    s_add_u32 s11, s11, s10
    s_mul_i32 s89, s11, 18432
    s_add_u32 s89, s89, 0x1280000
    s_add_u32 s10, s10, 8
    s_mul_i32 s92, s10, 18432
    s_add_u32 s92, s92, 0x1280000
    s_mul_i32 s10, s7, 9216
    s_add_u32 s92, s92, s10
    s_lshl_b32 s8, s7, 6
    s_lshl_b32 s9, s6, 4
    s_add_u32 s8, s8, s9
    v_add_u32 v64, s8, v3
    v_and_b32 v65, 1, v4
    v_lshlrev_b32 v65, 1, v65
    v_lshrrev_b32 v66, 1, v4
    v_add_u32 v65, v65, v66
    v_lshlrev_b32 v32, 8, v65
    v_lshl_add_u32 v32, v3, 4, v32
    s_lshl_b32 s9, s8, 6
    s_add_u32 s9, s9, s57
    v_add_u32 v32, s9, v32
    v_lshlrev_b32 v33, 3, v64
    s_add_u32 s9, s57, 8192
    v_add_u32 v33, s9, v33
    v_lshlrev_b32 v64, 3, v1
    s_mul_i32 s8, s3, 3072
    s_add_u32 s8, s8, 127488
    v_add_u32 v34, s8, v64
    v_add_u32 v37, 124416, v64
    s_lshl_b32 s8, s3, 9
    v_add_u32 v35, s8, v37
    s_lshl_b32 s8, s3, 10
    s_add_u32 s8, s8, 142848
    v_add_u32 v36, s8, v27
    s_lshl_b32 s8, s3, 12
    s_add_u32 s8, s8, 142848
    v_add_u32 v12, s8, v27
    v_add_u32 v14, 159232, v27
    s_add_u32 s8, s6, 1
    s_mul_i32 s8, s8, 3072
    s_cmp_eq_u32 s7, 0
    s_cselect_b32 s8, 0, s8
    s_add_u32 s8, s8, 124416
    v_add_u32 v38, s8, v64
    v_subrev_u32 v64, 32, v1
    v_and_b32 v65, 1, v64
    v_lshlrev_b32 v65, 4, v65
    v_mov_b32 v66, 0x3f80
    v_lshlrev_b32 v66, v65, v66
    v_lshrrev_b32 v64, 1, v64
    v_cmp_eq_u32 vcc, 0, v64
    s_nop 1
    v_cndmask_b32 v40, 0, v66, vcc
    v_cmp_eq_u32 vcc, 1, v64
    s_nop 1
    v_cndmask_b32 v41, 0, v66, vcc
    v_mov_b32 v42, 0
    v_mov_b32 v43, 0
    s_lshl_b32 s9, s87, 12
    buffer_load_dwordx4 a[228:231], v13, s[72:75], s9 offen
    buffer_load_ushort a240, v13, s[72:75], s9 offen offset:16
    s_lshl_b32 s9, s87, 12
    s_add_u32 s9, s9, 4096
    buffer_load_dwordx4 a[232:235], v13, s[72:75], s9 offen
    buffer_load_ushort a241, v13, s[72:75], s9 offen offset:16
    s_lshl_b32 s9, s88, 12
    buffer_load_dwordx4 a[236:239], v13, s[72:75], s9 offen
    buffer_load_ushort a242, v13, s[72:75], s9 offen offset:16
    buffer_load_ushort v62, v62, s[76:79], 0 offen
    buffer_load_dwordx4 v[44:47], v16, s[48:51], 0 offen
    buffer_load_dwordx4 v[48:51], v16, s[48:51], 0 offen offset:512
    buffer_load_dword v52, v17, s[48:51], 0 offen
    v_cmp_gt_u32 s[90:91], 16, v1
    v_lshlrev_b32 v64, 2, v4
    s_lshl_b32 s12, s6, 3
    v_add_u32 v65, 0, v64
    v_sub_u32 v66, v3, v65
    v_cmp_ge_u32 s[16:17], 7, v66
    v_add_u32 v66, 9, v3
    v_cmp_ge_u32 s[24:25], v65, v66
    v_subrev_u32 v65, s12, v65
    v_sub_u32 v66, v65, v3
    v_cmp_ge_u32 vcc, 7, v65
    v_cmp_lt_i32 s[14:15], 0, v66
    s_nop 0
    s_and_b64 s[14:15], s[14:15], vcc
    s_cmp_eq_u32 s4, 0
    s_cselect_b64 s[14:15], 0, s[14:15]
    s_cmp_eq_u32 s7, 0
    s_cselect_b64 s[32:33], s[14:15], s[24:25]
    v_add_u32 v65, 1, v64
    v_sub_u32 v66, v3, v65
    v_cmp_ge_u32 s[18:19], 7, v66
    v_add_u32 v66, 9, v3
    v_cmp_ge_u32 s[26:27], v65, v66
    v_subrev_u32 v65, s12, v65
    v_sub_u32 v66, v65, v3
    v_cmp_ge_u32 vcc, 7, v65
    v_cmp_lt_i32 s[14:15], 0, v66
    s_nop 0
    s_and_b64 s[14:15], s[14:15], vcc
    s_cmp_eq_u32 s4, 0
    s_cselect_b64 s[14:15], 0, s[14:15]
    s_cmp_eq_u32 s7, 0
    s_cselect_b64 s[34:35], s[14:15], s[26:27]
    v_add_u32 v65, 2, v64
    v_sub_u32 v66, v3, v65
    v_cmp_ge_u32 s[20:21], 7, v66
    v_add_u32 v66, 9, v3
    v_cmp_ge_u32 s[28:29], v65, v66
    v_subrev_u32 v65, s12, v65
    v_sub_u32 v66, v65, v3
    v_cmp_ge_u32 vcc, 7, v65
    v_cmp_lt_i32 s[14:15], 0, v66
    s_nop 0
    s_and_b64 s[14:15], s[14:15], vcc
    s_cmp_eq_u32 s4, 0
    s_cselect_b64 s[14:15], 0, s[14:15]
    s_cmp_eq_u32 s7, 0
    s_cselect_b64 s[36:37], s[14:15], s[28:29]
    v_add_u32 v65, 3, v64
    v_sub_u32 v66, v3, v65
    v_cmp_ge_u32 s[22:23], 7, v66
    v_add_u32 v66, 9, v3
    v_cmp_ge_u32 s[30:31], v65, v66
    v_subrev_u32 v65, s12, v65
    v_sub_u32 v66, v65, v3
    v_cmp_ge_u32 vcc, 7, v65
    v_cmp_lt_i32 s[14:15], 0, v66
    s_nop 0
    s_and_b64 s[14:15], s[14:15], vcc
    s_cmp_eq_u32 s4, 0
    s_cselect_b64 s[14:15], 0, s[14:15]
    s_cmp_eq_u32 s7, 0
    s_cselect_b64 s[38:39], s[14:15], s[30:31]
    v_mov_b32 v66, 0xffff
    v_cndmask_b32 v64, 0, v66, s[32:33]
    v_cndmask_b32 v65, 0, v66, s[34:35]
    v_lshl_or_b32 v64, v65, 16, v64
    v_accvgpr_write_b32 a252, v64
    v_cndmask_b32 v64, 0, v66, s[36:37]
    v_cndmask_b32 v65, 0, v66, s[38:39]
    v_lshl_or_b32 v64, v65, 16, v64
    v_accvgpr_write_b32 a253, v64
    v_cndmask_b32 v64, 0, v66, s[24:25]
    v_cndmask_b32 v65, 0, v66, s[26:27]
    v_lshl_or_b32 v64, v65, 16, v64
    v_accvgpr_write_b32 a254, v64
    v_cndmask_b32 v64, 0, v66, s[28:29]
    v_cndmask_b32 v65, 0, v66, s[30:31]
    v_lshl_or_b32 v64, v65, 16, v64
    v_accvgpr_write_b32 a255, v64
    s_mov_b32 s96, 0x3e715bef
    s_mov_b32 s97, 0x3e715bef
    s_mov_b32 s94, 0x3fb8aa3b
    s_mov_b32 s95, 0x3fb8aa3b
    s_waitcnt vmcnt(14)
    v_xor_b32 v30, 0x5bd1e990, v30
    v_xor_b32 v31, 0x9e3779b9, v31
    v_and_b32 v30, 0xfffffff0, v30
    v_mov_b32 v54, 163824
    v_mov_b32 v64, -1
    v_mov_b32 v65, -1
    v_mov_b32 v66, 0
    s_mov_b64 exec, 1
    ds_write_b96 v54, v[64:66]
    s_mov_b64 exec, -1
    v_mul_u32_u24 v55, 4352, v1
    s_waitcnt lgkmcnt(0)
    s_barrier
    ds_read_b32 v104, v108 offset:20832
    ds_read_b32 v105, v108 offset:20848
    ds_read_b32 v106, v108 offset:20864
    ds_read_b32 v107, v108 offset:20880
    ds_read_b32 v108, v108 offset:21904
    ds_read_b32 v131, v196 offset:640
    ds_read2_b32 v[132:133], v196 offset0:192 offset1:224
    ds_read2_b32 v[134:135], v197 offset0:0 offset1:32
    ds_read2_b32 v[136:137], v197 offset0:64 offset1:96
    ds_read2_b32 v[138:139], v197 offset0:128 offset1:160
    ds_read2_b32 v[140:141], v197 offset0:192 offset1:224
    ds_read2_b32 v[142:143], v198 offset0:0 offset1:32
    ds_read2_b32 v[144:145], v198 offset0:64 offset1:96
    ds_read2_b32 v[146:147], v198 offset0:128 offset1:160
    ds_read2_b32 v[148:149], v198 offset0:192 offset1:224
    v_lshlrev_b32 v224, 16, v110
    v_lshlrev_b32 v225, 16, v112
    v_and_b32 v226, s101, v110
    v_and_b32 v227, s101, v112
    v_lshlrev_b32 v228, 16, v111
    v_lshlrev_b32 v229, 16, v113
    v_and_b32 v230, s101, v111
    v_and_b32 v231, s101, v113
    s_cmp_ge_u32 s2, 8
    s_cbranch_scc1 L_nomask
    v_and_b32 v64, 7, v0
    v_cmp_eq_u32 vcc, 0, v64
    s_waitcnt lgkmcnt(0)
    s_nop 0
    v_cndmask_b32 v131, v131, 0, vcc
    v_cndmask_b32 v132, v132, 0, vcc
    v_cndmask_b32 v133, v133, 0, vcc
    v_cmp_gt_u32 vcc, 3, v109
    s_nop 1
    v_cndmask_b32 v104, v104, 0, vcc
    v_cmp_gt_u32 vcc, 2, v109
    s_nop 1
    v_cndmask_b32 v105, v105, 0, vcc
    v_cmp_gt_u32 vcc, 1, v109
    s_nop 1
    v_cndmask_b32 v106, v106, 0, vcc
L_nomask:
    s_waitcnt lgkmcnt(10)
    v_and_b32 v233, s101, v104
    v_lshlrev_b32 v232, 16, v104
    v_and_b32 v235, s101, v105
    v_lshlrev_b32 v234, 16, v105
    v_and_b32 v237, s101, v106
    v_lshlrev_b32 v236, 16, v106
    v_and_b32 v239, s101, v107
    v_lshlrev_b32 v238, 16, v107
    v_pk_mul_f32 v[244:245], v[232:233], v[230:231]
    v_cvt_pk_bf16_f32 v244, 0, v244
    v_cvt_pk_bf16_f32 v245, 0, v245
    v_pk_mul_f32 v[246:247], v[234:235], v[228:229]
    v_cvt_pk_bf16_f32 v246, 0, v246
    v_cvt_pk_bf16_f32 v247, 0, v247
    v_pk_add_f32 v[244:245], v[244:245], v[246:247]
    v_cvt_pk_bf16_f32 v244, 0, v244
    v_cvt_pk_bf16_f32 v245, 0, v245
    v_pk_mul_f32 v[246:247], v[236:237], v[226:227]
    v_cvt_pk_bf16_f32 v246, 0, v246
    v_cvt_pk_bf16_f32 v247, 0, v247
    v_pk_add_f32 v[244:245], v[244:245], v[246:247]
    v_cvt_pk_bf16_f32 v244, 0, v244
    v_cvt_pk_bf16_f32 v245, 0, v245
    v_pk_mul_f32 v[246:247], v[238:239], v[224:225]
    v_cvt_pk_bf16_f32 v246, 0, v246
    v_cvt_pk_bf16_f32 v247, 0, v247
    v_pk_add_f32 v[244:245], v[244:245], v[246:247]
    v_cvt_pk_bf16_f32 v244, 0, v244
    v_cvt_pk_bf16_f32 v245, 0, v245
    v_and_b32 v247, s101, v108
    v_lshlrev_b32 v246, 16, v108
    v_pk_mul_f32 v[244:245], v[244:245], v[246:247]
    v_cvt_pk_bf16_f32 v240, v244, v245
    s_nop 1
    v_mov_b32_dpp v241, v240 quad_perm:[1,0,3,2] row_mask:0xf bank_mask:0xf
    v_perm_b32 v107, v241, v240, v125
    s_mov_b32 s65, 0xe00000
    buffer_store_dword v107, v124, s[40:43], s65 offen
    v_lshlrev_b32 v156, 16, v152
    v_lshlrev_b32 v157, 16, v154
    v_and_b32 v158, s101, v152
    v_and_b32 v159, s101, v154
    v_lshlrev_b32 v160, 16, v153
    v_lshlrev_b32 v161, 16, v155
    v_and_b32 v162, s101, v153
    v_and_b32 v163, s101, v155
    s_waitcnt lgkmcnt(4)
    v_and_b32 v165, s101, v131
    v_lshlrev_b32 v164, 16, v131
    v_and_b32 v167, s101, v132
    v_lshlrev_b32 v166, 16, v132
    v_and_b32 v169, s101, v133
    v_lshlrev_b32 v168, 16, v133
    v_and_b32 v171, s101, v134
    v_lshlrev_b32 v170, 16, v134
    v_and_b32 v173, s101, v135
    v_lshlrev_b32 v172, 16, v135
    v_and_b32 v175, s101, v136
    v_lshlrev_b32 v174, 16, v136
    v_and_b32 v177, s101, v137
    v_lshlrev_b32 v176, 16, v137
    v_and_b32 v179, s101, v138
    v_lshlrev_b32 v178, 16, v138
    v_and_b32 v181, s101, v139
    v_lshlrev_b32 v180, 16, v139
    v_and_b32 v183, s101, v140
    v_lshlrev_b32 v182, 16, v140
    v_and_b32 v185, s101, v141
    v_lshlrev_b32 v184, 16, v141
    s_waitcnt lgkmcnt(0)
    v_pk_mul_f32 v[196:197], v[164:165], v[162:163]
    v_pk_mul_f32 v[202:203], v[166:167], v[162:163]
    v_pk_mul_f32 v[208:209], v[168:169], v[162:163]
    v_pk_mul_f32 v[214:215], v[170:171], v[162:163]
    v_cvt_pk_bf16_f32 v196, 0, v196
    v_cvt_pk_bf16_f32 v197, 0, v197
    v_cvt_pk_bf16_f32 v202, 0, v202
    v_cvt_pk_bf16_f32 v203, 0, v203
    v_cvt_pk_bf16_f32 v208, 0, v208
    v_cvt_pk_bf16_f32 v209, 0, v209
    v_cvt_pk_bf16_f32 v214, 0, v214
    v_cvt_pk_bf16_f32 v215, 0, v215
    v_pk_mul_f32 v[198:199], v[166:167], v[160:161]
    v_pk_mul_f32 v[204:205], v[168:169], v[160:161]
    v_pk_mul_f32 v[210:211], v[170:171], v[160:161]
    v_pk_mul_f32 v[216:217], v[172:173], v[160:161]
    v_cvt_pk_bf16_f32 v198, 0, v198
    v_cvt_pk_bf16_f32 v199, 0, v199
    v_cvt_pk_bf16_f32 v204, 0, v204
    v_cvt_pk_bf16_f32 v205, 0, v205
    v_cvt_pk_bf16_f32 v210, 0, v210
    v_cvt_pk_bf16_f32 v211, 0, v211
    v_cvt_pk_bf16_f32 v216, 0, v216
    v_cvt_pk_bf16_f32 v217, 0, v217
    v_pk_add_f32 v[196:197], v[196:197], v[198:199]
    v_pk_add_f32 v[202:203], v[202:203], v[204:205]
    v_pk_add_f32 v[208:209], v[208:209], v[210:211]
    v_pk_add_f32 v[214:215], v[214:215], v[216:217]
    v_cvt_pk_bf16_f32 v196, 0, v196
    v_cvt_pk_bf16_f32 v197, 0, v197
    v_cvt_pk_bf16_f32 v202, 0, v202
    v_cvt_pk_bf16_f32 v203, 0, v203
    v_cvt_pk_bf16_f32 v208, 0, v208
    v_cvt_pk_bf16_f32 v209, 0, v209
    v_cvt_pk_bf16_f32 v214, 0, v214
    v_cvt_pk_bf16_f32 v215, 0, v215
    v_pk_mul_f32 v[198:199], v[168:169], v[158:159]
    v_pk_mul_f32 v[204:205], v[170:171], v[158:159]
    v_pk_mul_f32 v[210:211], v[172:173], v[158:159]
    v_pk_mul_f32 v[216:217], v[174:175], v[158:159]
    v_cvt_pk_bf16_f32 v198, 0, v198
    v_cvt_pk_bf16_f32 v199, 0, v199
    v_cvt_pk_bf16_f32 v204, 0, v204
    v_cvt_pk_bf16_f32 v205, 0, v205
    v_cvt_pk_bf16_f32 v210, 0, v210
    v_cvt_pk_bf16_f32 v211, 0, v211
    v_cvt_pk_bf16_f32 v216, 0, v216
    v_cvt_pk_bf16_f32 v217, 0, v217
    v_pk_add_f32 v[196:197], v[196:197], v[198:199]
    v_pk_add_f32 v[202:203], v[202:203], v[204:205]
    v_pk_add_f32 v[208:209], v[208:209], v[210:211]
    v_pk_add_f32 v[214:215], v[214:215], v[216:217]
    v_cvt_pk_bf16_f32 v196, 0, v196
    v_cvt_pk_bf16_f32 v197, 0, v197
    v_cvt_pk_bf16_f32 v202, 0, v202
    v_cvt_pk_bf16_f32 v203, 0, v203
    v_cvt_pk_bf16_f32 v208, 0, v208
    v_cvt_pk_bf16_f32 v209, 0, v209
    v_cvt_pk_bf16_f32 v214, 0, v214
    v_cvt_pk_bf16_f32 v215, 0, v215
    v_pk_mul_f32 v[198:199], v[170:171], v[156:157]
    v_pk_mul_f32 v[204:205], v[172:173], v[156:157]
    v_pk_mul_f32 v[210:211], v[174:175], v[156:157]
    v_pk_mul_f32 v[216:217], v[176:177], v[156:157]
    v_cvt_pk_bf16_f32 v198, 0, v198
    v_cvt_pk_bf16_f32 v199, 0, v199
    v_cvt_pk_bf16_f32 v204, 0, v204
    v_cvt_pk_bf16_f32 v205, 0, v205
    v_cvt_pk_bf16_f32 v210, 0, v210
    v_cvt_pk_bf16_f32 v211, 0, v211
    v_cvt_pk_bf16_f32 v216, 0, v216
    v_cvt_pk_bf16_f32 v217, 0, v217
    v_pk_add_f32 v[196:197], v[196:197], v[198:199]
    v_pk_add_f32 v[202:203], v[202:203], v[204:205]
    v_pk_add_f32 v[208:209], v[208:209], v[210:211]
    v_pk_add_f32 v[214:215], v[214:215], v[216:217]
    v_cvt_pk_bf16_f32 v196, 0, v196
    v_cvt_pk_bf16_f32 v197, 0, v197
    v_cvt_pk_bf16_f32 v202, 0, v202
    v_cvt_pk_bf16_f32 v203, 0, v203
    v_cvt_pk_bf16_f32 v208, 0, v208
    v_cvt_pk_bf16_f32 v209, 0, v209
    v_cvt_pk_bf16_f32 v214, 0, v214
    v_cvt_pk_bf16_f32 v215, 0, v215
    v_and_b32 v199, s101, v142
    v_lshlrev_b32 v198, 16, v142
    v_pk_mul_f32 v[196:197], v[196:197], v[198:199]
    v_cvt_pk_bf16_f32 v186, v196, v197
    v_and_b32 v205, s101, v143
    v_lshlrev_b32 v204, 16, v143
    v_pk_mul_f32 v[202:203], v[202:203], v[204:205]
    v_cvt_pk_bf16_f32 v187, v202, v203
    v_and_b32 v211, s101, v144
    v_lshlrev_b32 v210, 16, v144
    v_pk_mul_f32 v[208:209], v[208:209], v[210:211]
    v_cvt_pk_bf16_f32 v188, v208, v209
    v_and_b32 v217, s101, v145
    v_lshlrev_b32 v216, 16, v145
    v_pk_mul_f32 v[214:215], v[214:215], v[216:217]
    v_cvt_pk_bf16_f32 v189, v214, v215
    s_waitcnt vmcnt(11)
    v_mov_b32 v108, 1
    s_mov_b64 exec, 1
    ds_add_rtn_u32 v108, v54, v108 offset:8
    s_mov_b64 exec, -1
    s_add_u32 s11, s84, 0x15c0000
    s_waitcnt lgkmcnt(0)
    v_readfirstlane_b32 s8, v108
    s_nop 0
    s_mov_b32 s81, s8
    s_cmp_lg_u32 s8, 3
    s_cbranch_scc1 L_nofw
    s_mov_b64 exec, 0xff
    buffer_store_dwordx2 v[30:31], v55, s[40:43], s11 offen sc1
    s_mov_b64 exec, -1
L_nofw:
    v_pk_mul_f32 v[196:197], v[172:173], v[162:163]
    v_pk_mul_f32 v[202:203], v[174:175], v[162:163]
    v_pk_mul_f32 v[208:209], v[176:177], v[162:163]
    v_pk_mul_f32 v[214:215], v[178:179], v[162:163]
    v_cvt_pk_bf16_f32 v196, 0, v196
    v_cvt_pk_bf16_f32 v197, 0, v197
    v_cvt_pk_bf16_f32 v202, 0, v202
    v_cvt_pk_bf16_f32 v203, 0, v203
    v_cvt_pk_bf16_f32 v208, 0, v208
    v_cvt_pk_bf16_f32 v209, 0, v209
    v_cvt_pk_bf16_f32 v214, 0, v214
    v_cvt_pk_bf16_f32 v215, 0, v215
    v_pk_mul_f32 v[198:199], v[174:175], v[160:161]
    v_pk_mul_f32 v[204:205], v[176:177], v[160:161]
    v_pk_mul_f32 v[210:211], v[178:179], v[160:161]
    v_pk_mul_f32 v[216:217], v[180:181], v[160:161]
    v_cvt_pk_bf16_f32 v198, 0, v198
    v_cvt_pk_bf16_f32 v199, 0, v199
    v_cvt_pk_bf16_f32 v204, 0, v204
    v_cvt_pk_bf16_f32 v205, 0, v205
    v_cvt_pk_bf16_f32 v210, 0, v210
    v_cvt_pk_bf16_f32 v211, 0, v211
    v_cvt_pk_bf16_f32 v216, 0, v216
    v_cvt_pk_bf16_f32 v217, 0, v217
    v_pk_add_f32 v[196:197], v[196:197], v[198:199]
    v_pk_add_f32 v[202:203], v[202:203], v[204:205]
    v_pk_add_f32 v[208:209], v[208:209], v[210:211]
    v_pk_add_f32 v[214:215], v[214:215], v[216:217]
    v_cvt_pk_bf16_f32 v196, 0, v196
    v_cvt_pk_bf16_f32 v197, 0, v197
    v_cvt_pk_bf16_f32 v202, 0, v202
    v_cvt_pk_bf16_f32 v203, 0, v203
    v_cvt_pk_bf16_f32 v208, 0, v208
    v_cvt_pk_bf16_f32 v209, 0, v209
    v_cvt_pk_bf16_f32 v214, 0, v214
    v_cvt_pk_bf16_f32 v215, 0, v215
    v_pk_mul_f32 v[198:199], v[176:177], v[158:159]
    v_pk_mul_f32 v[204:205], v[178:179], v[158:159]
    v_pk_mul_f32 v[210:211], v[180:181], v[158:159]
    v_pk_mul_f32 v[216:217], v[182:183], v[158:159]
    v_cvt_pk_bf16_f32 v198, 0, v198
    v_cvt_pk_bf16_f32 v199, 0, v199
    v_cvt_pk_bf16_f32 v204, 0, v204
    v_cvt_pk_bf16_f32 v205, 0, v205
    v_cvt_pk_bf16_f32 v210, 0, v210
    v_cvt_pk_bf16_f32 v211, 0, v211
    v_cvt_pk_bf16_f32 v216, 0, v216
    v_cvt_pk_bf16_f32 v217, 0, v217
    v_pk_add_f32 v[196:197], v[196:197], v[198:199]
    v_pk_add_f32 v[202:203], v[202:203], v[204:205]
    v_pk_add_f32 v[208:209], v[208:209], v[210:211]
    v_pk_add_f32 v[214:215], v[214:215], v[216:217]
    v_cvt_pk_bf16_f32 v196, 0, v196
    v_cvt_pk_bf16_f32 v197, 0, v197
    v_cvt_pk_bf16_f32 v202, 0, v202
    v_cvt_pk_bf16_f32 v203, 0, v203
    v_cvt_pk_bf16_f32 v208, 0, v208
    v_cvt_pk_bf16_f32 v209, 0, v209
    v_cvt_pk_bf16_f32 v214, 0, v214
    v_cvt_pk_bf16_f32 v215, 0, v215
    v_pk_mul_f32 v[198:199], v[178:179], v[156:157]
    v_pk_mul_f32 v[204:205], v[180:181], v[156:157]
    v_pk_mul_f32 v[210:211], v[182:183], v[156:157]
    v_pk_mul_f32 v[216:217], v[184:185], v[156:157]
    v_cvt_pk_bf16_f32 v198, 0, v198
    v_cvt_pk_bf16_f32 v199, 0, v199
    v_cvt_pk_bf16_f32 v204, 0, v204
    v_cvt_pk_bf16_f32 v205, 0, v205
    v_cvt_pk_bf16_f32 v210, 0, v210
    v_cvt_pk_bf16_f32 v211, 0, v211
    v_cvt_pk_bf16_f32 v216, 0, v216
    v_cvt_pk_bf16_f32 v217, 0, v217
    v_pk_add_f32 v[196:197], v[196:197], v[198:199]
    v_pk_add_f32 v[202:203], v[202:203], v[204:205]
    v_pk_add_f32 v[208:209], v[208:209], v[210:211]
    v_pk_add_f32 v[214:215], v[214:215], v[216:217]
    v_cvt_pk_bf16_f32 v196, 0, v196
    v_cvt_pk_bf16_f32 v197, 0, v197
    v_cvt_pk_bf16_f32 v202, 0, v202
    v_cvt_pk_bf16_f32 v203, 0, v203
    v_cvt_pk_bf16_f32 v208, 0, v208
    v_cvt_pk_bf16_f32 v209, 0, v209
    v_cvt_pk_bf16_f32 v214, 0, v214
    v_cvt_pk_bf16_f32 v215, 0, v215
    v_and_b32 v199, s101, v146
    v_lshlrev_b32 v198, 16, v146
    v_pk_mul_f32 v[196:197], v[196:197], v[198:199]
    v_cvt_pk_bf16_f32 v190, v196, v197
    v_and_b32 v205, s101, v147
    v_lshlrev_b32 v204, 16, v147
    v_pk_mul_f32 v[202:203], v[202:203], v[204:205]
    v_cvt_pk_bf16_f32 v191, v202, v203
    v_and_b32 v211, s101, v148
    v_lshlrev_b32 v210, 16, v148
    v_pk_mul_f32 v[208:209], v[208:209], v[210:211]
    v_cvt_pk_bf16_f32 v192, v208, v209
    v_and_b32 v217, s101, v149
    v_lshlrev_b32 v216, 16, v149
    v_pk_mul_f32 v[214:215], v[214:215], v[216:217]
    v_cvt_pk_bf16_f32 v193, v214, v215
    v_perm_b32 v96, v192, v193, s100
    v_perm_b32 v100, v192, v193, s99
    v_perm_b32 v97, v190, v191, s100
    v_perm_b32 v101, v190, v191, s99
    v_perm_b32 v98, v188, v189, s100
    v_perm_b32 v102, v188, v189, s99
    v_perm_b32 v99, v186, v187, s100
    v_perm_b32 v103, v186, v187, s99
    buffer_store_dwordx4 v[96:99], v129, s[40:43], s65 offen
    buffer_store_dwordx4 v[100:103], v128, s[40:43], s65 offen
    v_lshlrev_b32 v78, 3, v1
    v_and_b32 v79, 0xff, v78
    v_or_b32 v252, s66, v30
    v_mov_b32 v253, v31
    s_waitcnt vmcnt(6)
    v_accvgpr_read_b32 v160, a228
    v_accvgpr_read_b32 v161, a229
    v_accvgpr_read_b32 v162, a230
    v_accvgpr_read_b32 v163, a231
    v_accvgpr_read_b32 v164, a240
    v_lshlrev_b32 v178, 16, v160
    v_alignbit_b32 v160, v161, v160, 16
    v_alignbit_b32 v161, v162, v161, 16
    v_alignbit_b32 v162, v163, v162, 16
    v_alignbit_b32 v163, v164, v163, 16
    v_accvgpr_read_b32 v166, a232
    v_accvgpr_read_b32 v167, a233
    v_accvgpr_read_b32 v168, a234
    v_accvgpr_read_b32 v169, a235
    v_accvgpr_read_b32 v170, a241
    v_lshlrev_b32 v179, 16, v166
    v_alignbit_b32 v166, v167, v166, 16
    v_alignbit_b32 v167, v168, v167, 16
    v_alignbit_b32 v168, v169, v168, 16
    v_alignbit_b32 v169, v170, v169, 16
    v_accvgpr_read_b32 v172, a236
    v_accvgpr_read_b32 v173, a237
    v_accvgpr_read_b32 v174, a238
    v_accvgpr_read_b32 v175, a239
    v_accvgpr_read_b32 v176, a242
    v_lshlrev_b32 v180, 16, v172
    v_alignbit_b32 v172, v173, v172, 16
    v_alignbit_b32 v173, v174, v173, 16
    v_alignbit_b32 v174, v175, v174, 16
    v_alignbit_b32 v175, v176, v175, 16
    v_add_u32 v64, 124416, v13
    ds_write_b128 v64, a[228:231] offset:32
    ds_write_b128 v64, v[160:163] offset:4192
    ds_write_b128 v64, a[232:235] offset:12928
    ds_write_b128 v64, v[166:169] offset:17088
    ds_write_b128 v64, a[236:239] offset:25824
    ds_write_b128 v64, v[172:175] offset:29984
    v_mov_b32 v240, 0
    v_mov_b32 v241, 0
    v_mov_b32 v242, 0
    v_cmp_eq_u32 vcc, 0, v0
    s_nop 0
    s_and_saveexec_b64 s[8:9], vcc
    v_mov_b32 v243, v178
    ds_write_b128 v64, v[240:243] offset:4176
    v_mov_b32 v243, v179
    ds_write_b128 v64, v[240:243] offset:17072
    v_mov_b32 v243, v180
    ds_write_b128 v64, v[240:243] offset:29968
    s_mov_b64 exec, s[8:9]
    s_waitcnt vmcnt(3)
    v_and_b32 v217, s101, v44
    v_lshlrev_b32 v216, 16, v44
    v_and_b32 v219, s101, v45
    v_lshlrev_b32 v218, 16, v45
    v_and_b32 v221, s101, v46
    v_lshlrev_b32 v220, 16, v46
    v_and_b32 v223, s101, v47
    v_lshlrev_b32 v222, 16, v47
    v_and_b32 v225, s101, v48
    v_lshlrev_b32 v224, 16, v48
    v_and_b32 v227, s101, v49
    v_lshlrev_b32 v226, 16, v49
    v_and_b32 v229, s101, v50
    v_lshlrev_b32 v228, 16, v50
    v_and_b32 v231, s101, v51
    v_lshlrev_b32 v230, 16, v51
    v_and_b32 v233, s101, v52
    v_lshlrev_b32 v232, 16, v52
    v_pk_mul_f32 v[240:241], v[216:217], v[216:217]
    v_pk_add_f32 v[238:239], v[216:217], v[218:219]
    v_pk_fma_f32 v[240:241], v[218:219], v[218:219], v[240:241]
    v_pk_add_f32 v[238:239], v[238:239], v[220:221]
    v_pk_fma_f32 v[240:241], v[220:221], v[220:221], v[240:241]
    v_pk_add_f32 v[238:239], v[238:239], v[222:223]
    v_pk_fma_f32 v[240:241], v[222:223], v[222:223], v[240:241]
    v_pk_add_f32 v[238:239], v[238:239], v[224:225]
    v_pk_fma_f32 v[240:241], v[224:225], v[224:225], v[240:241]
    v_pk_add_f32 v[238:239], v[238:239], v[226:227]
    v_pk_fma_f32 v[240:241], v[226:227], v[226:227], v[240:241]
    v_pk_add_f32 v[238:239], v[238:239], v[228:229]
    v_pk_fma_f32 v[240:241], v[228:229], v[228:229], v[240:241]
    v_pk_add_f32 v[238:239], v[238:239], v[230:231]
    v_pk_fma_f32 v[240:241], v[230:231], v[230:231], v[240:241]
    v_pk_add_f32 v[238:239], v[238:239], v[232:233]
    v_pk_fma_f32 v[240:241], v[232:233], v[232:233], v[240:241]
    v_add_f32 v238, v238, v239
    v_add_f32 v240, v240, v241
    s_nop 0
    v_add_f32_dpp v238, v238, v238 quad_perm:[1,0,3,2] row_mask:0xf bank_mask:0xf
    v_add_f32_dpp v240, v240, v240 quad_perm:[1,0,3,2] row_mask:0xf bank_mask:0xf
    s_nop 0
    v_add_f32_dpp v238, v238, v238 quad_perm:[2,3,0,1] row_mask:0xf bank_mask:0xf
    v_add_f32_dpp v240, v240, v240 quad_perm:[2,3,0,1] row_mask:0xf bank_mask:0xf
    s_nop 0
    v_add_f32_dpp v238, v238, v238 row_half_mirror row_mask:0xf bank_mask:0xf
    v_add_f32_dpp v240, v240, v240 row_half_mirror row_mask:0xf bank_mask:0xf
    s_nop 0
    v_add_f32_dpp v238, v238, v238 row_mirror row_mask:0xf bank_mask:0xf
    v_add_f32_dpp v240, v240, v240 row_mirror row_mask:0xf bank_mask:0xf
    v_mov_b32 v239, v238
    v_mov_b32 v241, v240
    s_nop 0
    v_permlane16_swap_b32 v238, v239
    v_permlane16_swap_b32 v240, v241
    v_add_f32 v238, v238, v239
    v_add_f32 v240, v240, v241
    v_mul_f32 v238, 0x3ae38e39, v238
    v_mul_f32 v240, 0x3ae38e39, v240
    v_fma_f32 v240, -v238, v238, v240
    v_max_f32 v240, 0, v240
    v_cvt_pk_bf16_f32 v242, v238, v240
    v_and_b32 v240, s101, v242
    v_lshlrev_b32 v238, 16, v242
    v_add_f32 v240, 0x3727c5ac, v240
    v_cvt_pk_bf16_f32 v242, v240, v240
    v_lshlrev_b32 v240, 16, v242
    v_sqrt_f32 v240, v240
    s_nop 0
    v_cvt_pk_bf16_f32 v242, v240, v240
    v_lshlrev_b32 v240, 16, v242
    v_rcp_f32 v236, v240
    v_sub_f32 v234, 0, v238
    v_sub_f32 v235, 0, v238
    v_fma_f32 v242, -v240, v236, 2.0
    v_mul_f32 v236, v236, v242
    v_mov_b32 v237, v236
    v_pk_add_f32 v[216:217], v[216:217], v[234:235]
    v_pk_add_f32 v[218:219], v[218:219], v[234:235]
    v_pk_add_f32 v[220:221], v[220:221], v[234:235]
    v_pk_add_f32 v[222:223], v[222:223], v[234:235]
    v_pk_add_f32 v[224:225], v[224:225], v[234:235]
    v_pk_add_f32 v[226:227], v[226:227], v[234:235]
    v_pk_add_f32 v[228:229], v[228:229], v[234:235]
    v_pk_add_f32 v[230:231], v[230:231], v[234:235]
    v_pk_add_f32 v[232:233], v[232:233], v[234:235]
    v_cvt_pk_bf16_f32 v216, 0, v216
    v_cvt_pk_bf16_f32 v217, 0, v217
    v_cvt_pk_bf16_f32 v218, 0, v218
    v_cvt_pk_bf16_f32 v219, 0, v219
    v_cvt_pk_bf16_f32 v220, 0, v220
    v_cvt_pk_bf16_f32 v221, 0, v221
    v_cvt_pk_bf16_f32 v222, 0, v222
    v_cvt_pk_bf16_f32 v223, 0, v223
    v_cvt_pk_bf16_f32 v224, 0, v224
    v_cvt_pk_bf16_f32 v225, 0, v225
    v_cvt_pk_bf16_f32 v226, 0, v226
    v_cvt_pk_bf16_f32 v227, 0, v227
    v_cvt_pk_bf16_f32 v228, 0, v228
    v_cvt_pk_bf16_f32 v229, 0, v229
    v_cvt_pk_bf16_f32 v230, 0, v230
    v_cvt_pk_bf16_f32 v231, 0, v231
    v_cvt_pk_bf16_f32 v232, 0, v232
    v_cvt_pk_bf16_f32 v233, 0, v233
    v_pk_mul_f32 v[216:217], v[216:217], v[236:237]
    v_pk_mul_f32 v[218:219], v[218:219], v[236:237]
    v_pk_mul_f32 v[220:221], v[220:221], v[236:237]
    v_pk_mul_f32 v[222:223], v[222:223], v[236:237]
    v_pk_mul_f32 v[224:225], v[224:225], v[236:237]
    v_pk_mul_f32 v[226:227], v[226:227], v[236:237]
    v_pk_mul_f32 v[228:229], v[228:229], v[236:237]
    v_pk_mul_f32 v[230:231], v[230:231], v[236:237]
    v_pk_mul_f32 v[232:233], v[232:233], v[236:237]
    v_cvt_pk_bf16_f32 v240, v216, v217
    v_cvt_pk_bf16_f32 v241, v218, v219
    v_cvt_pk_bf16_f32 v242, v220, v221
    v_cvt_pk_bf16_f32 v243, v222, v223
    v_cvt_pk_bf16_f32 v244, v224, v225
    v_cvt_pk_bf16_f32 v245, v226, v227
    v_cvt_pk_bf16_f32 v246, v228, v229
    v_cvt_pk_bf16_f32 v247, v230, v231
    v_cvt_pk_bf16_f32 v248, v232, v233
    v_add_u32 v64, -9344, v21
    v_add_u32 v65, -9344, v22
    ds_write_b128 v64, v[240:243]
    ds_write_b128 v64, v[244:247] offset:512
    ds_write_b32 v65, v248
    v_add_u32 v67, -9344, v23
    s_add_u32 s12, s84, 0x1582000
    s_add_u32 s11, s84, 0x15a0000
    s_and_b32 s13, s84, 0x700
    s_add_u32 s85, s13, 0x1582000
    s_and_b32 s83, s2, 7
    s_mul_i32 s83, s83, 4352
    s_add_u32 s83, s83, 0x15a0000
    s_mov_b32 s9, 8192
    s_mov_b32 s10, 16384
    s_waitcnt vmcnt(0)
L_bb1:
    s_cmp_lg_u32 s3, 3
    s_waitcnt vmcnt(1) lgkmcnt(0)
    s_barrier
    s_cbranch_scc1 L_nofl
    s_mov_b64 exec, 1
    buffer_store_dwordx2 v[252:253], off, s[40:43], s12
    s_mov_b64 exec, -1
    buffer_load_dwordx2 v[104:105], v79, s[40:43], s85 offen sc1
L_nofl:
    s_cmp_lg_u32 s3, 2
    s_cbranch_scc1 L_nofwi
    s_add_u32 s8, s83, 0x20000
    buffer_load_dwordx4 v[108:111], v15, s[40:43], s8 offen sc1
    buffer_load_dwordx4 v[112:115], v15, s[40:43], s8 offen offset:16 sc1
L_nofwi:
    ds_read_b128 v[80:83], v67
    ds_read_b128 v[84:87], v67 offset:512
    ds_read_b128 v[88:91], v67 offset:1024
    s_waitcnt lgkmcnt(2)
    buffer_store_dwordx4 v[80:83], v24, s[40:43], 0 offen
    s_waitcnt lgkmcnt(1)
    buffer_store_dwordx4 v[84:87], v24, s[40:43], s9 offen
    s_waitcnt lgkmcnt(0)
    buffer_store_dwordx4 v[88:91], v9, s[40:43], s10 offen
    s_cmp_lg_u32 s3, 0
    s_cbranch_scc1 L_nofu
    s_mov_b64 exec, 0xff
    buffer_store_dwordx2 v[252:253], v55, s[40:43], s11 offen sc1
    s_mov_b64 exec, -1
L_nofu:
    s_mul_i32 s59, s5, 124416
    s_add_u32 s59, s59, 0x1380000
    s_mov_b32 s48, 0
    s_mov_b32 s49, 0
    s_mul_i32 s10, s7, 9216
    s_add_u32 s50, s89, s10
    s_sub_u32 s51, 9216, s10
    s_add_u32 s51, s51, s89
    s_add_u32 s72, s56, 0
    s_sub_u32 s10, s72, 18432
    s_cmp_ge_u32 s72, 18432
    s_cselect_b32 s72, s10, s72
    s_add_u32 s73, s56, 4096
    s_sub_u32 s10, s73, 18432
    s_cmp_ge_u32 s73, 18432
    s_cselect_b32 s73, s10, s73
    s_add_u32 s74, s56, 8192
    s_sub_u32 s10, s74, 18432
    s_cmp_ge_u32 s74, 18432
    s_cselect_b32 s74, s10, s74
    s_add_u32 s75, s56, 13312
    s_sub_u32 s10, s75, 18432
    s_cmp_ge_u32 s75, 18432
    s_cselect_b32 s75, s10, s75
    s_add_u32 s77, s56, 10240
    s_sub_u32 s10, s77, 18432
    s_cmp_ge_u32 s77, 18432
    s_cselect_b32 s77, s10, s77
    s_add_u32 s77, s77, s68
    s_add_u32 s78, s56, 11264
    s_sub_u32 s10, s78, 18432
    s_cmp_ge_u32 s78, 18432
    s_cselect_b32 s78, s10, s78
    s_add_u32 s78, s78, s68
    s_add_u32 s79, s56, 12288
    s_sub_u32 s10, s79, 18432
    s_cmp_ge_u32 s79, 18432
    s_cselect_b32 s79, s10, s79
    s_add_u32 s79, s79, s68
    s_add_u32 s80, s56, 13312
    s_sub_u32 s10, s80, 18432
    s_cmp_ge_u32 s80, 18432
    s_cselect_b32 s80, s10, s80
    s_add_u32 s80, s80, s68
    s_add_u32 s81, s56, 14336
    s_sub_u32 s10, s81, 18432
    s_cmp_ge_u32 s81, 18432
    s_cselect_b32 s81, s10, s81
    s_add_u32 s81, s81, s68
    s_mov_b32 s60, 4096
    s_mov_b32 s61, 36864
    s_mov_b32 s62, 40960
    v_add_u32 v248, s72, v5
    v_add_u32 v249, s73, v5
    v_add_u32 v250, s74, v5
    v_add_u32 v251, s75, v5
    s_lshl_b32 s8, s3, 12
    s_add_u32 s8, s8, 124416
    v_add_u32 v116, s8, v27
    s_xor_b32 s8, s3, 1
    s_lshl_b32 s8, s8, 12
    s_add_u32 s8, s8, 124416
    v_add_u32 v118, s8, v27
    s_lshl_b32 s8, s3, 11
    s_add_u32 s8, s8, 140800
    v_add_u32 v117, s8, v27
    s_lshl_b32 s8, s6, 10
    s_add_u32 s8, s8, 140800
    v_add_u32 v119, s8, v27
    v_lshrrev_b32 v66, 1, v4
    v_lshlrev_b32 v64, 4, v66
    v_lshlrev_b32 v65, 5, v3
    v_lshl_add_u32 v65, v66, 4, v65
    v_and_b32 v66, 1, v4
    v_lshl_add_u32 v65, v66, 3, v65
    v_readlane_b32 s10, v62, s7
    v_readlane_b32 s12, v62, 2
    s_lshl_b32 s10, s10, 16
    s_mov_b32 s11, s10
    s_lshl_b32 s12, s12, 16
    s_mov_b32 s13, s12
    s_add_u32 s14, s87, s7
    s_lshl_b32 s14, s14, 12
    s_lshl_b32 s15, s6, 11
    s_add_u32 s14, s14, s15
    s_add_u32 s14, s14, 0x1040000
    s_sub_u32 s8, 7, s71
    s_cmp_eq_u32 s6, 0
    s_cselect_b32 s8, s71, s8
    s_lshl_b32 s15, s88, 12
    s_lshl_b32 s8, s8, 9
    s_add_u32 s15, s15, s8
    s_add_u32 s15, s15, 0x1040000
    s_lshl_b32 s58, s3, 12
    s_add_u32 s59, s59, s58
    s_lshl_b32 s76, s4, 9
    s_add_u32 s76, s76, 0x1584000
    v_mov_b32 v66, 163824
    s_add_u32 s9, s64, 0x1584000
    s_cmp_eq_u32 s3, 0
    s_cbranch_scc1 L_f1w
    s_waitcnt vmcnt(0)
L_f1w:
    s_waitcnt vmcnt(1)
    s_mov_b64 exec, 1
    buffer_store_dwordx2 v[30:31], off, s[40:43], s9
    s_mov_b64 exec, -1
    s_cmp_eq_u32 s3, 3
    s_cbranch_scc1 L_w3
    s_cmp_lg_u32 s3, 2
    s_cbranch_scc1 L_x1
    s_mov_b32 s93, 0
    s_branch L_fw2
L_fw:
    s_sleep 4
    s_add_u32 s8, s83, 0x20000
    buffer_load_dwordx4 v[108:111], v15, s[40:43], s8 offen sc1
    buffer_load_dwordx4 v[112:115], v15, s[40:43], s8 offen offset:16 sc1
    s_waitcnt vmcnt(0)
L_fw2:
    v_xor_b32 v108, v30, v108
    v_xor_b32 v109, v31, v109
    v_xor_b32 v110, v30, v110
    v_xor_b32 v111, v31, v111
    v_xor_b32 v112, v30, v112
    v_xor_b32 v113, v31, v113
    v_xor_b32 v114, v30, v114
    v_xor_b32 v115, v31, v115
    v_or3_b32 v92, v108, v110, v112
    v_or3_b32 v93, v109, v111, v113
    v_or_b32 v92, v92, v114
    v_lshrrev_b32 v92, 4, v92
    v_or3_b32 v92, v92, v93, v115
    v_cmp_ne_u32 vcc, 0, v92
    s_nop 0
    s_cmp_eq_u64 vcc, 0
    s_cbranch_scc1 L_fwd
    s_add_u32 s93, s93, 1
    s_cmp_lt_u32 s93, 30000
    s_cbranch_scc1 L_fw
L_fwd:
    v_mov_b32 v67, 1
    ds_write_b32 v66, v67 offset:4
    s_branch L_x1
L_w3:
    s_mov_b32 s93, 0
    s_branch L_fl2
L_fl:
    s_waitcnt vmcnt(0)
L_fl2:
    v_cmp_ne_u64 vcc, v[252:253], v[104:105]
    s_nop 0
    s_cmp_eq_u64 vcc, 0
    s_cbranch_scc1 L_fl_ok
    buffer_load_dwordx2 v[104:105], v79, s[40:43], s85 offen sc1
    s_add_u32 s93, s93, 1
    s_cmp_lt_u32 s93, 40
    s_cbranch_scc1 L_fl
    s_and_b32 s85, s84, 0x700
    s_add_u32 s85, s85, s83
    s_mov_b32 s93, 0
L_fs:
    buffer_load_dwordx2 v[104:105], v79, s[40:43], s85 offen sc1
    s_waitcnt vmcnt(0)
    v_xor_b32 v104, v30, v104
    v_xor_b32 v105, v31, v105
    v_lshrrev_b32 v106, 4, v104
    v_or_b32 v106, v106, v105
    v_cmp_ne_u32 vcc, 0, v106
    s_nop 0
    s_cmp_eq_u64 vcc, 0
    s_cbranch_scc1 L_fs_ok
    s_sleep 8
    s_add_u32 s93, s93, 1
    s_cmp_lt_u32 s93, 30000
    s_cbranch_scc1 L_fs
L_fs_ok:
    v_cmp_ne_u32 vcc, s66, v104
    s_nop 0
    s_cmp_eq_u64 vcc, 0
L_fl_ok:
    s_cselect_b32 s67, 1, 0
    v_mov_b32 v67, s67
    s_cmp_lg_u32 s67, 0
    s_cbranch_scc1 L_w3l
    ds_write_b32 v66, v67
    s_branch L_x1
L_w3l:
    s_lshl_b32 s82, s87, 12
    s_add_u32 s82, s82, s65
    s_mov_b32 m0, 132736
    s_nop 0
    buffer_load_dwordx4 v27, s[40:43], s82 offen offset:0 sc1 lds
    buffer_load_dwordx4 v27, s[40:43], s82 offen offset:1024 sc1 lds
    buffer_load_dwordx4 v27, s[40:43], s82 offen offset:2048 sc1 lds
    buffer_load_dwordx4 v27, s[40:43], s82 offen offset:3072 sc1 lds
    s_add_u32 s82, s82, 4096
    s_mov_b32 m0, 145632
    s_nop 0
    buffer_load_dwordx4 v27, s[40:43], s82 offen offset:0 sc1 lds
    buffer_load_dwordx4 v27, s[40:43], s82 offen offset:1024 sc1 lds
    buffer_load_dwordx4 v27, s[40:43], s82 offen offset:2048 sc1 lds
    buffer_load_dwordx4 v27, s[40:43], s82 offen offset:3072 sc1 lds
    s_lshl_b32 s82, s88, 12
    s_add_u32 s82, s82, s65
    s_mov_b32 m0, 158528
    s_nop 0
    buffer_load_dwordx4 v27, s[40:43], s82 offen offset:0 sc1 lds
    buffer_load_dwordx4 v27, s[40:43], s82 offen offset:1024 sc1 lds
    buffer_load_dwordx4 v27, s[40:43], s82 offen offset:2048 sc1 lds
    buffer_load_dwordx4 v27, s[40:43], s82 offen offset:3072 sc1 lds
    buffer_load_dwordx2 v[104:105], v78, s[40:43], s76 offen sc1
    ds_write_b32 v66, v67
    s_waitcnt vmcnt(0)
    v_cmp_ne_u64 vcc, v[30:31], v[104:105]
    s_nop 0
    s_cmp_eq_u64 vcc, 0
    s_cbranch_scc1 L_pd2
    s_mov_b32 s93, 0
    s_nop 1
L_pl1:
    s_sleep 1
    buffer_load_dwordx2 v[104:105], v78, s[40:43], s76 offen sc1
    s_waitcnt vmcnt(0)
    v_cmp_ne_u64 vcc, v[30:31], v[104:105]
    s_nop 0
    s_cmp_eq_u64 vcc, 0
    s_cbranch_scc1 L_pd2
    s_add_u32 s93, s93, 1
    s_cmp_lt_u32 s93, 30000
    s_cbranch_scc1 L_pl1
L_pd2:
    s_nop 0
L_x1:
    ds_read_b64 v[92:93], v66
    s_waitcnt lgkmcnt(0)
    v_readfirstlane_b32 s67, v92
    v_readfirstlane_b32 s8, v93
    s_nop 0
    s_or_b32 s8, s8, s67
    s_cmp_eq_u32 s8, -1
    s_cbranch_scc1 L_x1
    s_add_u32 m0, s58, 0
    s_add_u32 s85, s59, 0
    buffer_load_dwordx4 v27, s[40:43], s85 offen offset:0 lds
    buffer_load_dwordx4 v27, s[40:43], s85 offen offset:1024 lds
    buffer_load_dwordx4 v27, s[40:43], s85 offen offset:2048 lds
    buffer_load_dwordx4 v27, s[40:43], s85 offen offset:3072 lds
    s_add_u32 m0, s58, 16384
    s_add_u32 s85, s59, 16384
    buffer_load_dwordx4 v27, s[40:43], s85 offen offset:0 lds
    buffer_load_dwordx4 v27, s[40:43], s85 offen offset:1024 lds
    buffer_load_dwordx4 v27, s[40:43], s85 offen offset:2048 lds
    buffer_load_dwordx4 v27, s[40:43], s85 offen offset:3072 lds
    s_barrier
    s_cmp_lg_u32 s67, 0
    s_cbranch_scc1 L_loc
    s_mov_b32 s65, 0x1800000
    buffer_store_dwordx4 v[96:99], v129, s[40:43], s65 offen sc1
    buffer_store_dwordx4 v[100:103], v128, s[40:43], s65 offen sc1
    buffer_store_dword v107, v124, s[40:43], s65 offen sc1
    s_mov_b32 s9, 0x2000000
    buffer_store_dwordx4 v[80:83], v24, s[40:43], s9 offen sc1
    s_mov_b32 s9, 0x2002000
    buffer_store_dwordx4 v[84:87], v24, s[40:43], s9 offen sc1
    s_mov_b32 s9, 0x2004000
    buffer_store_dwordx4 v[88:91], v9, s[40:43], s9 offen sc1
    s_mov_b32 s48, 0x2000000
    s_mov_b32 s60, 0x2001000
    s_mov_b32 s61, 0x2009000
    s_mov_b32 s62, 0x200a000
    s_waitcnt vmcnt(0)
    s_barrier
    s_cmp_lg_u32 s3, 3
    s_cbranch_scc1 L_nofg
    s_add_u32 s9, s84, 0x158a000
    s_mov_b64 exec, 1
    buffer_store_dwordx2 v[30:31], off, s[40:43], s9 sc1
    s_mov_b64 exec, -1
    s_and_b32 s85, s84, 0x700
    s_add_u32 s85, s85, 0x158a000
    s_sleep 16
    buffer_load_dwordx2 v[104:105], v79, s[40:43], s85 offen sc1
    s_waitcnt vmcnt(0)
    v_cmp_ne_u64 vcc, v[30:31], v[104:105]
    s_nop 0
    s_cmp_eq_u64 vcc, 0
    s_cbranch_scc1 L_pd4
    s_mov_b32 s93, 0
    s_nop 1
L_pl3:
    s_sleep 8
    buffer_load_dwordx2 v[104:105], v79, s[40:43], s85 offen sc1
    s_waitcnt vmcnt(0)
    v_cmp_ne_u64 vcc, v[30:31], v[104:105]
    s_nop 0
    s_cmp_eq_u64 vcc, 0
    s_cbranch_scc1 L_pd4
    s_add_u32 s93, s93, 1
    s_cmp_lt_u32 s93, 30000
    s_cbranch_scc1 L_pl3
L_pd4:
    s_nop 0
    s_lshl_b32 s82, s87, 12
    s_add_u32 s82, s82, s65
    s_mov_b32 m0, 132736
    s_nop 0
    buffer_load_dwordx4 v27, s[40:43], s82 offen offset:0 sc1 lds
    buffer_load_dwordx4 v27, s[40:43], s82 offen offset:1024 sc1 lds
    buffer_load_dwordx4 v27, s[40:43], s82 offen offset:2048 sc1 lds
    buffer_load_dwordx4 v27, s[40:43], s82 offen offset:3072 sc1 lds
    s_add_u32 s82, s82, 4096
    s_mov_b32 m0, 145632
    s_nop 0
    buffer_load_dwordx4 v27, s[40:43], s82 offen offset:0 sc1 lds
    buffer_load_dwordx4 v27, s[40:43], s82 offen offset:1024 sc1 lds
    buffer_load_dwordx4 v27, s[40:43], s82 offen offset:2048 sc1 lds
    buffer_load_dwordx4 v27, s[40:43], s82 offen offset:3072 sc1 lds
    s_lshl_b32 s82, s88, 12
    s_add_u32 s82, s82, s65
    s_mov_b32 m0, 158528
    s_nop 0
    buffer_load_dwordx4 v27, s[40:43], s82 offen offset:0 sc1 lds
    buffer_load_dwordx4 v27, s[40:43], s82 offen offset:1024 sc1 lds
    buffer_load_dwordx4 v27, s[40:43], s82 offen offset:2048 sc1 lds
    buffer_load_dwordx4 v27, s[40:43], s82 offen offset:3072 sc1 lds
    s_waitcnt vmcnt(0)
L_nofg:
    s_barrier
L_loc:
    ds_read2_b32 v[120:121], v68 offset0:0 offset1:1
    ds_read2_b32 v[122:123], v68 offset0:2 offset1:3
    ds_read_b128 v[180:183], v72 offset:3584
    ds_read2_b32 v[124:125], v68 offset0:128 offset1:129
    ds_read2_b32 v[126:127], v68 offset0:130 offset1:131
    ds_read_b128 v[176:179], v72 offset:3072
    ds_read2_b32 v[128:129], v69 offset0:0 offset1:1
    ds_read2_b32 v[130:131], v69 offset0:2 offset1:3
    ds_read_b128 v[172:175], v72 offset:2560
    ds_read2_b32 v[132:133], v69 offset0:128 offset1:129
    ds_read2_b32 v[134:135], v69 offset0:130 offset1:131
    ds_read_b128 v[168:171], v72 offset:2048
    ds_read2_b32 v[136:137], v70 offset0:0 offset1:1
    ds_read2_b32 v[138:139], v70 offset0:2 offset1:3
    ds_read_b128 v[164:167], v72 offset:1536
    s_waitcnt lgkmcnt(12)
    v_mfma_f32_16x16x32_bf16 a[180:183], v[120:123], v[180:183], 0
    ds_read2_b32 v[140:141], v70 offset0:128 offset1:129
    s_cmp_eq_u32 s70, 0
    s_cbranch_scc1 L_noxh
    v_mov_b32 v92, -1
    v_mov_b32 v93, -1
    v_mov_b32 v94, -1
    v_mov_b32 v95, -1
    s_add_u32 s9, s69, 0x90000
    buffer_store_dwordx4 v[80:83], v24, s[40:43], s9 offen sc1
    s_add_u32 s9, s69, 0x92000
    buffer_store_dwordx4 v[84:87], v24, s[40:43], s9 offen sc1
    s_add_u32 s9, s69, 0x94000
    buffer_store_dwordx4 v[88:91], v9, s[40:43], s9 offen sc1
    s_add_u32 s9, s69, 0x0
    buffer_store_dwordx4 v[92:95], v24, s[40:43], s9 offen sc1
    s_add_u32 s9, s69, 0x2000
    buffer_store_dwordx4 v[92:95], v24, s[40:43], s9 offen sc1
    s_add_u32 s9, s69, 0x4000
    buffer_store_dwordx4 v[92:95], v9, s[40:43], s9 offen sc1
L_noxh:
    s_waitcnt lgkmcnt(10)
    v_mfma_f32_16x16x32_bf16 a[184:187], v[120:123], v[176:179], 0
    ds_read2_b32 v[142:143], v70 offset0:130 offset1:131
    s_add_u32 m0, s58, 32768
    s_add_u32 s85, s59, 32768
    v_mfma_f32_16x16x32_bf16 a[188:191], v[124:127], v[176:179], 0
    ds_read_b128 v[160:163], v72 offset:1024
    v_mfma_f32_16x16x32_bf16 a[184:187], v[124:127], v[180:183], a[184:187]
    ds_read2_b32 v[144:145], v71 offset0:0 offset1:1
    s_waitcnt lgkmcnt(10)
    v_mfma_f32_16x16x32_bf16 a[188:191], v[120:123], v[172:175], a[188:191]
    ds_read2_b32 v[146:147], v71 offset0:2 offset1:3
    buffer_load_dwordx4 v27, s[40:43], s85 offen offset:0 lds
    v_mfma_f32_16x16x32_bf16 a[192:195], v[124:127], v[172:175], 0
    ds_read_b128 v[156:159], v72 offset:512
    v_mfma_f32_16x16x32_bf16 a[188:191], v[128:131], v[180:183], a[188:191]
    ds_read2_b32 v[148:149], v71 offset0:128 offset1:129
    v_mfma_f32_16x16x32_bf16 a[192:195], v[128:131], v[176:179], a[192:195]
    ds_read2_b32 v[150:151], v71 offset0:130 offset1:131
    v_mfma_f32_16x16x32_bf16 a[196:199], v[128:131], v[172:175], 0
    ds_read_b128 v[152:155], v72 offset:0
    buffer_load_dwordx4 v27, s[40:43], s85 offen offset:1024 lds
    s_waitcnt lgkmcnt(12)
    v_mfma_f32_16x16x32_bf16 a[192:195], v[120:123], v[168:171], a[192:195]
    ds_read2_b32 v[184:185], v68 offset0:32 offset1:33
    v_mfma_f32_16x16x32_bf16 a[196:199], v[124:127], v[168:171], a[196:199]
    ds_read2_b32 v[186:187], v68 offset0:34 offset1:35
    v_mfma_f32_16x16x32_bf16 a[192:195], v[132:135], v[180:183], a[192:195]
    ds_read_b128 v[244:247], v72 offset:3712
    v_mfma_f32_16x16x32_bf16 a[196:199], v[132:135], v[176:179], a[196:199]
    ds_read2_b32 v[188:189], v68 offset0:160 offset1:161
    buffer_load_dwordx4 v27, s[40:43], s85 offen offset:2048 lds
    v_mfma_f32_16x16x32_bf16 a[200:203], v[128:131], v[168:171], 0
    ds_read2_b32 v[190:191], v68 offset0:162 offset1:163
    v_mfma_f32_16x16x32_bf16 a[204:207], v[132:135], v[168:171], 0
    ds_read_b128 v[240:243], v72 offset:3200
    v_mfma_f32_16x16x32_bf16 a[200:203], v[132:135], v[172:175], a[200:203]
    ds_read2_b32 v[192:193], v69 offset0:32 offset1:33
    s_waitcnt lgkmcnt(15)
    v_mfma_f32_16x16x32_bf16 a[196:199], v[120:123], v[164:167], a[196:199]
    ds_read2_b32 v[194:195], v69 offset0:34 offset1:35
    buffer_load_dwordx4 v27, s[40:43], s85 offen offset:3072 lds
    v_mfma_f32_16x16x32_bf16 a[200:203], v[124:127], v[164:167], a[200:203]
    ds_read_b128 v[236:239], v72 offset:2688
    s_add_u32 m0, s58, 49152
    s_add_u32 s85, s59, 49152
    v_mfma_f32_16x16x32_bf16 a[196:199], v[136:139], v[180:183], a[196:199]
    ds_read2_b32 v[196:197], v69 offset0:160 offset1:161
    v_mfma_f32_16x16x32_bf16 a[200:203], v[136:139], v[176:179], a[200:203]
    ds_read2_b32 v[198:199], v69 offset0:162 offset1:163
    v_mfma_f32_16x16x32_bf16 a[204:207], v[128:131], v[164:167], a[204:207]
    ds_read_b128 v[232:235], v72 offset:2176
    buffer_load_dwordx4 v27, s[40:43], s85 offen offset:0 lds
    v_mfma_f32_16x16x32_bf16 a[208:211], v[132:135], v[164:167], 0
    ds_read2_b32 v[200:201], v70 offset0:32 offset1:33
    v_mfma_f32_16x16x32_bf16 a[204:207], v[136:139], v[172:175], a[204:207]
    ds_read2_b32 v[202:203], v70 offset0:34 offset1:35
    v_mfma_f32_16x16x32_bf16 a[208:211], v[136:139], v[168:171], a[208:211]
    ds_read_b128 v[228:231], v72 offset:1664
    s_waitcnt lgkmcnt(15)
    v_mfma_f32_16x16x32_bf16 a[200:203], v[120:123], v[160:163], a[200:203]
    ds_read2_b32 v[204:205], v70 offset0:160 offset1:161
    buffer_load_dwordx4 v27, s[40:43], s85 offen offset:1024 lds
    v_mfma_f32_16x16x32_bf16 a[204:207], v[124:127], v[160:163], a[204:207]
    ds_read2_b32 v[206:207], v70 offset0:162 offset1:163
    v_mfma_f32_16x16x32_bf16 a[200:203], v[140:143], v[180:183], a[200:203]
    ds_read_b128 v[224:227], v72 offset:1152
    v_mfma_f32_16x16x32_bf16 a[204:207], v[140:143], v[176:179], a[204:207]
    ds_read2_b32 v[208:209], v71 offset0:32 offset1:33
    v_mfma_f32_16x16x32_bf16 a[208:211], v[128:131], v[160:163], a[208:211]
    ds_read2_b32 v[210:211], v71 offset0:34 offset1:35
    buffer_load_dwordx4 v27, s[40:43], s85 offen offset:2048 lds
    v_mfma_f32_16x16x32_bf16 a[204:207], v[120:123], v[156:159], a[204:207]
    ds_read_b128 v[220:223], v72 offset:640
    v_mfma_f32_16x16x32_bf16 a[208:211], v[140:143], v[172:175], a[208:211]
    ds_read2_b32 v[212:213], v71 offset0:160 offset1:161
    v_mfma_f32_16x16x32_bf16 a[204:207], v[144:147], v[180:183], a[204:207]
    ds_read2_b32 v[214:215], v71 offset0:162 offset1:163
    v_mfma_f32_16x16x32_bf16 a[208:211], v[124:127], v[156:159], a[208:211]
    ds_read_b128 v[216:219], v72 offset:128
    buffer_load_dwordx4 v27, s[40:43], s85 offen offset:3072 lds
    v_mfma_f32_16x16x32_bf16 a[208:211], v[144:147], v[176:179], a[208:211]
    ds_read_b128 v[96:99], v59 offset:1536
    s_add_u32 m0, s58, 65536
    s_add_u32 s85, s59, 65536
    v_mfma_f32_16x16x32_bf16 a[208:211], v[120:123], v[152:155], a[208:211]
    ds_read_b128 v[100:103], v59 offset:1024
    v_mfma_f32_16x16x32_bf16 a[208:211], v[148:151], v[180:183], a[208:211]
    ds_read_b128 v[104:107], v59 offset:512
    s_waitcnt lgkmcnt(15)
    v_mfma_f32_16x16x32_bf16 a[180:183], v[184:187], v[244:247], a[180:183]
    ds_read2_b32 v[120:121], v68 offset0:64 offset1:65
    buffer_load_dwordx4 v27, s[40:43], s85 offen offset:0 lds
    v_mfma_f32_16x16x32_bf16 a[184:187], v[184:187], v[240:243], a[184:187]
    ds_read2_b32 v[122:123], v68 offset0:66 offset1:67
    v_mfma_f32_16x16x32_bf16 a[188:191], v[188:191], v[240:243], a[188:191]
    ds_read_b128 v[180:183], v72 offset:3840
    v_mfma_f32_16x16x32_bf16 a[184:187], v[188:191], v[244:247], a[184:187]
    ds_read2_b32 v[124:125], v68 offset0:192 offset1:193
    v_mfma_f32_16x16x32_bf16 a[188:191], v[184:187], v[236:239], a[188:191]
    ds_read2_b32 v[126:127], v68 offset0:194 offset1:195
    buffer_load_dwordx4 v27, s[40:43], s85 offen offset:1024 lds
    v_mfma_f32_16x16x32_bf16 a[192:195], v[188:191], v[236:239], a[192:195]
    ds_read_b128 v[176:179], v72 offset:3328
    v_mfma_f32_16x16x32_bf16 a[188:191], v[192:195], v[244:247], a[188:191]
    ds_read2_b32 v[128:129], v69 offset0:64 offset1:65
    v_mfma_f32_16x16x32_bf16 a[192:195], v[192:195], v[240:243], a[192:195]
    ds_read2_b32 v[130:131], v69 offset0:66 offset1:67
    v_mfma_f32_16x16x32_bf16 a[196:199], v[192:195], v[236:239], a[196:199]
    ds_read_b128 v[172:175], v72 offset:2816
    buffer_load_dwordx4 v27, s[40:43], s85 offen offset:2048 lds
    v_mfma_f32_16x16x32_bf16 a[192:195], v[184:187], v[232:235], a[192:195]
    ds_read2_b32 v[132:133], v69 offset0:192 offset1:193
    v_mfma_f32_16x16x32_bf16 a[196:199], v[188:191], v[232:235], a[196:199]
    ds_read2_b32 v[134:135], v69 offset0:194 offset1:195
    v_mfma_f32_16x16x32_bf16 a[192:195], v[196:199], v[244:247], a[192:195]
    ds_read_b128 v[168:171], v72 offset:2304
    v_mfma_f32_16x16x32_bf16 a[196:199], v[196:199], v[240:243], a[196:199]
    ds_read2_b32 v[136:137], v70 offset0:64 offset1:65
    buffer_load_dwordx4 v27, s[40:43], s85 offen offset:3072 lds
    v_mfma_f32_16x16x32_bf16 a[200:203], v[192:195], v[232:235], a[200:203]
    ds_read2_b32 v[138:139], v70 offset0:66 offset1:67
    s_add_u32 m0, s58, 81920
    s_add_u32 s85, s59, 81920
    v_mfma_f32_16x16x32_bf16 a[204:207], v[196:199], v[232:235], a[204:207]
    ds_read_b128 v[164:167], v72 offset:1792
    v_mfma_f32_16x16x32_bf16 a[200:203], v[196:199], v[236:239], a[200:203]
    ds_read2_b32 v[140:141], v70 offset0:192 offset1:193
    s_waitcnt lgkmcnt(15)
    v_mfma_f32_16x16x32_bf16 a[196:199], v[184:187], v[228:231], a[196:199]
    ds_read2_b32 v[142:143], v70 offset0:194 offset1:195
    buffer_load_dwordx4 v27, s[40:43], s85 offen offset:0 lds
    v_mfma_f32_16x16x32_bf16 a[200:203], v[188:191], v[228:231], a[200:203]
    ds_read_b128 v[160:163], v72 offset:1280
    v_mfma_f32_16x16x32_bf16 a[196:199], v[200:203], v[244:247], a[196:199]
    ds_read2_b32 v[144:145], v71 offset0:64 offset1:65
    v_mfma_f32_16x16x32_bf16 a[200:203], v[200:203], v[240:243], a[200:203]
    ds_read2_b32 v[146:147], v71 offset0:66 offset1:67
    v_mfma_f32_16x16x32_bf16 a[204:207], v[192:195], v[228:231], a[204:207]
    ds_read_b128 v[156:159], v72 offset:768
    buffer_load_dwordx4 v27, s[40:43], s85 offen offset:1024 lds
    v_mfma_f32_16x16x32_bf16 a[208:211], v[196:199], v[228:231], a[208:211]
    ds_read2_b32 v[148:149], v71 offset0:192 offset1:193
    v_mfma_f32_16x16x32_bf16 a[204:207], v[200:203], v[236:239], a[204:207]
    ds_read2_b32 v[150:151], v71 offset0:194 offset1:195
    v_mfma_f32_16x16x32_bf16 a[208:211], v[200:203], v[232:235], a[208:211]
    ds_read_b128 v[152:155], v72 offset:256
    v_mfma_f32_16x16x32_bf16 a[200:203], v[184:187], v[224:227], a[200:203]
    ds_read2_b32 a[120:121], v73 offset0:0 offset1:1
    buffer_load_dwordx4 v27, s[40:43], s85 offen offset:2048 lds
    v_mfma_f32_16x16x32_bf16 a[204:207], v[188:191], v[224:227], a[204:207]
    ds_read2_b32 a[122:123], v73 offset0:2 offset1:3
    v_mfma_f32_16x16x32_bf16 a[200:203], v[204:207], v[244:247], a[200:203]
    ds_read2_b32 a[124:125], v73 offset0:128 offset1:129
    v_mfma_f32_16x16x32_bf16 a[204:207], v[204:207], v[240:243], a[204:207]
    ds_read2_b32 a[126:127], v73 offset0:130 offset1:131
    v_mfma_f32_16x16x32_bf16 a[208:211], v[192:195], v[224:227], a[208:211]
    ds_read2_b32 a[128:129], v75 offset0:0 offset1:1
    buffer_load_dwordx4 v27, s[40:43], s85 offen offset:3072 lds
    v_mfma_f32_16x16x32_bf16 a[204:207], v[184:187], v[220:223], a[204:207]
    ds_read2_b32 a[130:131], v75 offset0:2 offset1:3
    s_add_u32 m0, s58, 98304
    s_add_u32 s85, s59, 98304
    v_mfma_f32_16x16x32_bf16 a[208:211], v[204:207], v[236:239], a[208:211]
    ds_read2_b32 a[132:133], v75 offset0:128 offset1:129
    v_mfma_f32_16x16x32_bf16 a[204:207], v[208:211], v[244:247], a[204:207]
    ds_read2_b32 a[134:135], v75 offset0:130 offset1:131
    v_mfma_f32_16x16x32_bf16 a[208:211], v[188:191], v[220:223], a[208:211]
    ds_read2_b32 a[136:137], v76 offset0:0 offset1:1
    buffer_load_dwordx4 v27, s[40:43], s85 offen offset:0 lds
    v_mfma_f32_16x16x32_bf16 a[208:211], v[208:211], v[240:243], a[208:211]
    ds_read2_b32 a[138:139], v76 offset0:2 offset1:3
    v_mfma_f32_16x16x32_bf16 a[208:211], v[184:187], v[216:219], a[208:211]
    ds_read2_b32 a[140:141], v76 offset0:128 offset1:129
    v_mfma_f32_16x16x32_bf16 a[208:211], v[212:215], v[244:247], a[208:211]
    ds_read2_b32 a[142:143], v76 offset0:130 offset1:131
    s_waitcnt lgkmcnt(15)
    v_mfma_f32_16x16x32_bf16 a[180:183], v[120:123], v[180:183], a[180:183]
    ds_read2_b32 a[144:145], v77 offset0:0 offset1:1
    buffer_load_dwordx4 v27, s[40:43], s85 offen offset:1024 lds
    v_mfma_f32_16x16x32_bf16 a[184:187], v[120:123], v[176:179], a[184:187]
    ds_read2_b32 a[146:147], v77 offset0:2 offset1:3
    v_mfma_f32_16x16x32_bf16 a[188:191], v[124:127], v[176:179], a[188:191]
    ds_read2_b32 a[220:221], v77 offset0:128 offset1:129
    v_mfma_f32_16x16x32_bf16 a[184:187], v[124:127], v[180:183], a[184:187]
    ds_read2_b32 a[222:223], v77 offset0:130 offset1:131
    v_mfma_f32_16x16x32_bf16 a[188:191], v[120:123], v[172:175], a[188:191]
    ds_read2_b32 v[184:185], v68 offset0:96 offset1:97
    buffer_load_dwordx4 v27, s[40:43], s85 offen offset:2048 lds
    v_mfma_f32_16x16x32_bf16 a[192:195], v[124:127], v[172:175], a[192:195]
    ds_read2_b32 v[186:187], v68 offset0:98 offset1:99
    v_mfma_f32_16x16x32_bf16 a[188:191], v[128:131], v[180:183], a[188:191]
    ds_read_b128 v[244:247], v72 offset:3968
    v_mfma_f32_16x16x32_bf16 a[192:195], v[128:131], v[176:179], a[192:195]
    ds_read2_b32 v[188:189], v68 offset0:224 offset1:225
    v_mfma_f32_16x16x32_bf16 a[196:199], v[128:131], v[172:175], a[196:199]
    ds_read2_b32 v[190:191], v68 offset0:226 offset1:227
    s_cmp_eq_u32 s70, 0
    s_cbranch_scc1 L_nof2
    s_waitcnt vmcnt(19)
    s_add_u32 s9, s64, 0x158c000
    s_mov_b64 exec, 1
    buffer_store_dwordx2 v[30:31], off, s[40:43], s9 sc1
    s_mov_b64 exec, -1
L_nof2:
    v_mfma_f32_16x16x32_bf16 a[192:195], v[120:123], v[168:171], a[192:195]
    ds_read_b128 v[240:243], v72 offset:3456
    v_mfma_f32_16x16x32_bf16 a[196:199], v[124:127], v[168:171], a[196:199]
    ds_read2_b32 v[192:193], v69 offset0:96 offset1:97
    v_mfma_f32_16x16x32_bf16 a[192:195], v[132:135], v[180:183], a[192:195]
    ds_read2_b32 v[194:195], v69 offset0:98 offset1:99
    v_mfma_f32_16x16x32_bf16 a[196:199], v[132:135], v[176:179], a[196:199]
    ds_read_b128 v[236:239], v72 offset:2944
    buffer_load_dwordx4 v27, s[40:43], s85 offen offset:3072 lds
    v_mfma_f32_16x16x32_bf16 a[200:203], v[128:131], v[168:171], a[200:203]
    ds_read2_b32 v[196:197], v69 offset0:224 offset1:225
    s_sub_u32 s59, s59, s58
    s_lshl_b32 s58, s3, 10
    v_mfma_f32_16x16x32_bf16 a[204:207], v[132:135], v[168:171], a[204:207]
    ds_read2_b32 v[198:199], v69 offset0:226 offset1:227
    s_add_u32 s59, s59, s58
    s_add_u32 m0, s58, 114688
    v_mfma_f32_16x16x32_bf16 a[200:203], v[132:135], v[172:175], a[200:203]
    ds_read_b128 v[232:235], v72 offset:2432
    s_add_u32 s85, s59, 114688
    v_mfma_f32_16x16x32_bf16 a[196:199], v[120:123], v[164:167], a[196:199]
    ds_read2_b32 v[200:201], v70 offset0:96 offset1:97
    buffer_load_dwordx4 v27, s[40:43], s85 offen offset:0 lds
    v_mfma_f32_16x16x32_bf16 a[200:203], v[124:127], v[164:167], a[200:203]
    ds_read2_b32 v[202:203], v70 offset0:98 offset1:99
    s_add_u32 m0, s58, 118784
    s_add_u32 s85, s59, 118784
    v_mfma_f32_16x16x32_bf16 a[196:199], v[136:139], v[180:183], a[196:199]
    ds_read_b128 v[228:231], v72 offset:1920
    v_mfma_f32_16x16x32_bf16 a[200:203], v[136:139], v[176:179], a[200:203]
    ds_read2_b32 v[204:205], v70 offset0:224 offset1:225
    v_mfma_f32_16x16x32_bf16 a[204:207], v[128:131], v[164:167], a[204:207]
    ds_read2_b32 v[206:207], v70 offset0:226 offset1:227
    buffer_load_dwordx4 v27, s[40:43], s85 offen offset:0 lds
    v_mfma_f32_16x16x32_bf16 a[208:211], v[132:135], v[164:167], a[208:211]
    ds_read_b128 v[224:227], v72 offset:1408
    s_lshl_b32 s85, s6, 9
    s_add_u32 m0, s85, 122880
    v_mfma_f32_16x16x32_bf16 a[204:207], v[136:139], v[172:175], a[204:207]
    ds_read2_b32 v[208:209], v71 offset0:96 offset1:97
    s_sub_u32 s85, s59, s58
    s_add_u32 s85, s85, m0
    v_mfma_f32_16x16x32_bf16 a[208:211], v[136:139], v[168:171], a[208:211]
    ds_read2_b32 v[210:211], v71 offset0:98 offset1:99
    v_mfma_f32_16x16x32_bf16 a[200:203], v[120:123], v[160:163], a[200:203]
    ds_read_b128 v[220:223], v72 offset:896
    buffer_load_dwordx4 v27, s[40:43], s85 offen offset:0 lds
    v_mfma_f32_16x16x32_bf16 a[204:207], v[124:127], v[160:163], a[204:207]
    ds_read2_b32 v[212:213], v71 offset0:224 offset1:225
    v_mfma_f32_16x16x32_bf16 a[200:203], v[140:143], v[180:183], a[200:203]
    ds_read2_b32 v[214:215], v71 offset0:226 offset1:227
    v_mfma_f32_16x16x32_bf16 a[204:207], v[140:143], v[176:179], a[204:207]
    ds_read_b128 v[216:219], v72 offset:384
    v_mfma_f32_16x16x32_bf16 a[208:211], v[128:131], v[160:163], a[208:211]
    buffer_load_dwordx4 a[0:3], v248, s[40:43], s48 offen offset:0 sc1
    v_mfma_f32_16x16x32_bf16 a[204:207], v[120:123], v[156:159], a[204:207]
    v_mfma_f32_16x16x32_bf16 a[208:211], v[140:143], v[172:175], a[208:211]
    v_mfma_f32_16x16x32_bf16 a[204:207], v[144:147], v[180:183], a[204:207]
    v_mfma_f32_16x16x32_bf16 a[208:211], v[124:127], v[156:159], a[208:211]
    ds_read_b128 a[176:179], v74 offset:3584
    buffer_load_dwordx4 a[4:7], v248, s[40:43], s61 offen offset:0 sc1
    v_mfma_f32_16x16x32_bf16 a[208:211], v[144:147], v[176:179], a[208:211]
    ds_read_b128 a[172:175], v74 offset:3072
    s_waitcnt lgkmcnt(15)
    v_mfma_f32_16x16x32_bf16 a[208:211], v[120:123], v[152:155], a[208:211]
    ds_read_b128 a[168:171], v74 offset:2560
    v_mfma_f32_16x16x32_bf16 a[208:211], v[148:151], v[180:183], a[208:211]
    ds_read_b128 a[164:167], v74 offset:2048
    v_mfma_f32_16x16x32_bf16 a[180:183], v[184:187], v[244:247], a[180:183]
    ds_read_b128 a[160:163], v74 offset:1536
    buffer_load_dwordx4 a[8:11], v248, s[40:43], s48 offen offset:1024 sc1
    v_mfma_f32_16x16x32_bf16 a[184:187], v[184:187], v[240:243], a[184:187]
    ds_read_b128 a[156:159], v74 offset:1024
    v_mfma_f32_16x16x32_bf16 a[188:191], v[188:191], v[240:243], a[188:191]
    ds_read_b128 a[152:155], v74 offset:512
    v_mfma_f32_16x16x32_bf16 a[184:187], v[188:191], v[244:247], a[184:187]
    ds_read_b128 a[148:151], v74 offset:0
    v_mfma_f32_16x16x32_bf16 a[188:191], v[184:187], v[236:239], a[188:191]
    ds_read_b128 v[108:111], v59 offset:0
    buffer_load_dwordx4 a[12:15], v248, s[40:43], s61 offen offset:1024 sc1
    v_mfma_f32_16x16x32_bf16 a[192:195], v[188:191], v[236:239], a[192:195]
    ds_read_b128 v[112:115], v60
    s_waitcnt lgkmcnt(2)
    s_cmp_lg_u32 s71, 0
    s_cbranch_scc1 L_sh0_1
    v_mfma_f32_16x16x32_bf16 a[216:219], a[120:123], a[148:151], 0
    v_mfma_f32_16x16x32_bf16 a[212:215], a[120:123], a[176:179], 0
    v_mfma_f32_16x16x32_bf16 a[216:219], a[124:127], a[152:155], a[216:219]
    buffer_load_dwordx4 a[16:19], v248, s[40:43], s48 offen offset:2048 sc1
    v_mfma_f32_16x16x32_bf16 a[216:219], a[128:131], a[156:159], a[216:219]
    v_mfma_f32_16x16x32_bf16 a[216:219], a[132:135], a[160:163], a[216:219]
    v_mfma_f32_16x16x32_bf16 a[216:219], a[136:139], a[164:167], a[216:219]
    v_mfma_f32_16x16x32_bf16 a[216:219], a[140:143], a[168:171], a[216:219]
    buffer_load_dwordx4 a[20:23], v248, s[40:43], s61 offen offset:2048 sc1
    v_mfma_f32_16x16x32_bf16 a[216:219], a[144:147], a[172:175], a[216:219]
    v_mfma_f32_16x16x32_bf16 a[216:219], a[220:223], a[176:179], a[216:219]
    s_nop 1
    s_branch L_sh0_done
L_sh0_1:
    s_cmp_lg_u32 s71, 1
    s_cbranch_scc1 L_sh0_2
    s_nop 2
    v_mfma_f32_16x16x32_bf16 a[216:219], a[120:123], a[152:155], 0
    v_mfma_f32_16x16x32_bf16 a[212:215], a[120:123], a[172:175], 0
    v_mfma_f32_16x16x32_bf16 a[216:219], a[124:127], a[156:159], a[216:219]
    buffer_load_dwordx4 a[16:19], v248, s[40:43], s48 offen offset:2048 sc1
    v_mfma_f32_16x16x32_bf16 a[212:215], a[124:127], a[176:179], a[212:215]
    v_mfma_f32_16x16x32_bf16 a[216:219], a[128:131], a[160:163], a[216:219]
    v_mfma_f32_16x16x32_bf16 a[216:219], a[132:135], a[164:167], a[216:219]
    v_mfma_f32_16x16x32_bf16 a[216:219], a[136:139], a[168:171], a[216:219]
    buffer_load_dwordx4 a[20:23], v248, s[40:43], s61 offen offset:2048 sc1
    v_mfma_f32_16x16x32_bf16 a[216:219], a[140:143], a[172:175], a[216:219]
    v_mfma_f32_16x16x32_bf16 a[216:219], a[144:147], a[176:179], a[216:219]
    s_nop 1
    s_branch L_sh0_done
L_sh0_2:
    s_cmp_lg_u32 s71, 2
    s_cbranch_scc1 L_sh0_3
    s_nop 2
    v_mfma_f32_16x16x32_bf16 a[216:219], a[120:123], a[156:159], 0
    v_mfma_f32_16x16x32_bf16 a[212:215], a[120:123], a[168:171], 0
    v_mfma_f32_16x16x32_bf16 a[216:219], a[124:127], a[160:163], a[216:219]
    buffer_load_dwordx4 a[16:19], v248, s[40:43], s48 offen offset:2048 sc1
    v_mfma_f32_16x16x32_bf16 a[212:215], a[124:127], a[172:175], a[212:215]
    v_mfma_f32_16x16x32_bf16 a[216:219], a[128:131], a[164:167], a[216:219]
    v_mfma_f32_16x16x32_bf16 a[212:215], a[128:131], a[176:179], a[212:215]
    v_mfma_f32_16x16x32_bf16 a[216:219], a[132:135], a[168:171], a[216:219]
    buffer_load_dwordx4 a[20:23], v248, s[40:43], s61 offen offset:2048 sc1
    v_mfma_f32_16x16x32_bf16 a[216:219], a[136:139], a[172:175], a[216:219]
    v_mfma_f32_16x16x32_bf16 a[216:219], a[140:143], a[176:179], a[216:219]
    s_nop 1
    s_branch L_sh0_done
L_sh0_3:
    s_nop 4
    v_mfma_f32_16x16x32_bf16 a[216:219], a[120:123], a[160:163], 0
    v_mfma_f32_16x16x32_bf16 a[212:215], a[120:123], a[164:167], 0
    v_mfma_f32_16x16x32_bf16 a[216:219], a[124:127], a[164:167], a[216:219]
    buffer_load_dwordx4 a[16:19], v248, s[40:43], s48 offen offset:2048 sc1
    v_mfma_f32_16x16x32_bf16 a[212:215], a[124:127], a[168:171], a[212:215]
    v_mfma_f32_16x16x32_bf16 a[216:219], a[128:131], a[168:171], a[216:219]
    v_mfma_f32_16x16x32_bf16 a[212:215], a[128:131], a[172:175], a[212:215]
    v_mfma_f32_16x16x32_bf16 a[216:219], a[132:135], a[172:175], a[216:219]
    buffer_load_dwordx4 a[20:23], v248, s[40:43], s61 offen offset:2048 sc1
    v_mfma_f32_16x16x32_bf16 a[212:215], a[132:135], a[176:179], a[212:215]
    v_mfma_f32_16x16x32_bf16 a[216:219], a[136:139], a[176:179], a[216:219]
    s_nop 1
L_sh0_done:
    v_mfma_f32_16x16x32_bf16 a[188:191], v[192:195], v[244:247], a[188:191]
    ds_read2_b32 a[120:121], v73 offset0:64 offset1:65
    v_mfma_f32_16x16x32_bf16 a[192:195], v[192:195], v[240:243], a[192:195]
    ds_read2_b32 a[122:123], v73 offset0:66 offset1:67
    buffer_load_dwordx4 a[24:27], v248, s[40:43], s48 offen offset:3072 sc1
    v_mfma_f32_16x16x32_bf16 a[196:199], v[192:195], v[236:239], a[196:199]
    ds_read_b128 a[176:179], v74 offset:3840
    v_mfma_f32_16x16x32_bf16 a[192:195], v[184:187], v[232:235], a[192:195]
    ds_read2_b32 a[124:125], v73 offset0:192 offset1:193
    v_mfma_f32_16x16x32_bf16 a[196:199], v[188:191], v[232:235], a[196:199]
    ds_read2_b32 a[126:127], v73 offset0:194 offset1:195
    v_mfma_f32_16x16x32_bf16 a[192:195], v[196:199], v[244:247], a[192:195]
    ds_read_b128 a[172:175], v74 offset:3328
    buffer_load_dwordx4 a[28:31], v248, s[40:43], s61 offen offset:3072 sc1
    v_mfma_f32_16x16x32_bf16 a[196:199], v[196:199], v[240:243], a[196:199]
    ds_read2_b32 a[128:129], v75 offset0:64 offset1:65
    v_mfma_f32_16x16x32_bf16 a[200:203], v[192:195], v[232:235], a[200:203]
    ds_read2_b32 a[130:131], v75 offset0:66 offset1:67
    v_mfma_f32_16x16x32_bf16 a[204:207], v[196:199], v[232:235], a[204:207]
    ds_read_b128 a[168:171], v74 offset:2816
    v_mfma_f32_16x16x32_bf16 a[200:203], v[196:199], v[236:239], a[200:203]
    ds_read2_b32 a[132:133], v75 offset0:192 offset1:193
    buffer_load_dwordx4 a[32:35], v249, s[40:43], s48 offen offset:0 sc1
    v_mfma_f32_16x16x32_bf16 a[196:199], v[184:187], v[228:231], a[196:199]
    ds_read2_b32 a[134:135], v75 offset0:194 offset1:195
    v_mfma_f32_16x16x32_bf16 a[200:203], v[188:191], v[228:231], a[200:203]
    ds_read_b128 a[164:167], v74 offset:2304
    v_mfma_f32_16x16x32_bf16 a[196:199], v[200:203], v[244:247], a[196:199]
    ds_read2_b32 a[136:137], v76 offset0:64 offset1:65
    v_mfma_f32_16x16x32_bf16 a[200:203], v[200:203], v[240:243], a[200:203]
    ds_read2_b32 a[138:139], v76 offset0:66 offset1:67
    buffer_load_dwordx4 a[36:39], v249, s[40:43], s61 offen offset:0 sc1
    v_mfma_f32_16x16x32_bf16 a[204:207], v[192:195], v[228:231], a[204:207]
    ds_read_b128 a[160:163], v74 offset:1792
    v_mfma_f32_16x16x32_bf16 a[208:211], v[196:199], v[228:231], a[208:211]
    ds_read2_b32 a[140:141], v76 offset0:192 offset1:193
    v_mfma_f32_16x16x32_bf16 a[204:207], v[200:203], v[236:239], a[204:207]
    ds_read2_b32 a[142:143], v76 offset0:194 offset1:195
    v_mfma_f32_16x16x32_bf16 a[208:211], v[200:203], v[232:235], a[208:211]
    ds_read_b128 a[156:159], v74 offset:1280
    buffer_load_dwordx4 a[40:43], v249, s[40:43], s48 offen offset:1024 sc1
    v_mfma_f32_16x16x32_bf16 a[200:203], v[184:187], v[224:227], a[200:203]
    ds_read2_b32 a[144:145], v77 offset0:64 offset1:65
    v_mfma_f32_16x16x32_bf16 a[204:207], v[188:191], v[224:227], a[204:207]
    ds_read2_b32 a[146:147], v77 offset0:66 offset1:67
    v_mfma_f32_16x16x32_bf16 a[200:203], v[204:207], v[244:247], a[200:203]
    ds_read_b128 a[152:155], v74 offset:768
    v_mfma_f32_16x16x32_bf16 a[204:207], v[204:207], v[240:243], a[204:207]
    ds_read2_b32 a[220:221], v77 offset0:192 offset1:193
    buffer_load_dwordx4 a[44:47], v249, s[40:43], s61 offen offset:1024 sc1
    v_mfma_f32_16x16x32_bf16 a[208:211], v[192:195], v[224:227], a[208:211]
    ds_read2_b32 a[222:223], v77 offset0:194 offset1:195
    v_mfma_f32_16x16x32_bf16 a[204:207], v[184:187], v[220:223], a[204:207]
    ds_read_b128 a[148:151], v74 offset:256
    v_mfma_f32_16x16x32_bf16 a[208:211], v[204:207], v[236:239], a[208:211]
    s_waitcnt lgkmcnt(0)
    s_barrier
    s_cmp_lg_u32 s71, 0
    s_cbranch_scc1 L_sh1_1
    v_mfma_f32_16x16x32_bf16 a[216:219], a[120:123], a[148:151], a[216:219]
    buffer_load_dwordx4 a[48:51], v249, s[40:43], s48 offen offset:2048 sc1
    v_mfma_f32_16x16x32_bf16 a[212:215], a[120:123], a[176:179], a[212:215]
    v_mfma_f32_16x16x32_bf16 a[216:219], a[124:127], a[152:155], a[216:219]
    v_mfma_f32_16x16x32_bf16 a[216:219], a[128:131], a[156:159], a[216:219]
    v_mfma_f32_16x16x32_bf16 a[216:219], a[132:135], a[160:163], a[216:219]
    buffer_load_dwordx4 a[52:55], v249, s[40:43], s61 offen offset:2048 sc1
    v_mfma_f32_16x16x32_bf16 a[216:219], a[136:139], a[164:167], a[216:219]
    v_mfma_f32_16x16x32_bf16 a[216:219], a[140:143], a[168:171], a[216:219]
    v_mfma_f32_16x16x32_bf16 a[216:219], a[144:147], a[172:175], a[216:219]
    v_mfma_f32_16x16x32_bf16 a[216:219], a[220:223], a[176:179], a[216:219]
    buffer_load_dwordx4 a[56:59], v249, s[40:43], s48 offen offset:3072 sc1
    s_nop 1
    s_branch L_sh1_done
L_sh1_1:
    s_cmp_lg_u32 s71, 1
    s_cbranch_scc1 L_sh1_2
    v_mfma_f32_16x16x32_bf16 a[216:219], a[120:123], a[152:155], a[216:219]
    buffer_load_dwordx4 a[48:51], v249, s[40:43], s48 offen offset:2048 sc1
    v_mfma_f32_16x16x32_bf16 a[212:215], a[120:123], a[172:175], a[212:215]
    v_mfma_f32_16x16x32_bf16 a[216:219], a[124:127], a[156:159], a[216:219]
    v_mfma_f32_16x16x32_bf16 a[212:215], a[124:127], a[176:179], a[212:215]
    v_mfma_f32_16x16x32_bf16 a[216:219], a[128:131], a[160:163], a[216:219]
    buffer_load_dwordx4 a[52:55], v249, s[40:43], s61 offen offset:2048 sc1
    v_mfma_f32_16x16x32_bf16 a[216:219], a[132:135], a[164:167], a[216:219]
    v_mfma_f32_16x16x32_bf16 a[216:219], a[136:139], a[168:171], a[216:219]
    v_mfma_f32_16x16x32_bf16 a[216:219], a[140:143], a[172:175], a[216:219]
    v_mfma_f32_16x16x32_bf16 a[216:219], a[144:147], a[176:179], a[216:219]
    buffer_load_dwordx4 a[56:59], v249, s[40:43], s48 offen offset:3072 sc1
    s_nop 1
    s_branch L_sh1_done
L_sh1_2:
    s_cmp_lg_u32 s71, 2
    s_cbranch_scc1 L_sh1_3
    v_mfma_f32_16x16x32_bf16 a[216:219], a[120:123], a[156:159], a[216:219]
    buffer_load_dwordx4 a[48:51], v249, s[40:43], s48 offen offset:2048 sc1
    v_mfma_f32_16x16x32_bf16 a[212:215], a[120:123], a[168:171], a[212:215]
    v_mfma_f32_16x16x32_bf16 a[216:219], a[124:127], a[160:163], a[216:219]
    v_mfma_f32_16x16x32_bf16 a[212:215], a[124:127], a[172:175], a[212:215]
    v_mfma_f32_16x16x32_bf16 a[216:219], a[128:131], a[164:167], a[216:219]
    buffer_load_dwordx4 a[52:55], v249, s[40:43], s61 offen offset:2048 sc1
    v_mfma_f32_16x16x32_bf16 a[212:215], a[128:131], a[176:179], a[212:215]
    v_mfma_f32_16x16x32_bf16 a[216:219], a[132:135], a[168:171], a[216:219]
    v_mfma_f32_16x16x32_bf16 a[216:219], a[136:139], a[172:175], a[216:219]
    v_mfma_f32_16x16x32_bf16 a[216:219], a[140:143], a[176:179], a[216:219]
    buffer_load_dwordx4 a[56:59], v249, s[40:43], s48 offen offset:3072 sc1
    s_nop 1
    s_branch L_sh1_done
L_sh1_3:
    v_mfma_f32_16x16x32_bf16 a[216:219], a[120:123], a[160:163], a[216:219]
    buffer_load_dwordx4 a[48:51], v249, s[40:43], s48 offen offset:2048 sc1
    v_mfma_f32_16x16x32_bf16 a[212:215], a[120:123], a[164:167], a[212:215]
    v_mfma_f32_16x16x32_bf16 a[216:219], a[124:127], a[164:167], a[216:219]
    v_mfma_f32_16x16x32_bf16 a[212:215], a[124:127], a[168:171], a[212:215]
    v_mfma_f32_16x16x32_bf16 a[216:219], a[128:131], a[168:171], a[216:219]
    buffer_load_dwordx4 a[52:55], v249, s[40:43], s61 offen offset:2048 sc1
    v_mfma_f32_16x16x32_bf16 a[212:215], a[128:131], a[172:175], a[212:215]
    v_mfma_f32_16x16x32_bf16 a[216:219], a[132:135], a[172:175], a[216:219]
    v_mfma_f32_16x16x32_bf16 a[212:215], a[132:135], a[176:179], a[212:215]
    v_mfma_f32_16x16x32_bf16 a[216:219], a[136:139], a[176:179], a[216:219]
    buffer_load_dwordx4 a[56:59], v249, s[40:43], s48 offen offset:3072 sc1
    s_nop 1
L_sh1_done:
    v_mfma_f32_16x16x32_bf16 a[204:207], v[208:211], v[244:247], a[204:207]
    v_mfma_f32_16x16x32_bf16 a[208:211], v[188:191], v[220:223], a[208:211]
    v_mfma_f32_16x16x32_bf16 a[208:211], v[208:211], v[240:243], a[208:211]
    v_mfma_f32_16x16x32_bf16 a[208:211], v[184:187], v[216:219], a[208:211]
    buffer_load_dwordx4 a[60:63], v249, s[40:43], s61 offen offset:3072 sc1
    v_mfma_f32_16x16x32_bf16 a[208:211], v[212:215], v[244:247], a[208:211]
    ds_write_b128 v117, a[212:215]
    ds_write_b128 v117, a[216:219] offset:1024
    s_cmp_eq_u32 s6, 0
    s_cbranch_scc1 L_cv_e0
    ds_write_b128 v116, a[180:183] offset:0
    ds_write_b128 v116, a[184:187] offset:1024
    ds_write_b128 v116, a[188:191] offset:2048
    ds_write_b128 v116, a[192:195] offset:3072
    v_accvgpr_read_b32 v120, a196
    v_accvgpr_read_b32 v121, a197
    v_accvgpr_read_b32 v122, a198
    v_accvgpr_read_b32 v123, a199
    v_accvgpr_read_b32 v124, a200
    v_accvgpr_read_b32 v125, a201
    v_accvgpr_read_b32 v126, a202
    v_accvgpr_read_b32 v127, a203
    v_accvgpr_read_b32 v128, a204
    v_accvgpr_read_b32 v129, a205
    v_accvgpr_read_b32 v130, a206
    v_accvgpr_read_b32 v131, a207
    v_accvgpr_read_b32 v132, a208
    v_accvgpr_read_b32 v133, a209
    v_accvgpr_read_b32 v134, a210
    v_accvgpr_read_b32 v135, a211
    s_nop 1
    s_branch L_cv_e1
L_cv_e0:
    s_nop 7
    ds_write_b128 v116, a[196:199] offset:0
    ds_write_b128 v116, a[200:203] offset:1024
    ds_write_b128 v116, a[204:207] offset:2048
    ds_write_b128 v116, a[208:211] offset:3072
    v_accvgpr_read_b32 v120, a180
    v_accvgpr_read_b32 v121, a181
    v_accvgpr_read_b32 v122, a182
    v_accvgpr_read_b32 v123, a183
    v_accvgpr_read_b32 v124, a184
    v_accvgpr_read_b32 v125, a185
    v_accvgpr_read_b32 v126, a186
    v_accvgpr_read_b32 v127, a187
    v_accvgpr_read_b32 v128, a188
    v_accvgpr_read_b32 v129, a189
    v_accvgpr_read_b32 v130, a190
    v_accvgpr_read_b32 v131, a191
    v_accvgpr_read_b32 v132, a192
    v_accvgpr_read_b32 v133, a193
    v_accvgpr_read_b32 v134, a194
    v_accvgpr_read_b32 v135, a195
L_cv_e1:
    s_waitcnt lgkmcnt(0)
    s_barrier
    ds_read_b128 v[144:147], v118 offset:0
    ds_read_b128 v[148:151], v118 offset:1024
    ds_read_b128 v[152:155], v118 offset:2048
    ds_read_b128 v[156:159], v118 offset:3072
    ds_read_b128 v[160:163], v119 offset:0
    ds_read_b128 v[164:167], v119 offset:2048
    ds_read_b128 v[168:171], v119 offset:4096
    ds_read_b128 v[172:175], v119 offset:6144
    s_waitcnt lgkmcnt(7)
    v_pk_add_f32 v[120:121], v[120:121], v[144:145]
    v_pk_add_f32 v[122:123], v[122:123], v[146:147]
    v_cvt_pk_bf16_f32 v120, 0, v120
    v_cvt_pk_bf16_f32 v121, 0, v121
    v_cvt_pk_bf16_f32 v122, 0, v122
    v_cvt_pk_bf16_f32 v123, 0, v123
    v_lshlrev_b32 v178, v64, v99
    v_lshlrev_b32 v179, v64, v98
    buffer_load_dwordx4 a[64:67], v250, s[40:43], s48 offen offset:0 sc1
    v_lshlrev_b32 v180, v64, v97
    v_lshlrev_b32 v181, v64, v96
    v_and_b32 v178, s101, v178
    v_and_b32 v179, s101, v179
    v_and_b32 v180, s101, v180
    v_and_b32 v181, s101, v181
    v_pk_mul_f32 v[178:179], v[178:179], s[10:11]
    v_pk_mul_f32 v[180:181], v[180:181], s[10:11]
    v_cvt_pk_bf16_f32 v178, 0, v178
    v_cvt_pk_bf16_f32 v179, 0, v179
    v_cvt_pk_bf16_f32 v180, 0, v180
    v_cvt_pk_bf16_f32 v181, 0, v181
    v_pk_add_f32 v[120:121], v[120:121], v[178:179]
    v_pk_add_f32 v[122:123], v[122:123], v[180:181]
    v_cvt_pk_bf16_f32 v184, v120, v121
    v_cvt_pk_bf16_f32 v185, v122, v123
    buffer_load_dwordx4 a[68:71], v250, s[40:43], s61 offen offset:0 sc1
    buffer_store_dwordx2 v[184:185], v65, s[40:43], s14 offen offset:0 sc1
    s_waitcnt lgkmcnt(6)
    v_pk_add_f32 v[124:125], v[124:125], v[148:149]
    v_pk_add_f32 v[126:127], v[126:127], v[150:151]
    v_cvt_pk_bf16_f32 v124, 0, v124
    v_cvt_pk_bf16_f32 v125, 0, v125
    v_cvt_pk_bf16_f32 v126, 0, v126
    v_cvt_pk_bf16_f32 v127, 0, v127
    v_lshlrev_b32 v178, v64, v103
    v_lshlrev_b32 v179, v64, v102
    v_lshlrev_b32 v180, v64, v101
    v_lshlrev_b32 v181, v64, v100
    v_and_b32 v178, s101, v178
    v_and_b32 v179, s101, v179
    v_and_b32 v180, s101, v180
    v_and_b32 v181, s101, v181
    v_pk_mul_f32 v[178:179], v[178:179], s[10:11]
    v_pk_mul_f32 v[180:181], v[180:181], s[10:11]
    buffer_load_dwordx4 a[72:75], v250, s[40:43], s48 offen offset:1024 sc1
    v_cvt_pk_bf16_f32 v178, 0, v178
    v_cvt_pk_bf16_f32 v179, 0, v179
    v_cvt_pk_bf16_f32 v180, 0, v180
    v_cvt_pk_bf16_f32 v181, 0, v181
    v_pk_add_f32 v[124:125], v[124:125], v[178:179]
    v_pk_add_f32 v[126:127], v[126:127], v[180:181]
    v_cvt_pk_bf16_f32 v186, v124, v125
    v_cvt_pk_bf16_f32 v187, v126, v127
    buffer_store_dwordx2 v[186:187], v65, s[40:43], s14 offen offset:512 sc1
    s_waitcnt lgkmcnt(5)
    v_pk_add_f32 v[128:129], v[128:129], v[152:153]
    v_pk_add_f32 v[130:131], v[130:131], v[154:155]
    v_cvt_pk_bf16_f32 v128, 0, v128
    v_cvt_pk_bf16_f32 v129, 0, v129
    v_cvt_pk_bf16_f32 v130, 0, v130
    v_cvt_pk_bf16_f32 v131, 0, v131
    v_lshlrev_b32 v178, v64, v107
    v_lshlrev_b32 v179, v64, v106
    buffer_load_dwordx4 a[76:79], v250, s[40:43], s61 offen offset:1024 sc1
    v_lshlrev_b32 v180, v64, v105
    v_lshlrev_b32 v181, v64, v104
    v_and_b32 v178, s101, v178
    v_and_b32 v179, s101, v179
    v_lshrrev_b32 v252, 3, v0
    v_and_b32 v180, s101, v180
    v_and_b32 v181, s101, v181
    v_pk_mul_f32 v[178:179], v[178:179], s[10:11]
    v_pk_mul_f32 v[180:181], v[180:181], s[10:11]
    v_and_b32 v253, 7, v0
    v_cvt_pk_bf16_f32 v178, 0, v178
    v_cvt_pk_bf16_f32 v179, 0, v179
    v_cvt_pk_bf16_f32 v180, 0, v180
    v_cvt_pk_bf16_f32 v181, 0, v181
    v_lshlrev_b32 v252, 8, v252
    v_pk_add_f32 v[128:129], v[128:129], v[178:179]
    v_pk_add_f32 v[130:131], v[130:131], v[180:181]
    v_cvt_pk_bf16_f32 v188, v128, v129
    v_cvt_pk_bf16_f32 v189, v130, v131
    v_lshl_add_u32 v252, v253, 4, v252
    buffer_store_dwordx2 v[188:189], v65, s[40:43], s14 offen offset:1024 sc1
    s_waitcnt lgkmcnt(4)
    v_pk_add_f32 v[132:133], v[132:133], v[156:157]
    v_pk_add_f32 v[134:135], v[134:135], v[158:159]
    v_cvt_pk_bf16_f32 v132, 0, v132
    v_cvt_pk_bf16_f32 v133, 0, v133
    v_sub_u32 v252, v24, v252
    v_cvt_pk_bf16_f32 v134, 0, v134
    v_cvt_pk_bf16_f32 v135, 0, v135
    v_lshlrev_b32 v178, v64, v111
    v_lshlrev_b32 v179, v64, v110
    v_lshl_add_u32 v252, v0, 8, v252
    v_lshlrev_b32 v180, v64, v109
    v_lshlrev_b32 v181, v64, v108
    v_and_b32 v178, s101, v178
    v_and_b32 v179, s101, v179
    v_cmp_gt_u32 vcc, 72, v0
    s_nop 1
    v_cndmask_b32 v252, v63, v252, vcc
    v_lshlrev_b32 v253, 7, v0
    v_cndmask_b32 v253, v63, v253, vcc
    v_and_b32 v180, s101, v180
    v_and_b32 v181, s101, v181
    v_pk_mul_f32 v[178:179], v[178:179], s[10:11]
    v_pk_mul_f32 v[180:181], v[180:181], s[10:11]
    v_cvt_pk_bf16_f32 v178, 0, v178
    v_cvt_pk_bf16_f32 v179, 0, v179
    v_cvt_pk_bf16_f32 v180, 0, v180
    v_cvt_pk_bf16_f32 v181, 0, v181
    v_pk_add_f32 v[132:133], v[132:133], v[178:179]
    v_pk_add_f32 v[134:135], v[134:135], v[180:181]
    v_cvt_pk_bf16_f32 v190, v132, v133
    v_cvt_pk_bf16_f32 v191, v134, v135
    buffer_store_dwordx2 v[190:191], v65, s[40:43], s14 offen offset:1536 sc1
    s_cmp_ge_u32 s3, 2
    s_cbranch_scc1 L_cv_nosh
    s_waitcnt lgkmcnt(0)
    v_pk_add_f32 v[160:161], v[160:161], v[164:165]
    v_pk_add_f32 v[168:169], v[168:169], v[172:173]
    v_pk_add_f32 v[160:161], v[160:161], v[168:169]
    v_pk_add_f32 v[162:163], v[162:163], v[166:167]
    v_pk_add_f32 v[170:171], v[170:171], v[174:175]
    v_pk_add_f32 v[162:163], v[162:163], v[170:171]
    v_cvt_pk_bf16_f32 v160, 0, v160
    v_cvt_pk_bf16_f32 v161, 0, v161
    v_cvt_pk_bf16_f32 v162, 0, v162
    v_cvt_pk_bf16_f32 v163, 0, v163
    v_lshlrev_b32 v178, v64, v115
    v_lshlrev_b32 v179, v64, v114
    v_lshlrev_b32 v180, v64, v113
    v_lshlrev_b32 v181, v64, v112
    v_and_b32 v178, s101, v178
    v_and_b32 v179, s101, v179
    v_and_b32 v180, s101, v180
    v_and_b32 v181, s101, v181
    v_pk_mul_f32 v[178:179], v[178:179], s[12:13]
    v_pk_mul_f32 v[180:181], v[180:181], s[12:13]
    v_cvt_pk_bf16_f32 v178, 0, v178
    v_cvt_pk_bf16_f32 v179, 0, v179
    v_cvt_pk_bf16_f32 v180, 0, v180
    v_cvt_pk_bf16_f32 v181, 0, v181
    v_pk_add_f32 v[160:161], v[160:161], v[178:179]
    v_pk_add_f32 v[162:163], v[162:163], v[180:181]
    v_cvt_pk_bf16_f32 v192, v160, v161
    v_cvt_pk_bf16_f32 v193, v162, v163
    buffer_store_dwordx2 v[192:193], v65, s[40:43], s15 offen sc1
L_cv_nosh:
    s_waitcnt lgkmcnt(0)
    s_nop 1
    v_add_u32 v246, 0x90000, v6
    v_add_u32 v247, 0x90000, v10
    v_and_b32 v15, 3, v1
    v_lshlrev_b32 v15, 3, v15
    v_bfe_u32 v64, v1, 2, 1
    v_lshl_add_u32 v15, v64, 6, v15
    s_max_u32 s85, s4, 1
    s_lshl_b32 s85, s85, 9
    s_add_u32 s85, s85, 0x158bfa0
    s_waitcnt vmcnt(24)
    s_barrier
    s_cmp_eq_u32 s67, 0
    s_cbranch_scc1 L_tail_n
    v_add_u32 v7, s52, v27
    v_add_u32 v39, s52, v8
    ds_read_b128 a[180:183], v7 offset:0
    ds_read_b128 a[184:187], v7 offset:1024
    ds_read_b128 a[188:191], v7 offset:2048
    ds_read_b128 a[192:195], v7 offset:3072
    ds_read_b128 a[196:199], v7 offset:4096
    ds_read_b128 a[200:203], v7 offset:5120
    ds_read_b128 a[204:207], v39 offset:0
    s_waitcnt vmcnt(22)
    s_waitcnt lgkmcnt(6)
    v_mfma_f32_16x16x32_bf16 v[64:67], a[180:183], a[0:3], 0
    buffer_load_dwordx2 v[54:55], v15, s[40:43], s85 offen sc1
    v_mfma_f32_16x16x32_bf16 v[92:95], a[180:183], a[4:7], 0
    ds_read_b128 a[180:183], v7 offset:6912
    s_waitcnt lgkmcnt(6)
    v_mfma_f32_16x16x32_bf16 v[68:71], a[184:187], a[0:3], 0
    v_mov_b32 v140, -1
    v_mov_b32 v141, -1
    v_mfma_f32_16x16x32_bf16 v[96:99], a[184:187], a[4:7], 0
    ds_read_b128 a[184:187], v7 offset:7936
    s_waitcnt lgkmcnt(6)
    v_mfma_f32_16x16x32_bf16 v[72:75], a[188:191], a[0:3], 0
    v_mov_b32 v142, -1
    v_mov_b32 v143, -1
    v_mfma_f32_16x16x32_bf16 v[100:103], a[188:191], a[4:7], 0
    ds_read_b128 a[188:191], v7 offset:8960
    s_waitcnt lgkmcnt(6)
    v_mfma_f32_16x16x32_bf16 v[76:79], a[192:195], a[0:3], 0
    s_mov_b32 s9, 0x240000
    v_mfma_f32_16x16x32_bf16 v[104:107], a[192:195], a[4:7], 0
    ds_read_b128 a[192:195], v7 offset:9984
    s_waitcnt lgkmcnt(6)
    v_mfma_f32_16x16x32_bf16 v[80:83], a[0:3], a[196:199], 0
    buffer_store_dwordx4 v[140:143], v24, s[40:43], s9 offen
    v_mfma_f32_16x16x32_bf16 v[108:111], a[4:7], a[196:199], 0
    ds_read_b128 a[196:199], v7 offset:11008
    s_waitcnt lgkmcnt(6)
    v_mfma_f32_16x16x32_bf16 v[84:87], a[0:3], a[200:203], 0
    s_mov_b32 s9, 0x242000
    v_mfma_f32_16x16x32_bf16 v[112:115], a[4:7], a[200:203], 0
    ds_read_b128 a[200:203], v7 offset:12032
    s_waitcnt lgkmcnt(6)
    v_mfma_f32_16x16x32_bf16 v[88:91], a[204:207], a[0:3], 0
    v_mfma_f32_16x16x32_bf16 v[116:119], a[204:207], a[4:7], 0
    ds_read_b128 a[204:207], v39 offset:6912
    buffer_store_dwordx4 v[140:143], v24, s[40:43], s9 offen
    s_add_u32 s8, s51, 20480
    buffer_load_dwordx4 a[120:123], v27, s[40:43], s8 offen offset:1024
    s_add_u32 s8, s51, 20480
    buffer_load_dwordx4 a[124:127], v27, s[40:43], s8 offen offset:2048
    s_add_u32 s8, s51, 20480
    buffer_load_dwordx4 a[128:131], v27, s[40:43], s8 offen offset:3072
    s_waitcnt vmcnt(26)
    s_waitcnt lgkmcnt(6)
    v_mfma_f32_16x16x32_bf16 v[64:67], a[180:183], a[8:11], v[64:67]
    s_mov_b32 s9, 0x244000
    v_mfma_f32_16x16x32_bf16 v[92:95], a[180:183], a[12:15], v[92:95]
    ds_read_b128 a[180:183], v7 offset:13824
    s_waitcnt lgkmcnt(6)
    v_mfma_f32_16x16x32_bf16 v[68:71], a[184:187], a[8:11], v[68:71]
    v_mfma_f32_16x16x32_bf16 v[96:99], a[184:187], a[12:15], v[96:99]
    ds_read_b128 a[184:187], v7 offset:14848
    s_waitcnt lgkmcnt(6)
    v_mfma_f32_16x16x32_bf16 v[72:75], a[188:191], a[8:11], v[72:75]
    v_mfma_f32_16x16x32_bf16 v[100:103], a[188:191], a[12:15], v[100:103]
    ds_read_b128 a[188:191], v7 offset:15872
    s_waitcnt lgkmcnt(6)
    v_mfma_f32_16x16x32_bf16 v[76:79], a[192:195], a[8:11], v[76:79]
    v_mfma_f32_16x16x32_bf16 v[104:107], a[192:195], a[12:15], v[104:107]
    ds_read_b128 a[192:195], v7 offset:16896
    s_waitcnt lgkmcnt(6)
    v_mfma_f32_16x16x32_bf16 v[80:83], a[8:11], a[196:199], v[80:83]
    v_mfma_f32_16x16x32_bf16 v[108:111], a[12:15], a[196:199], v[108:111]
    ds_read_b128 a[196:199], v7 offset:17920
    s_waitcnt lgkmcnt(6)
    v_mfma_f32_16x16x32_bf16 v[84:87], a[8:11], a[200:203], v[84:87]
    buffer_store_dwordx4 v[140:143], v9, s[40:43], s9 offen
    v_mfma_f32_16x16x32_bf16 v[112:115], a[12:15], a[200:203], v[112:115]
    ds_read_b128 a[200:203], v7 offset:18944
    s_waitcnt lgkmcnt(6)
    v_mfma_f32_16x16x32_bf16 v[88:91], a[204:207], a[8:11], v[88:91]
    s_add_u32 s9, s57, 0x0
    v_mfma_f32_16x16x32_bf16 v[116:119], a[204:207], a[12:15], v[116:119]
    ds_read_b128 a[204:207], v39 offset:13824
    buffer_store_dwordx4 v[140:143], v13, s[40:43], s9 offen
    s_add_u32 s8, s51, 24576
    buffer_load_dwordx4 a[132:135], v27, s[40:43], s8 offen offset:0
    s_add_u32 s8, s51, 24576
    buffer_load_dwordx4 a[136:139], v27, s[40:43], s8 offen offset:1024
    s_add_u32 s8, s51, 24576
    buffer_load_dwordx4 a[140:143], v27, s[40:43], s8 offen offset:2048
    s_waitcnt vmcnt(29)
    s_waitcnt lgkmcnt(6)
    v_mfma_f32_16x16x32_bf16 v[64:67], a[180:183], a[16:19], v[64:67]
    s_add_u32 s9, s57, 0x1000
    v_mfma_f32_16x16x32_bf16 v[92:95], a[180:183], a[20:23], v[92:95]
    ds_read_b128 a[180:183], v7 offset:20736
    s_waitcnt lgkmcnt(6)
    v_mfma_f32_16x16x32_bf16 v[68:71], a[184:187], a[16:19], v[68:71]
    v_mfma_f32_16x16x32_bf16 v[96:99], a[184:187], a[20:23], v[96:99]
    ds_read_b128 a[184:187], v7 offset:21760
    s_waitcnt lgkmcnt(6)
    v_mfma_f32_16x16x32_bf16 v[72:75], a[188:191], a[16:19], v[72:75]
    v_mfma_f32_16x16x32_bf16 v[100:103], a[188:191], a[20:23], v[100:103]
    ds_read_b128 a[188:191], v7 offset:22784
    s_waitcnt lgkmcnt(6)
    v_mfma_f32_16x16x32_bf16 v[76:79], a[192:195], a[16:19], v[76:79]
    v_mfma_f32_16x16x32_bf16 v[104:107], a[192:195], a[20:23], v[104:107]
    ds_read_b128 a[192:195], v7 offset:23808
    s_waitcnt lgkmcnt(6)
    v_mfma_f32_16x16x32_bf16 v[80:83], a[16:19], a[196:199], v[80:83]
    v_mfma_f32_16x16x32_bf16 v[108:111], a[20:23], a[196:199], v[108:111]
    ds_read_b128 a[196:199], v7 offset:24832
    s_waitcnt lgkmcnt(6)
    v_mfma_f32_16x16x32_bf16 v[84:87], a[16:19], a[200:203], v[84:87]
    buffer_store_dwordx4 v[140:143], v13, s[40:43], s9 offen
    v_mfma_f32_16x16x32_bf16 v[112:115], a[20:23], a[200:203], v[112:115]
    ds_read_b128 a[200:203], v7 offset:25856
    s_waitcnt lgkmcnt(6)
    v_mfma_f32_16x16x32_bf16 v[88:91], a[204:207], a[16:19], v[88:91]
    s_add_u32 s9, s57, 0x2000
    v_mfma_f32_16x16x32_bf16 v[116:119], a[204:207], a[20:23], v[116:119]
    ds_read_b128 a[204:207], v39 offset:20736
    buffer_store_dwordx4 v[140:143], v13, s[40:43], s9 offen
    buffer_load_dwordx4 a[80:83], v250, s[40:43], s48 offen offset:2048 sc1
    buffer_load_dwordx4 a[84:87], v250, s[40:43], s61 offen offset:2048 sc1
    s_add_u32 s8, s92, 0
    buffer_load_dwordx4 a[144:147], v27, s[40:43], s8 offen offset:0
    s_waitcnt vmcnt(32)
    s_waitcnt lgkmcnt(6)
    v_mfma_f32_16x16x32_bf16 v[64:67], a[180:183], a[24:27], v[64:67]
    s_add_u32 s9, s57, 0x3000
    v_mfma_f32_16x16x32_bf16 v[92:95], a[180:183], a[28:31], v[92:95]
    v_add_u32 v7, s53, v27
    v_add_u32 v39, s53, v8
    ds_read_b128 a[180:183], v7 offset:0
    s_waitcnt lgkmcnt(6)
    v_mfma_f32_16x16x32_bf16 v[68:71], a[184:187], a[24:27], v[68:71]
    v_mfma_f32_16x16x32_bf16 v[96:99], a[184:187], a[28:31], v[96:99]
    ds_read_b128 a[184:187], v7 offset:1024
    s_waitcnt lgkmcnt(6)
    v_mfma_f32_16x16x32_bf16 v[72:75], a[188:191], a[24:27], v[72:75]
    v_mfma_f32_16x16x32_bf16 v[100:103], a[188:191], a[28:31], v[100:103]
    ds_read_b128 a[188:191], v7 offset:2048
    s_waitcnt lgkmcnt(6)
    v_mfma_f32_16x16x32_bf16 v[76:79], a[192:195], a[24:27], v[76:79]
    v_mfma_f32_16x16x32_bf16 v[104:107], a[192:195], a[28:31], v[104:107]
    ds_read_b128 a[192:195], v7 offset:3072
    s_waitcnt lgkmcnt(6)
    v_mfma_f32_16x16x32_bf16 v[80:83], a[24:27], a[196:199], v[80:83]
    v_mfma_f32_16x16x32_bf16 v[108:111], a[28:31], a[196:199], v[108:111]
    ds_read_b128 a[196:199], v7 offset:4096
    s_waitcnt lgkmcnt(6)
    v_mfma_f32_16x16x32_bf16 v[84:87], a[24:27], a[200:203], v[84:87]
    buffer_store_dwordx4 v[140:143], v13, s[40:43], s9 offen
    v_mfma_f32_16x16x32_bf16 v[112:115], a[28:31], a[200:203], v[112:115]
    ds_read_b128 a[200:203], v7 offset:5120
    s_waitcnt lgkmcnt(6)
    v_mfma_f32_16x16x32_bf16 v[88:91], a[204:207], a[24:27], v[88:91]
    s_add_u32 s9, s57, 0x4000
    v_mfma_f32_16x16x32_bf16 v[116:119], a[204:207], a[28:31], v[116:119]
    ds_read_b128 a[204:207], v39 offset:0
    buffer_store_dwordx4 v[140:143], v13, s[40:43], s9 offen
    buffer_load_dwordx4 a[88:91], v250, s[40:43], s48 offen offset:3072 sc1
    buffer_load_dwordx4 a[92:95], v250, s[40:43], s61 offen offset:3072 sc1
    s_add_u32 s8, s92, 0
    buffer_load_dwordx4 a[148:151], v27, s[40:43], s8 offen offset:1024
    s_waitcnt vmcnt(20)
    v_cmp_ne_u64 vcc, v[30:31], v[54:55]
    s_nop 0
    s_cmp_eq_u64 vcc, 0
    s_cbranch_scc1 L_pd6_l
    s_mov_b32 s93, 0
    s_nop 1
L_pl5_l:
    s_sleep 2
    buffer_load_dwordx2 v[54:55], v15, s[40:43], s85 offen sc1
    s_waitcnt vmcnt(0)
    v_cmp_ne_u64 vcc, v[30:31], v[54:55]
    s_nop 0
    s_cmp_eq_u64 vcc, 0
    s_cbranch_scc1 L_pd6_l
    s_add_u32 s93, s93, 1
    s_cmp_lt_u32 s93, 30000
    s_cbranch_scc1 L_pl5_l
L_pd6_l:
    s_nop 0
    s_waitcnt lgkmcnt(6)
    v_mfma_f32_16x16x32_bf16 v[64:67], a[180:183], a[32:35], v[64:67]
    s_add_u32 s9, s57, 0x5000
    v_mfma_f32_16x16x32_bf16 v[92:95], a[180:183], a[36:39], v[92:95]
    ds_read_b128 a[180:183], v7 offset:6912
    s_waitcnt lgkmcnt(6)
    v_mfma_f32_16x16x32_bf16 v[68:71], a[184:187], a[32:35], v[68:71]
    v_mfma_f32_16x16x32_bf16 v[96:99], a[184:187], a[36:39], v[96:99]
    ds_read_b128 a[184:187], v7 offset:7936
    s_waitcnt lgkmcnt(6)
    v_mfma_f32_16x16x32_bf16 v[72:75], a[188:191], a[32:35], v[72:75]
    v_mfma_f32_16x16x32_bf16 v[100:103], a[188:191], a[36:39], v[100:103]
    ds_read_b128 a[188:191], v7 offset:8960
    s_waitcnt lgkmcnt(6)
    v_mfma_f32_16x16x32_bf16 v[76:79], a[192:195], a[32:35], v[76:79]
    v_mfma_f32_16x16x32_bf16 v[104:107], a[192:195], a[36:39], v[104:107]
    ds_read_b128 a[192:195], v7 offset:9984
    s_waitcnt lgkmcnt(6)
    v_mfma_f32_16x16x32_bf16 v[80:83], a[32:35], a[196:199], v[80:83]
    v_mfma_f32_16x16x32_bf16 v[108:111], a[36:39], a[196:199], v[108:111]
    ds_read_b128 a[196:199], v7 offset:11008
    s_waitcnt lgkmcnt(6)
    v_mfma_f32_16x16x32_bf16 v[84:87], a[32:35], a[200:203], v[84:87]
    buffer_store_dwordx4 v[140:143], v13, s[40:43], s9 offen
    v_mfma_f32_16x16x32_bf16 v[112:115], a[36:39], a[200:203], v[112:115]
    ds_read_b128 a[200:203], v7 offset:12032
    s_waitcnt lgkmcnt(6)
    v_mfma_f32_16x16x32_bf16 v[88:91], a[204:207], a[32:35], v[88:91]
    s_add_u32 s9, s57, 0x6000
    v_mfma_f32_16x16x32_bf16 v[116:119], a[204:207], a[36:39], v[116:119]
    ds_read_b128 a[204:207], v39 offset:6912
    buffer_store_dwordx4 v[140:143], v13, s[40:43], s9 offen
    buffer_load_dwordx4 a[96:99], v250, s[40:43], s60 offen offset:0 sc1
    buffer_load_dwordx4 a[100:103], v250, s[40:43], s62 offen offset:0 sc1
    buffer_load_dwordx4 a[208:211], v246, s[40:43], s77 offen sc1
    s_waitcnt lgkmcnt(6)
    v_mfma_f32_16x16x32_bf16 v[64:67], a[180:183], a[40:43], v[64:67]
    s_add_u32 s9, s57, 0x7000
    v_mfma_f32_16x16x32_bf16 v[92:95], a[180:183], a[44:47], v[92:95]
    ds_read_b128 a[180:183], v7 offset:13824
    s_waitcnt lgkmcnt(6)
    v_mfma_f32_16x16x32_bf16 v[68:71], a[184:187], a[40:43], v[68:71]
    v_mfma_f32_16x16x32_bf16 v[96:99], a[184:187], a[44:47], v[96:99]
    ds_read_b128 a[184:187], v7 offset:14848
    s_waitcnt lgkmcnt(6)
    v_mfma_f32_16x16x32_bf16 v[72:75], a[188:191], a[40:43], v[72:75]
    v_mfma_f32_16x16x32_bf16 v[100:103], a[188:191], a[44:47], v[100:103]
    ds_read_b128 a[188:191], v7 offset:15872
    s_waitcnt lgkmcnt(6)
    v_mfma_f32_16x16x32_bf16 v[76:79], a[192:195], a[40:43], v[76:79]
    v_mfma_f32_16x16x32_bf16 v[104:107], a[192:195], a[44:47], v[104:107]
    ds_read_b128 a[192:195], v7 offset:16896
    s_waitcnt lgkmcnt(6)
    v_mfma_f32_16x16x32_bf16 v[80:83], a[40:43], a[196:199], v[80:83]
    v_mfma_f32_16x16x32_bf16 v[108:111], a[44:47], a[196:199], v[108:111]
    ds_read_b128 a[196:199], v7 offset:17920
    s_waitcnt lgkmcnt(6)
    v_mfma_f32_16x16x32_bf16 v[84:87], a[40:43], a[200:203], v[84:87]
    buffer_store_dwordx4 v[140:143], v13, s[40:43], s9 offen
    v_mfma_f32_16x16x32_bf16 v[112:115], a[44:47], a[200:203], v[112:115]
    ds_read_b128 a[200:203], v7 offset:18944
    s_waitcnt lgkmcnt(6)
    v_mfma_f32_16x16x32_bf16 v[88:91], a[204:207], a[40:43], v[88:91]
    s_add_u32 s9, s57, 0x8000
    v_mfma_f32_16x16x32_bf16 v[116:119], a[204:207], a[44:47], v[116:119]
    ds_read_b128 a[204:207], v39 offset:13824
    buffer_store_dwordx4 v[140:143], v13, s[40:43], s9 offen
    buffer_load_dwordx4 a[104:107], v251, s[40:43], s48 offen offset:0 sc1
    buffer_load_dwordx4 a[108:111], v251, s[40:43], s61 offen offset:0 sc1
    buffer_load_dwordx4 a[212:215], v246, s[40:43], s78 offen sc1
    s_waitcnt lgkmcnt(6)
    v_mfma_f32_16x16x32_bf16 v[64:67], a[180:183], a[48:51], v[64:67]
    v_mfma_f32_16x16x32_bf16 v[92:95], a[180:183], a[52:55], v[92:95]
    ds_read_b128 a[180:183], v7 offset:20736
    s_waitcnt lgkmcnt(6)
    v_mfma_f32_16x16x32_bf16 v[68:71], a[184:187], a[48:51], v[68:71]
    v_mfma_f32_16x16x32_bf16 v[96:99], a[184:187], a[52:55], v[96:99]
    ds_read_b128 a[184:187], v7 offset:21760
    s_waitcnt lgkmcnt(6)
    v_mfma_f32_16x16x32_bf16 v[72:75], a[188:191], a[48:51], v[72:75]
    buffer_load_dwordx4 a[112:115], v251, s[40:43], s48 offen offset:1024 sc1
    v_mfma_f32_16x16x32_bf16 v[100:103], a[188:191], a[52:55], v[100:103]
    ds_read_b128 a[188:191], v7 offset:22784
    s_waitcnt lgkmcnt(6)
    v_mfma_f32_16x16x32_bf16 v[76:79], a[192:195], a[48:51], v[76:79]
    v_mfma_f32_16x16x32_bf16 v[104:107], a[192:195], a[52:55], v[104:107]
    ds_read_b128 a[192:195], v7 offset:23808
    s_waitcnt lgkmcnt(6)
    v_mfma_f32_16x16x32_bf16 v[80:83], a[48:51], a[196:199], v[80:83]
    buffer_load_dwordx4 a[116:119], v251, s[40:43], s61 offen offset:1024 sc1
    v_mfma_f32_16x16x32_bf16 v[108:111], a[52:55], a[196:199], v[108:111]
    ds_read_b128 a[196:199], v7 offset:24832
    s_waitcnt lgkmcnt(6)
    v_mfma_f32_16x16x32_bf16 v[84:87], a[48:51], a[200:203], v[84:87]
    v_mfma_f32_16x16x32_bf16 v[112:115], a[52:55], a[200:203], v[112:115]
    ds_read_b128 a[200:203], v7 offset:25856
    s_waitcnt lgkmcnt(6)
    v_mfma_f32_16x16x32_bf16 v[88:91], a[204:207], a[48:51], v[88:91]
    buffer_load_dwordx4 a[216:219], v246, s[40:43], s79 offen sc1
    v_mfma_f32_16x16x32_bf16 v[116:119], a[204:207], a[52:55], v[116:119]
    ds_read_b128 a[204:207], v39 offset:20736
    s_waitcnt lgkmcnt(6)
    v_mfma_f32_16x16x32_bf16 v[64:67], a[180:183], a[56:59], v[64:67]
    v_mfma_f32_16x16x32_bf16 v[92:95], a[180:183], a[60:63], v[92:95]
    v_add_u32 v7, s54, v27
    v_add_u32 v39, s54, v8
    ds_read_b128 a[180:183], v7 offset:0
    s_waitcnt lgkmcnt(6)
    v_mfma_f32_16x16x32_bf16 v[68:71], a[184:187], a[56:59], v[68:71]
    buffer_load_dwordx4 a[228:231], v251, s[40:43], s48 offen offset:2048 sc1
    v_mfma_f32_16x16x32_bf16 v[96:99], a[184:187], a[60:63], v[96:99]
    ds_read_b128 a[184:187], v7 offset:1024
    s_waitcnt lgkmcnt(6)
    v_mfma_f32_16x16x32_bf16 v[72:75], a[188:191], a[56:59], v[72:75]
    v_mfma_f32_16x16x32_bf16 v[100:103], a[188:191], a[60:63], v[100:103]
    ds_read_b128 a[188:191], v7 offset:2048
    s_waitcnt lgkmcnt(6)
    v_mfma_f32_16x16x32_bf16 v[76:79], a[192:195], a[56:59], v[76:79]
    buffer_load_dwordx4 a[232:235], v251, s[40:43], s61 offen offset:2048 sc1
    v_mfma_f32_16x16x32_bf16 v[104:107], a[192:195], a[60:63], v[104:107]
    ds_read_b128 a[192:195], v7 offset:3072
    s_waitcnt lgkmcnt(6)
    v_mfma_f32_16x16x32_bf16 v[80:83], a[56:59], a[196:199], v[80:83]
    v_mfma_f32_16x16x32_bf16 v[108:111], a[60:63], a[196:199], v[108:111]
    ds_read_b128 a[196:199], v7 offset:4096
    s_waitcnt lgkmcnt(6)
    v_mfma_f32_16x16x32_bf16 v[84:87], a[56:59], a[200:203], v[84:87]
    buffer_load_dwordx4 a[220:223], v246, s[40:43], s80 offen sc1
    v_mfma_f32_16x16x32_bf16 v[112:115], a[60:63], a[200:203], v[112:115]
    ds_read_b128 a[200:203], v7 offset:5120
    s_waitcnt lgkmcnt(6)
    v_mfma_f32_16x16x32_bf16 v[88:91], a[204:207], a[56:59], v[88:91]
    v_mfma_f32_16x16x32_bf16 v[116:119], a[204:207], a[60:63], v[116:119]
    ds_read_b128 a[204:207], v39 offset:0
    s_waitcnt lgkmcnt(6)
    v_mfma_f32_16x16x32_bf16 v[64:67], a[180:183], a[64:67], v[64:67]
    buffer_load_dwordx4 a[236:239], v251, s[40:43], s48 offen offset:3072 sc1
    v_mfma_f32_16x16x32_bf16 v[92:95], a[180:183], a[68:71], v[92:95]
    ds_read_b128 a[180:183], v7 offset:6912
    s_waitcnt lgkmcnt(6)
    v_mfma_f32_16x16x32_bf16 v[68:71], a[184:187], a[64:67], v[68:71]
    v_mfma_f32_16x16x32_bf16 v[96:99], a[184:187], a[68:71], v[96:99]
    ds_read_b128 a[184:187], v7 offset:7936
    s_waitcnt lgkmcnt(6)
    v_mfma_f32_16x16x32_bf16 v[72:75], a[188:191], a[64:67], v[72:75]
    buffer_load_dwordx4 a[240:243], v251, s[40:43], s61 offen offset:3072 sc1
    v_mfma_f32_16x16x32_bf16 v[100:103], a[188:191], a[68:71], v[100:103]
    ds_read_b128 a[188:191], v7 offset:8960
    s_waitcnt lgkmcnt(6)
    v_mfma_f32_16x16x32_bf16 v[76:79], a[192:195], a[64:67], v[76:79]
    v_mfma_f32_16x16x32_bf16 v[104:107], a[192:195], a[68:71], v[104:107]
    ds_read_b128 a[192:195], v7 offset:9984
    s_waitcnt lgkmcnt(6)
    v_mfma_f32_16x16x32_bf16 v[80:83], a[64:67], a[196:199], v[80:83]
    buffer_load_dwordx4 a[224:227], v247, s[40:43], s81 offen sc1
    v_mfma_f32_16x16x32_bf16 v[108:111], a[68:71], a[196:199], v[108:111]
    ds_read_b128 a[196:199], v7 offset:11008
    s_waitcnt lgkmcnt(6)
    v_mfma_f32_16x16x32_bf16 v[84:87], a[64:67], a[200:203], v[84:87]
    v_mfma_f32_16x16x32_bf16 v[112:115], a[68:71], a[200:203], v[112:115]
    ds_read_b128 a[200:203], v7 offset:12032
    s_waitcnt lgkmcnt(6)
    v_mfma_f32_16x16x32_bf16 v[88:91], a[204:207], a[64:67], v[88:91]
    v_mfma_f32_16x16x32_bf16 v[116:119], a[204:207], a[68:71], v[116:119]
    ds_read_b128 a[204:207], v39 offset:6912
    s_waitcnt lgkmcnt(6)
    v_mfma_f32_16x16x32_bf16 v[64:67], a[180:183], a[72:75], v[64:67]
    buffer_load_dwordx4 a[244:247], v251, s[40:43], s60 offen offset:0 sc1
    v_mfma_f32_16x16x32_bf16 v[92:95], a[180:183], a[76:79], v[92:95]
    ds_read_b128 a[180:183], v7 offset:13824
    s_waitcnt lgkmcnt(6)
    v_mfma_f32_16x16x32_bf16 v[68:71], a[184:187], a[72:75], v[68:71]
    v_mfma_f32_16x16x32_bf16 v[96:99], a[184:187], a[76:79], v[96:99]
    ds_read_b128 a[184:187], v7 offset:14848
    s_waitcnt lgkmcnt(6)
    v_mfma_f32_16x16x32_bf16 v[72:75], a[188:191], a[72:75], v[72:75]
    buffer_load_dwordx4 a[248:251], v251, s[40:43], s62 offen offset:0 sc1
    s_add_u32 s8, s92, 0
    v_mfma_f32_16x16x32_bf16 v[100:103], a[188:191], a[76:79], v[100:103]
    ds_read_b128 a[188:191], v7 offset:15872
    s_waitcnt lgkmcnt(6)
    v_mfma_f32_16x16x32_bf16 v[76:79], a[192:195], a[72:75], v[76:79]
    v_mfma_f32_16x16x32_bf16 v[104:107], a[192:195], a[76:79], v[104:107]
    ds_read_b128 a[192:195], v7 offset:16896
    s_waitcnt lgkmcnt(6)
    v_mfma_f32_16x16x32_bf16 v[80:83], a[72:75], a[196:199], v[80:83]
    buffer_load_dwordx4 a[152:155], v27, s[40:43], s8 offen offset:2048
    v_mfma_f32_16x16x32_bf16 v[108:111], a[76:79], a[196:199], v[108:111]
    ds_read_b128 a[196:199], v7 offset:17920
    s_waitcnt lgkmcnt(6)
    v_mfma_f32_16x16x32_bf16 v[84:87], a[72:75], a[200:203], v[84:87]
    v_mfma_f32_16x16x32_bf16 v[112:115], a[76:79], a[200:203], v[112:115]
    ds_read_b128 a[200:203], v7 offset:18944
    s_waitcnt lgkmcnt(6)
    v_mfma_f32_16x16x32_bf16 v[88:91], a[204:207], a[72:75], v[88:91]
    v_mfma_f32_16x16x32_bf16 v[116:119], a[204:207], a[76:79], v[116:119]
    ds_read_b128 a[204:207], v39 offset:13824
    s_waitcnt vmcnt(17)
    s_waitcnt lgkmcnt(6)
    v_mfma_f32_16x16x32_bf16 v[64:67], a[180:183], a[80:83], v[64:67]
    s_add_u32 s8, s92, 0
    buffer_load_dwordx4 a[156:159], v27, s[40:43], s8 offen offset:3072
    v_mfma_f32_16x16x32_bf16 v[92:95], a[180:183], a[84:87], v[92:95]
    ds_read_b128 a[180:183], v7 offset:20736
    s_waitcnt lgkmcnt(6)
    v_mfma_f32_16x16x32_bf16 v[68:71], a[184:187], a[80:83], v[68:71]
    s_add_u32 s8, s92, 4096
    v_mfma_f32_16x16x32_bf16 v[96:99], a[184:187], a[84:87], v[96:99]
    ds_read_b128 a[184:187], v7 offset:21760
    s_waitcnt lgkmcnt(6)
    v_mfma_f32_16x16x32_bf16 v[72:75], a[188:191], a[80:83], v[72:75]
    buffer_load_dwordx4 a[160:163], v27, s[40:43], s8 offen offset:0
    s_add_u32 s8, s92, 4096
    v_mfma_f32_16x16x32_bf16 v[100:103], a[188:191], a[84:87], v[100:103]
    v_mfma_f32_16x16x32_bf16 v[120:123], a[188:191], a[208:211], 0
    ds_read_b128 a[188:191], v7 offset:22784
    s_waitcnt lgkmcnt(6)
    v_mfma_f32_16x16x32_bf16 v[76:79], a[192:195], a[80:83], v[76:79]
    v_mfma_f32_16x16x32_bf16 v[104:107], a[192:195], a[84:87], v[104:107]
    buffer_load_dwordx4 a[164:167], v27, s[40:43], s8 offen offset:1024
    s_add_u32 s8, s92, 4096
    v_mfma_f32_16x16x32_bf16 v[124:127], a[192:195], a[208:211], 0
    ds_read_b128 a[192:195], v7 offset:23808
    s_waitcnt lgkmcnt(6)
    v_mfma_f32_16x16x32_bf16 v[80:83], a[80:83], a[196:199], v[80:83]
    v_mfma_f32_16x16x32_bf16 v[108:111], a[84:87], a[196:199], v[108:111]
    v_mfma_f32_16x16x32_bf16 v[128:131], a[208:211], a[196:199], 0
    ds_read_b128 a[196:199], v7 offset:24832
    s_waitcnt lgkmcnt(6)
    v_mfma_f32_16x16x32_bf16 v[84:87], a[80:83], a[200:203], v[84:87]
    buffer_load_dwordx4 a[168:171], v27, s[40:43], s8 offen offset:2048
    v_mfma_f32_16x16x32_bf16 v[112:115], a[84:87], a[200:203], v[112:115]
    v_mfma_f32_16x16x32_bf16 v[132:135], a[208:211], a[200:203], 0
    ds_read_b128 a[200:203], v7 offset:25856
    s_waitcnt lgkmcnt(6)
    v_mfma_f32_16x16x32_bf16 v[88:91], a[204:207], a[80:83], v[88:91]
    v_mfma_f32_16x16x32_bf16 v[116:119], a[204:207], a[84:87], v[116:119]
    v_mfma_f32_16x16x32_bf16 v[136:139], a[204:207], a[208:211], 0
    ds_read_b128 a[204:207], v39 offset:20736
    s_waitcnt vmcnt(16)
    s_waitcnt lgkmcnt(6)
    v_mfma_f32_16x16x32_bf16 v[64:67], a[180:183], a[88:91], v[64:67]
    s_add_u32 s8, s92, 4096
    buffer_load_dwordx4 a[172:175], v27, s[40:43], s8 offen offset:3072
    v_mfma_f32_16x16x32_bf16 v[92:95], a[180:183], a[92:95], v[92:95]
    ds_read_b128 a[180:183], v7 offset:27648
    s_waitcnt lgkmcnt(6)
    v_mfma_f32_16x16x32_bf16 v[68:71], a[184:187], a[88:91], v[68:71]
    s_add_u32 s8, s92, 8192
    v_mfma_f32_16x16x32_bf16 v[96:99], a[184:187], a[92:95], v[96:99]
    ds_read_b128 a[184:187], v7 offset:28672
    s_waitcnt lgkmcnt(6)
    v_mfma_f32_16x16x32_bf16 v[72:75], a[188:191], a[88:91], v[72:75]
    buffer_load_dwordx4 a[176:179], v27, s[40:43], s8 offen offset:0
    s_add_u32 s8, s50, 0
    v_mfma_f32_16x16x32_bf16 v[100:103], a[188:191], a[92:95], v[100:103]
    v_mfma_f32_16x16x32_bf16 v[120:123], a[188:191], a[212:215], v[120:123]
    ds_read_b128 a[188:191], v7 offset:29696
    s_waitcnt lgkmcnt(6)
    v_mfma_f32_16x16x32_bf16 v[76:79], a[192:195], a[88:91], v[76:79]
    v_mfma_f32_16x16x32_bf16 v[104:107], a[192:195], a[92:95], v[104:107]
    buffer_load_dwordx4 a[0:3], v27, s[40:43], s8 offen offset:0
    s_add_u32 s8, s50, 0
    v_mfma_f32_16x16x32_bf16 v[124:127], a[192:195], a[212:215], v[124:127]
    ds_read_b128 a[192:195], v7 offset:30720
    s_waitcnt lgkmcnt(6)
    v_mfma_f32_16x16x32_bf16 v[80:83], a[88:91], a[196:199], v[80:83]
    v_mfma_f32_16x16x32_bf16 v[108:111], a[92:95], a[196:199], v[108:111]
    v_mfma_f32_16x16x32_bf16 v[128:131], a[212:215], a[196:199], v[128:131]
    ds_read_b128 a[196:199], v7 offset:31744
    s_waitcnt lgkmcnt(6)
    v_mfma_f32_16x16x32_bf16 v[84:87], a[88:91], a[200:203], v[84:87]
    buffer_load_dwordx4 a[4:7], v27, s[40:43], s8 offen offset:1024
    s_add_u32 s9, s57, 0
    v_mfma_f32_16x16x32_bf16 v[112:115], a[92:95], a[200:203], v[112:115]
    v_mfma_f32_16x16x32_bf16 v[132:135], a[212:215], a[200:203], v[132:135]
    ds_read_b128 a[200:203], v7 offset:32768
    s_waitcnt lgkmcnt(6)
    v_mfma_f32_16x16x32_bf16 v[88:91], a[204:207], a[88:91], v[88:91]
    v_mfma_f32_16x16x32_bf16 v[116:119], a[204:207], a[92:95], v[116:119]
    buffer_load_dword v254, v253, s[40:43], s9 offen sc1
    v_mfma_f32_16x16x32_bf16 v[136:139], a[204:207], a[212:215], v[136:139]
    ds_read_b128 a[204:207], v39 offset:27648
    s_waitcnt vmcnt(18)
    s_waitcnt lgkmcnt(6)
    v_mfma_f32_16x16x32_bf16 v[64:67], a[180:183], a[96:99], v[64:67]
    s_add_u32 s8, s50, 0
    v_mfma_f32_16x16x32_bf16 v[92:95], a[180:183], a[100:103], v[92:95]
    v_add_u32 v7, s55, v27
    v_add_u32 v39, s55, v8
    ds_read_b128 a[180:183], v7 offset:0
    s_waitcnt lgkmcnt(6)
    v_mfma_f32_16x16x32_bf16 v[68:71], a[184:187], a[96:99], v[68:71]
    buffer_load_dwordx4 a[8:11], v27, s[40:43], s8 offen offset:2048
    s_add_u32 s8, s50, 0
    v_mfma_f32_16x16x32_bf16 v[96:99], a[184:187], a[100:103], v[96:99]
    ds_read_b128 a[184:187], v7 offset:1024
    s_waitcnt lgkmcnt(6)
    v_mfma_f32_16x16x32_bf16 v[72:75], a[188:191], a[96:99], v[72:75]
    v_mfma_f32_16x16x32_bf16 v[100:103], a[188:191], a[100:103], v[100:103]
    v_mfma_f32_16x16x32_bf16 v[120:123], a[188:191], a[216:219], v[120:123]
    ds_read_b128 a[188:191], v7 offset:2048
    s_waitcnt lgkmcnt(6)
    v_mfma_f32_16x16x32_bf16 v[76:79], a[192:195], a[96:99], v[76:79]
    buffer_load_dwordx4 a[12:15], v27, s[40:43], s8 offen offset:3072
    s_add_u32 s8, s50, 4096
    v_mfma_f32_16x16x32_bf16 v[104:107], a[192:195], a[100:103], v[104:107]
    v_mfma_f32_16x16x32_bf16 v[124:127], a[192:195], a[216:219], v[124:127]
    ds_read_b128 a[192:195], v7 offset:3072
    s_waitcnt lgkmcnt(6)
    v_mfma_f32_16x16x32_bf16 v[80:83], a[96:99], a[196:199], v[80:83]
    v_mfma_f32_16x16x32_bf16 v[108:111], a[100:103], a[196:199], v[108:111]
    buffer_load_dwordx4 a[16:19], v27, s[40:43], s8 offen offset:0
    s_add_u32 s8, s50, 4096
    v_mfma_f32_16x16x32_bf16 v[128:131], a[216:219], a[196:199], v[128:131]
    ds_read_b128 a[196:199], v7 offset:4096
    s_waitcnt lgkmcnt(6)
    v_mfma_f32_16x16x32_bf16 v[84:87], a[96:99], a[200:203], v[84:87]
    v_mfma_f32_16x16x32_bf16 v[112:115], a[100:103], a[200:203], v[112:115]
    v_mfma_f32_16x16x32_bf16 v[132:135], a[216:219], a[200:203], v[132:135]
    ds_read_b128 a[200:203], v7 offset:5120
    s_waitcnt lgkmcnt(6)
    v_mfma_f32_16x16x32_bf16 v[88:91], a[204:207], a[96:99], v[88:91]
    buffer_load_dwordx4 a[20:23], v27, s[40:43], s8 offen offset:1024
    v_mfma_f32_16x16x32_bf16 v[116:119], a[204:207], a[100:103], v[116:119]
    v_mfma_f32_16x16x32_bf16 v[136:139], a[204:207], a[216:219], v[136:139]
    ds_read_b128 a[204:207], v39 offset:0
    s_waitcnt vmcnt(19)
    s_waitcnt lgkmcnt(6)
    v_mfma_f32_16x16x32_bf16 v[64:67], a[180:183], a[104:107], v[64:67]
    s_add_u32 s8, s50, 4096
    v_mfma_f32_16x16x32_bf16 v[92:95], a[180:183], a[108:111], v[92:95]
    ds_read_b128 a[180:183], v7 offset:6912
    s_waitcnt lgkmcnt(6)
    v_mfma_f32_16x16x32_bf16 v[68:71], a[184:187], a[104:107], v[68:71]
    buffer_load_dwordx4 a[24:27], v27, s[40:43], s8 offen offset:2048
    s_add_u32 s8, s50, 4096
    v_mfma_f32_16x16x32_bf16 v[96:99], a[184:187], a[108:111], v[96:99]
    ds_read_b128 a[184:187], v7 offset:7936
    s_waitcnt lgkmcnt(6)
    v_mfma_f32_16x16x32_bf16 v[72:75], a[188:191], a[104:107], v[72:75]
    v_mfma_f32_16x16x32_bf16 v[100:103], a[188:191], a[108:111], v[100:103]
    v_mfma_f32_16x16x32_bf16 v[120:123], a[188:191], a[220:223], v[120:123]
    ds_read_b128 a[188:191], v7 offset:8960
    s_waitcnt lgkmcnt(6)
    v_mfma_f32_16x16x32_bf16 v[76:79], a[192:195], a[104:107], v[76:79]
    buffer_load_dwordx4 a[28:31], v27, s[40:43], s8 offen offset:3072
    s_add_u32 s8, s50, 8192
    v_mfma_f32_16x16x32_bf16 v[104:107], a[192:195], a[108:111], v[104:107]
    v_mfma_f32_16x16x32_bf16 v[124:127], a[192:195], a[220:223], v[124:127]
    ds_read_b128 a[192:195], v7 offset:9984
    s_waitcnt lgkmcnt(6)
    v_mfma_f32_16x16x32_bf16 v[80:83], a[104:107], a[196:199], v[80:83]
    v_mfma_f32_16x16x32_bf16 v[108:111], a[108:111], a[196:199], v[108:111]
    buffer_load_dwordx4 a[32:35], v27, s[40:43], s8 offen offset:0
    s_add_u32 s8, s51, 0
    v_mfma_f32_16x16x32_bf16 v[128:131], a[220:223], a[196:199], v[128:131]
    ds_read_b128 a[196:199], v7 offset:11008
    s_waitcnt lgkmcnt(6)
    v_mfma_f32_16x16x32_bf16 v[84:87], a[104:107], a[200:203], v[84:87]
    v_mfma_f32_16x16x32_bf16 v[112:115], a[108:111], a[200:203], v[112:115]
    v_mfma_f32_16x16x32_bf16 v[132:135], a[220:223], a[200:203], v[132:135]
    ds_read_b128 a[200:203], v7 offset:12032
    s_waitcnt lgkmcnt(6)
    v_mfma_f32_16x16x32_bf16 v[88:91], a[204:207], a[104:107], v[88:91]
    buffer_load_dwordx4 a[36:39], v27, s[40:43], s8 offen offset:0
    v_mfma_f32_16x16x32_bf16 v[116:119], a[204:207], a[108:111], v[116:119]
    v_mfma_f32_16x16x32_bf16 v[136:139], a[204:207], a[220:223], v[136:139]
    ds_read_b128 a[204:207], v39 offset:6912
    s_waitcnt vmcnt(20)
    s_waitcnt lgkmcnt(6)
    v_mfma_f32_16x16x32_bf16 v[64:67], a[180:183], a[112:115], v[64:67]
    v_mfma_f32_16x16x32_bf16 v[92:95], a[180:183], a[116:119], v[92:95]
    ds_read_b128 a[180:183], v7 offset:13824
    s_waitcnt lgkmcnt(6)
    v_mfma_f32_16x16x32_bf16 v[68:71], a[184:187], a[112:115], v[68:71]
    v_mfma_f32_16x16x32_bf16 v[96:99], a[184:187], a[116:119], v[96:99]
    ds_read_b128 a[184:187], v7 offset:14848
    s_waitcnt lgkmcnt(6)
    v_mfma_f32_16x16x32_bf16 v[72:75], a[188:191], a[112:115], v[72:75]
    v_mfma_f32_16x16x32_bf16 v[100:103], a[188:191], a[116:119], v[100:103]
    v_mfma_f32_16x16x32_bf16 v[120:123], a[188:191], a[224:227], v[120:123]
    ds_read_b128 a[188:191], v7 offset:15872
    s_waitcnt lgkmcnt(6)
    v_mfma_f32_16x16x32_bf16 v[76:79], a[192:195], a[112:115], v[76:79]
    v_mfma_f32_16x16x32_bf16 v[104:107], a[192:195], a[116:119], v[104:107]
    v_mfma_f32_16x16x32_bf16 v[124:127], a[192:195], a[224:227], v[124:127]
    ds_read_b128 a[192:195], v7 offset:16896
    s_waitcnt lgkmcnt(6)
    v_mfma_f32_16x16x32_bf16 v[80:83], a[112:115], a[196:199], v[80:83]
    v_mfma_f32_16x16x32_bf16 v[108:111], a[116:119], a[196:199], v[108:111]
    v_mfma_f32_16x16x32_bf16 v[128:131], a[224:227], a[196:199], v[128:131]
    ds_read_b128 a[196:199], v7 offset:17920
    s_waitcnt lgkmcnt(6)
    v_mfma_f32_16x16x32_bf16 v[84:87], a[112:115], a[200:203], v[84:87]
    v_mfma_f32_16x16x32_bf16 v[112:115], a[116:119], a[200:203], v[112:115]
    v_mfma_f32_16x16x32_bf16 v[132:135], a[224:227], a[200:203], v[132:135]
    ds_read_b128 a[200:203], v7 offset:18944
    s_waitcnt lgkmcnt(6)
    v_mfma_f32_16x16x32_bf16 v[88:91], a[204:207], a[112:115], v[88:91]
    v_mfma_f32_16x16x32_bf16 v[116:119], a[204:207], a[116:119], v[116:119]
    v_mfma_f32_16x16x32_bf16 v[136:139], a[204:207], a[224:227], v[136:139]
    ds_read_b128 a[204:207], v39 offset:13824
    s_waitcnt lgkmcnt(6)
    v_mfma_f32_16x16x32_bf16 v[64:67], a[180:183], a[228:231], v[64:67]
    ds_write_b128 v36, v[120:123] offset:0
    v_mfma_f32_16x16x32_bf16 v[92:95], a[180:183], a[232:235], v[92:95]
    ds_read_b128 a[180:183], v7 offset:20736
    s_waitcnt lgkmcnt(7)
    v_mfma_f32_16x16x32_bf16 v[68:71], a[184:187], a[228:231], v[68:71]
    ds_write_b128 v36, v[124:127] offset:4096
    v_mfma_f32_16x16x32_bf16 v[96:99], a[184:187], a[232:235], v[96:99]
    ds_read_b128 a[184:187], v7 offset:21760
    s_waitcnt lgkmcnt(8)
    v_mfma_f32_16x16x32_bf16 v[72:75], a[188:191], a[228:231], v[72:75]
    ds_write_b128 v36, v[128:131] offset:8192
    v_mfma_f32_16x16x32_bf16 v[100:103], a[188:191], a[232:235], v[100:103]
    ds_read_b128 a[188:191], v7 offset:22784
    s_waitcnt lgkmcnt(9)
    v_mfma_f32_16x16x32_bf16 v[76:79], a[192:195], a[228:231], v[76:79]
    ds_write_b128 v36, v[132:135] offset:12288
    v_mfma_f32_16x16x32_bf16 v[104:107], a[192:195], a[232:235], v[104:107]
    ds_read_b128 a[192:195], v7 offset:23808
    s_waitcnt lgkmcnt(10)
    v_mfma_f32_16x16x32_bf16 v[80:83], a[228:231], a[196:199], v[80:83]
    ds_write_b128 v36, v[136:139] offset:16384
    s_add_u32 s9, s57, 9216
    v_mfma_f32_16x16x32_bf16 v[108:111], a[232:235], a[196:199], v[108:111]
    ds_read_b128 a[196:199], v7 offset:24832
    s_waitcnt lgkmcnt(11)
    v_mfma_f32_16x16x32_bf16 v[84:87], a[228:231], a[200:203], v[84:87]
    buffer_load_dword v254, v253, s[40:43], s9 offen sc1
    v_mfma_f32_16x16x32_bf16 v[112:115], a[232:235], a[200:203], v[112:115]
    ds_read_b128 a[200:203], v7 offset:25856
    s_waitcnt lgkmcnt(11)
    v_mfma_f32_16x16x32_bf16 v[88:91], a[204:207], a[228:231], v[88:91]
    v_mfma_f32_16x16x32_bf16 v[116:119], a[204:207], a[232:235], v[116:119]
    ds_read_b128 a[204:207], v39 offset:20736
    s_waitcnt lgkmcnt(10)
    v_mfma_f32_16x16x32_bf16 v[64:67], a[180:183], a[236:239], v[64:67]
    s_waitcnt lgkmcnt(3)
    v_mfma_f32_16x16x32_bf16 v[92:95], a[180:183], a[240:243], v[92:95]
    ds_read_b128 a[180:183], v7 offset:27648
    v_mfma_f32_16x16x32_bf16 v[68:71], a[184:187], a[236:239], v[68:71]
    s_barrier
    s_cmp_lg_u32 s3, 3
    v_mfma_f32_16x16x32_bf16 v[96:99], a[184:187], a[240:243], v[96:99]
    ds_read_b128 a[184:187], v7 offset:28672
    v_mfma_f32_16x16x32_bf16 v[72:75], a[188:191], a[236:239], v[72:75]
    s_cbranch_scc1 L_nofc_l
    s_add_u32 s9, s84, 0x15b0000
    v_mul_u32_u24 v56, 4352, v1
    s_mov_b64 exec, 0xff
    buffer_store_dwordx2 v[30:31], v56, s[40:43], s9 offen sc1
    s_mov_b64 exec, -1
L_nofc_l:
    v_mfma_f32_16x16x32_bf16 v[100:103], a[188:191], a[240:243], v[100:103]
    ds_read_b128 a[188:191], v7 offset:29696
    v_mfma_f32_16x16x32_bf16 v[76:79], a[192:195], a[236:239], v[76:79]
    ds_read_b128 v[120:123], v12 offset:0
    v_mfma_f32_16x16x32_bf16 v[104:107], a[192:195], a[240:243], v[104:107]
    ds_read_b128 a[192:195], v7 offset:30720
    s_waitcnt lgkmcnt(7)
    v_mfma_f32_16x16x32_bf16 v[80:83], a[236:239], a[196:199], v[80:83]
    ds_read_b128 v[124:127], v12 offset:1024
    v_mfma_f32_16x16x32_bf16 v[108:111], a[240:243], a[196:199], v[108:111]
    ds_read_b128 a[196:199], v7 offset:31744
    s_waitcnt lgkmcnt(8)
    v_mfma_f32_16x16x32_bf16 v[84:87], a[236:239], a[200:203], v[84:87]
    ds_read_b128 v[128:131], v12 offset:2048
    v_mfma_f32_16x16x32_bf16 v[112:115], a[240:243], a[200:203], v[112:115]
    ds_read_b128 a[200:203], v7 offset:32768
    s_waitcnt lgkmcnt(9)
    v_mfma_f32_16x16x32_bf16 v[88:91], a[204:207], a[236:239], v[88:91]
    ds_read_b128 v[132:135], v12 offset:3072
    v_mfma_f32_16x16x32_bf16 v[116:119], a[204:207], a[240:243], v[116:119]
    ds_read_b128 a[204:207], v39 offset:27648
    ds_read_b128 v[220:223], v14 offset:0
    ds_read_b128 v[224:227], v14 offset:1024
    ds_read_b128 v[228:231], v14 offset:2048
    ds_read_b128 v[232:235], v14 offset:3072
    s_mov_b32 s9, 0x240000
    buffer_load_dword v254, v252, s[40:43], s9 offen sc1
    s_waitcnt vmcnt(20)
    s_waitcnt lgkmcnt(14)
    v_mfma_f32_16x16x32_bf16 v[64:67], a[180:183], a[244:247], v[64:67]
    s_waitcnt lgkmcnt(0)
    v_pk_add_f32 v[120:121], v[120:121], v[124:125]
    v_mfma_f32_16x16x32_bf16 v[92:95], a[180:183], a[248:251], v[92:95]
    v_pk_add_f32 v[128:129], v[128:129], v[132:133]
    v_mfma_f32_16x16x32_bf16 v[68:71], a[184:187], a[244:247], v[68:71]
    v_pk_add_f32 v[122:123], v[122:123], v[126:127]
    v_pk_add_f32 v[130:131], v[130:131], v[134:135]
    v_mfma_f32_16x16x32_bf16 v[96:99], a[184:187], a[248:251], v[96:99]
    v_pk_add_f32 v[220:221], v[220:221], v[224:225]
    v_mfma_f32_16x16x32_bf16 v[72:75], a[188:191], a[244:247], v[72:75]
    v_pk_add_f32 v[228:229], v[228:229], v[232:233]
    v_mfma_f32_16x16x32_bf16 v[100:103], a[188:191], a[248:251], v[100:103]
    v_pk_add_f32 v[222:223], v[222:223], v[226:227]
    v_pk_add_f32 v[230:231], v[230:231], v[234:235]
    v_mfma_f32_16x16x32_bf16 v[76:79], a[192:195], a[244:247], v[76:79]
    v_pk_add_f32 v[120:121], v[120:121], v[128:129]
    v_pk_add_f32 v[122:123], v[122:123], v[130:131]
    v_mfma_f32_16x16x32_bf16 v[104:107], a[192:195], a[248:251], v[104:107]
    v_pk_add_f32 v[220:221], v[220:221], v[228:229]
    v_pk_add_f32 v[222:223], v[222:223], v[230:231]
    v_mfma_f32_16x16x32_bf16 v[80:83], a[244:247], a[196:199], v[80:83]
    v_cvt_pk_bf16_f32 v124, v120, v121
    v_cvt_pk_bf16_f32 v125, v122, v123
    v_mfma_f32_16x16x32_bf16 v[108:111], a[248:251], a[196:199], v[108:111]
    v_cvt_pk_bf16_f32 v244, v220, v221
    v_cvt_pk_bf16_f32 v245, v222, v223
    v_mfma_f32_16x16x32_bf16 v[84:87], a[244:247], a[200:203], v[84:87]
    ds_write_b64 v35, v[124:125]
    v_mfma_f32_16x16x32_bf16 v[112:115], a[248:251], a[200:203], v[112:115]
    v_mfma_f32_16x16x32_bf16 v[88:91], a[204:207], a[244:247], v[88:91]
    v_mfma_f32_16x16x32_bf16 v[116:119], a[204:207], a[248:251], v[116:119]
    v_lshlrev_b32 v15, 5, v1
    s_add_u32 s85, s83, 0x10000
    s_nop 3
    s_branch L_attn_l
L_layer1_l:
    v_add_u32 v7, s52, v27
    v_add_u32 v39, s52, v8
    ds_read_b128 a[180:183], v7 offset:0
    ds_read_b128 a[184:187], v7 offset:1024
    ds_read_b128 a[188:191], v7 offset:2048
    ds_read_b128 a[192:195], v7 offset:3072
    ds_read_b128 a[196:199], v7 offset:4096
    ds_read_b128 a[200:203], v7 offset:5120
    ds_read_b128 a[204:207], v39 offset:0
    s_mov_b32 s93, 0
    s_nop 1
L_xp_l:
    buffer_load_dwordx4 v[140:143], v248, s[40:43], s48 offen offset:0 sc1
    buffer_load_dwordx4 v[144:147], v248, s[40:43], s61 offen offset:0 sc1
    buffer_load_dwordx4 v[148:151], v248, s[40:43], s48 offen offset:1024 sc1
    buffer_load_dwordx4 v[152:155], v248, s[40:43], s61 offen offset:1024 sc1
    buffer_load_dwordx4 v[156:159], v248, s[40:43], s48 offen offset:2048 sc1
    buffer_load_dwordx4 v[160:163], v248, s[40:43], s61 offen offset:2048 sc1
    buffer_load_dwordx4 v[164:167], v248, s[40:43], s48 offen offset:3072 sc1
    buffer_load_dwordx4 v[168:171], v248, s[40:43], s61 offen offset:3072 sc1
    v_add_u32 v249, s73, v5
    v_add_u32 v250, s74, v5
    v_add_u32 v251, s75, v5
    s_waitcnt vmcnt(0)
    v_max3_u32 v240, v140, v144, v148
    v_max3_u32 v240, v240, v152, v156
    v_max3_u32 v240, v240, v160, v164
    v_max_u32 v240, v240, v168
    v_cmp_eq_u32 vcc, -1, v240
    s_nop 0
    s_cmp_eq_u64 vcc, 0
    s_cbranch_scc1 L_sd7_l
    s_add_u32 s93, s93, 1
    s_cmp_lt_u32 s93, 30000
    s_cbranch_scc1 L_xp_l
L_sd7_l:
    s_nop 0
    s_waitcnt lgkmcnt(6)
    v_mfma_f32_16x16x32_bf16 v[64:67], a[180:183], v[140:143], 0
    buffer_load_dwordx4 v[172:175], v249, s[40:43], s48 offen offset:0 sc1
    v_mfma_f32_16x16x32_bf16 v[92:95], a[180:183], v[144:147], 0
    ds_read_b128 a[180:183], v7 offset:6912
    s_waitcnt lgkmcnt(6)
    v_mfma_f32_16x16x32_bf16 v[68:71], a[184:187], v[140:143], 0
    v_mfma_f32_16x16x32_bf16 v[96:99], a[184:187], v[144:147], 0
    ds_read_b128 a[184:187], v7 offset:7936
    s_waitcnt lgkmcnt(6)
    v_mfma_f32_16x16x32_bf16 v[72:75], a[188:191], v[140:143], 0
    buffer_load_dwordx4 v[176:179], v249, s[40:43], s61 offen offset:0 sc1
    v_mfma_f32_16x16x32_bf16 v[100:103], a[188:191], v[144:147], 0
    ds_read_b128 a[188:191], v7 offset:8960
    s_waitcnt lgkmcnt(6)
    v_mfma_f32_16x16x32_bf16 v[76:79], a[192:195], v[140:143], 0
    v_mfma_f32_16x16x32_bf16 v[104:107], a[192:195], v[144:147], 0
    ds_read_b128 a[192:195], v7 offset:9984
    s_waitcnt lgkmcnt(6)
    v_mfma_f32_16x16x32_bf16 v[80:83], v[140:143], a[196:199], 0
    buffer_load_dwordx4 v[180:183], v249, s[40:43], s48 offen offset:1024 sc1
    v_mfma_f32_16x16x32_bf16 v[108:111], v[144:147], a[196:199], 0
    ds_read_b128 a[196:199], v7 offset:11008
    s_waitcnt lgkmcnt(6)
    v_mfma_f32_16x16x32_bf16 v[84:87], v[140:143], a[200:203], 0
    v_mfma_f32_16x16x32_bf16 v[112:115], v[144:147], a[200:203], 0
    ds_read_b128 a[200:203], v7 offset:12032
    s_waitcnt lgkmcnt(6)
    v_mfma_f32_16x16x32_bf16 v[88:91], a[204:207], v[140:143], 0
    v_mfma_f32_16x16x32_bf16 v[116:119], a[204:207], v[144:147], 0
    ds_read_b128 a[204:207], v39 offset:6912
    s_waitcnt lgkmcnt(6)
    v_mfma_f32_16x16x32_bf16 v[64:67], a[180:183], v[148:151], v[64:67]
    buffer_load_dwordx4 v[184:187], v249, s[40:43], s61 offen offset:1024 sc1
    v_mfma_f32_16x16x32_bf16 v[92:95], a[180:183], v[152:155], v[92:95]
    ds_read_b128 a[180:183], v7 offset:13824
    s_waitcnt lgkmcnt(6)
    v_mfma_f32_16x16x32_bf16 v[68:71], a[184:187], v[148:151], v[68:71]
    v_mfma_f32_16x16x32_bf16 v[96:99], a[184:187], v[152:155], v[96:99]
    ds_read_b128 a[184:187], v7 offset:14848
    s_waitcnt lgkmcnt(6)
    v_mfma_f32_16x16x32_bf16 v[72:75], a[188:191], v[148:151], v[72:75]
    buffer_load_dwordx4 v[188:191], v249, s[40:43], s48 offen offset:2048 sc1
    v_mfma_f32_16x16x32_bf16 v[100:103], a[188:191], v[152:155], v[100:103]
    ds_read_b128 a[188:191], v7 offset:15872
    s_waitcnt lgkmcnt(6)
    v_mfma_f32_16x16x32_bf16 v[76:79], a[192:195], v[148:151], v[76:79]
    v_mfma_f32_16x16x32_bf16 v[104:107], a[192:195], v[152:155], v[104:107]
    ds_read_b128 a[192:195], v7 offset:16896
    s_waitcnt lgkmcnt(6)
    v_mfma_f32_16x16x32_bf16 v[80:83], v[148:151], a[196:199], v[80:83]
    buffer_load_dwordx4 v[192:195], v249, s[40:43], s61 offen offset:2048 sc1
    v_mfma_f32_16x16x32_bf16 v[108:111], v[152:155], a[196:199], v[108:111]
    ds_read_b128 a[196:199], v7 offset:17920
    s_waitcnt lgkmcnt(6)
    v_mfma_f32_16x16x32_bf16 v[84:87], v[148:151], a[200:203], v[84:87]
    v_mfma_f32_16x16x32_bf16 v[112:115], v[152:155], a[200:203], v[112:115]
    ds_read_b128 a[200:203], v7 offset:18944
    s_waitcnt lgkmcnt(6)
    v_mfma_f32_16x16x32_bf16 v[88:91], a[204:207], v[148:151], v[88:91]
    v_mfma_f32_16x16x32_bf16 v[116:119], a[204:207], v[152:155], v[116:119]
    ds_read_b128 a[204:207], v39 offset:13824
    s_waitcnt lgkmcnt(6)
    v_mfma_f32_16x16x32_bf16 v[64:67], a[180:183], v[156:159], v[64:67]
    buffer_load_dwordx4 v[196:199], v249, s[40:43], s48 offen offset:3072 sc1
    v_mfma_f32_16x16x32_bf16 v[92:95], a[180:183], v[160:163], v[92:95]
    ds_read_b128 a[180:183], v7 offset:20736
    s_waitcnt lgkmcnt(6)
    v_mfma_f32_16x16x32_bf16 v[68:71], a[184:187], v[156:159], v[68:71]
    v_mfma_f32_16x16x32_bf16 v[96:99], a[184:187], v[160:163], v[96:99]
    ds_read_b128 a[184:187], v7 offset:21760
    s_waitcnt lgkmcnt(6)
    v_mfma_f32_16x16x32_bf16 v[72:75], a[188:191], v[156:159], v[72:75]
    buffer_load_dwordx4 v[200:203], v249, s[40:43], s61 offen offset:3072 sc1
    v_mfma_f32_16x16x32_bf16 v[100:103], a[188:191], v[160:163], v[100:103]
    ds_read_b128 a[188:191], v7 offset:22784
    s_waitcnt lgkmcnt(6)
    v_mfma_f32_16x16x32_bf16 v[76:79], a[192:195], v[156:159], v[76:79]
    v_mfma_f32_16x16x32_bf16 v[104:107], a[192:195], v[160:163], v[104:107]
    ds_read_b128 a[192:195], v7 offset:23808
    s_waitcnt lgkmcnt(6)
    v_mfma_f32_16x16x32_bf16 v[80:83], v[156:159], a[196:199], v[80:83]
    buffer_load_dwordx4 v[204:207], v250, s[40:43], s48 offen offset:0 sc1
    v_mfma_f32_16x16x32_bf16 v[108:111], v[160:163], a[196:199], v[108:111]
    ds_read_b128 a[196:199], v7 offset:24832
    s_waitcnt lgkmcnt(6)
    v_mfma_f32_16x16x32_bf16 v[84:87], v[156:159], a[200:203], v[84:87]
    v_mfma_f32_16x16x32_bf16 v[112:115], v[160:163], a[200:203], v[112:115]
    ds_read_b128 a[200:203], v7 offset:25856
    s_waitcnt lgkmcnt(6)
    v_mfma_f32_16x16x32_bf16 v[88:91], a[204:207], v[156:159], v[88:91]
    v_mfma_f32_16x16x32_bf16 v[116:119], a[204:207], v[160:163], v[116:119]
    ds_read_b128 a[204:207], v39 offset:20736
    s_waitcnt lgkmcnt(6)
    v_mfma_f32_16x16x32_bf16 v[64:67], a[180:183], v[164:167], v[64:67]
    buffer_load_dwordx4 v[220:223], v6, s[40:43], s77 offen sc1
    v_mfma_f32_16x16x32_bf16 v[92:95], a[180:183], v[168:171], v[92:95]
    v_add_u32 v7, s53, v27
    v_add_u32 v39, s53, v8
    ds_read_b128 a[180:183], v7 offset:0
    s_waitcnt lgkmcnt(6)
    v_mfma_f32_16x16x32_bf16 v[68:71], a[184:187], v[164:167], v[68:71]
    v_mfma_f32_16x16x32_bf16 v[96:99], a[184:187], v[168:171], v[96:99]
    ds_read_b128 a[184:187], v7 offset:1024
    s_waitcnt lgkmcnt(6)
    v_mfma_f32_16x16x32_bf16 v[72:75], a[188:191], v[164:167], v[72:75]
    buffer_load_dwordx4 v[208:211], v250, s[40:43], s61 offen offset:0 sc1
    v_mfma_f32_16x16x32_bf16 v[100:103], a[188:191], v[168:171], v[100:103]
    ds_read_b128 a[188:191], v7 offset:2048
    s_waitcnt lgkmcnt(6)
    v_mfma_f32_16x16x32_bf16 v[76:79], a[192:195], v[164:167], v[76:79]
    v_mfma_f32_16x16x32_bf16 v[104:107], a[192:195], v[168:171], v[104:107]
    ds_read_b128 a[192:195], v7 offset:3072
    s_waitcnt lgkmcnt(6)
    v_mfma_f32_16x16x32_bf16 v[80:83], v[164:167], a[196:199], v[80:83]
    buffer_load_dwordx4 v[212:215], v250, s[40:43], s48 offen offset:1024 sc1
    s_waitcnt vmcnt(10)
    v_mfma_f32_16x16x32_bf16 v[108:111], v[168:171], a[196:199], v[108:111]
    ds_read_b128 a[196:199], v7 offset:4096
    s_waitcnt lgkmcnt(6)
    v_mfma_f32_16x16x32_bf16 v[84:87], v[164:167], a[200:203], v[84:87]
    v_max_u32 v240, v172, v176
    v_cmp_eq_u32 vcc, -1, v240
    v_mfma_f32_16x16x32_bf16 v[112:115], v[168:171], a[200:203], v[112:115]
    ds_read_b128 a[200:203], v7 offset:5120
    s_waitcnt lgkmcnt(6)
    v_mfma_f32_16x16x32_bf16 v[88:91], a[204:207], v[164:167], v[88:91]
    s_cbranch_vccnz L_xs4_l
L_xr4_l:
    v_mfma_f32_16x16x32_bf16 v[116:119], a[204:207], v[168:171], v[116:119]
    ds_read_b128 a[204:207], v39 offset:0
    s_waitcnt lgkmcnt(6)
    v_mfma_f32_16x16x32_bf16 v[64:67], a[180:183], v[172:175], v[64:67]
    buffer_load_dwordx4 v[224:227], v6, s[40:43], s78 offen sc1
    v_mfma_f32_16x16x32_bf16 v[92:95], a[180:183], v[176:179], v[92:95]
    ds_read_b128 a[180:183], v7 offset:6912
    s_waitcnt lgkmcnt(6)
    v_mfma_f32_16x16x32_bf16 v[68:71], a[184:187], v[172:175], v[68:71]
    v_mfma_f32_16x16x32_bf16 v[96:99], a[184:187], v[176:179], v[96:99]
    ds_read_b128 a[184:187], v7 offset:7936
    s_waitcnt lgkmcnt(6)
    v_mfma_f32_16x16x32_bf16 v[72:75], a[188:191], v[172:175], v[72:75]
    buffer_load_dwordx4 v[216:219], v250, s[40:43], s61 offen offset:1024 sc1
    v_mfma_f32_16x16x32_bf16 v[100:103], a[188:191], v[176:179], v[100:103]
    ds_read_b128 a[188:191], v7 offset:8960
    s_waitcnt lgkmcnt(6)
    v_mfma_f32_16x16x32_bf16 v[76:79], a[192:195], v[172:175], v[76:79]
    v_mfma_f32_16x16x32_bf16 v[104:107], a[192:195], v[176:179], v[104:107]
    ds_read_b128 a[192:195], v7 offset:9984
    s_waitcnt lgkmcnt(6)
    v_mfma_f32_16x16x32_bf16 v[80:83], v[172:175], a[196:199], v[80:83]
    buffer_load_dwordx4 v[140:143], v250, s[40:43], s48 offen offset:2048 sc1
    s_waitcnt vmcnt(11)
    v_mfma_f32_16x16x32_bf16 v[108:111], v[176:179], a[196:199], v[108:111]
    ds_read_b128 a[196:199], v7 offset:11008
    s_waitcnt lgkmcnt(6)
    v_mfma_f32_16x16x32_bf16 v[84:87], v[172:175], a[200:203], v[84:87]
    v_max_u32 v240, v180, v184
    v_cmp_eq_u32 vcc, -1, v240
    v_mfma_f32_16x16x32_bf16 v[112:115], v[176:179], a[200:203], v[112:115]
    ds_read_b128 a[200:203], v7 offset:12032
    s_waitcnt lgkmcnt(6)
    v_mfma_f32_16x16x32_bf16 v[88:91], a[204:207], v[172:175], v[88:91]
    s_cbranch_vccnz L_xs5_l
L_xr5_l:
    v_mfma_f32_16x16x32_bf16 v[116:119], a[204:207], v[176:179], v[116:119]
    ds_read_b128 a[204:207], v39 offset:6912
    s_waitcnt lgkmcnt(6)
    v_mfma_f32_16x16x32_bf16 v[64:67], a[180:183], v[180:183], v[64:67]
    buffer_load_dwordx4 v[228:231], v6, s[40:43], s79 offen sc1
    v_mfma_f32_16x16x32_bf16 v[92:95], a[180:183], v[184:187], v[92:95]
    ds_read_b128 a[180:183], v7 offset:13824
    s_waitcnt lgkmcnt(6)
    v_mfma_f32_16x16x32_bf16 v[68:71], a[184:187], v[180:183], v[68:71]
    v_mfma_f32_16x16x32_bf16 v[96:99], a[184:187], v[184:187], v[96:99]
    ds_read_b128 a[184:187], v7 offset:14848
    s_waitcnt lgkmcnt(6)
    v_mfma_f32_16x16x32_bf16 v[72:75], a[188:191], v[180:183], v[72:75]
    buffer_load_dwordx4 v[144:147], v250, s[40:43], s61 offen offset:2048 sc1
    v_mfma_f32_16x16x32_bf16 v[100:103], a[188:191], v[184:187], v[100:103]
    ds_read_b128 a[188:191], v7 offset:15872
    s_waitcnt lgkmcnt(6)
    v_mfma_f32_16x16x32_bf16 v[76:79], a[192:195], v[180:183], v[76:79]
    v_mfma_f32_16x16x32_bf16 v[104:107], a[192:195], v[184:187], v[104:107]
    ds_read_b128 a[192:195], v7 offset:16896
    s_waitcnt lgkmcnt(6)
    v_mfma_f32_16x16x32_bf16 v[80:83], v[180:183], a[196:199], v[80:83]
    buffer_load_dwordx4 v[148:151], v250, s[40:43], s48 offen offset:3072 sc1
    s_waitcnt vmcnt(12)
    v_mfma_f32_16x16x32_bf16 v[108:111], v[184:187], a[196:199], v[108:111]
    ds_read_b128 a[196:199], v7 offset:17920
    s_waitcnt lgkmcnt(6)
    v_mfma_f32_16x16x32_bf16 v[84:87], v[180:183], a[200:203], v[84:87]
    v_max_u32 v240, v188, v192
    v_cmp_eq_u32 vcc, -1, v240
    v_mfma_f32_16x16x32_bf16 v[112:115], v[184:187], a[200:203], v[112:115]
    ds_read_b128 a[200:203], v7 offset:18944
    s_waitcnt lgkmcnt(6)
    v_mfma_f32_16x16x32_bf16 v[88:91], a[204:207], v[180:183], v[88:91]
    s_cbranch_vccnz L_xs6_l
L_xr6_l:
    v_mfma_f32_16x16x32_bf16 v[116:119], a[204:207], v[184:187], v[116:119]
    ds_read_b128 a[204:207], v39 offset:13824
    s_waitcnt lgkmcnt(6)
    v_mfma_f32_16x16x32_bf16 v[64:67], a[180:183], v[188:191], v[64:67]
    buffer_load_dwordx4 v[232:235], v6, s[40:43], s80 offen sc1
    v_mfma_f32_16x16x32_bf16 v[92:95], a[180:183], v[192:195], v[92:95]
    ds_read_b128 a[180:183], v7 offset:20736
    s_waitcnt lgkmcnt(6)
    v_mfma_f32_16x16x32_bf16 v[68:71], a[184:187], v[188:191], v[68:71]
    v_mfma_f32_16x16x32_bf16 v[96:99], a[184:187], v[192:195], v[96:99]
    ds_read_b128 a[184:187], v7 offset:21760
    s_waitcnt lgkmcnt(6)
    v_mfma_f32_16x16x32_bf16 v[72:75], a[188:191], v[188:191], v[72:75]
    buffer_load_dwordx4 v[152:155], v250, s[40:43], s61 offen offset:3072 sc1
    v_mfma_f32_16x16x32_bf16 v[100:103], a[188:191], v[192:195], v[100:103]
    ds_read_b128 a[188:191], v7 offset:22784
    s_waitcnt lgkmcnt(6)
    v_mfma_f32_16x16x32_bf16 v[76:79], a[192:195], v[188:191], v[76:79]
    v_mfma_f32_16x16x32_bf16 v[104:107], a[192:195], v[192:195], v[104:107]
    ds_read_b128 a[192:195], v7 offset:23808
    s_waitcnt lgkmcnt(6)
    v_mfma_f32_16x16x32_bf16 v[80:83], v[188:191], a[196:199], v[80:83]
    buffer_load_dwordx4 v[156:159], v250, s[40:43], s60 offen offset:0 sc1
    s_waitcnt vmcnt(13)
    v_mfma_f32_16x16x32_bf16 v[108:111], v[192:195], a[196:199], v[108:111]
    ds_read_b128 a[196:199], v7 offset:24832
    s_waitcnt lgkmcnt(6)
    v_mfma_f32_16x16x32_bf16 v[84:87], v[188:191], a[200:203], v[84:87]
    v_max_u32 v240, v196, v200
    v_cmp_eq_u32 vcc, -1, v240
    v_mfma_f32_16x16x32_bf16 v[112:115], v[192:195], a[200:203], v[112:115]
    ds_read_b128 a[200:203], v7 offset:25856
    s_waitcnt lgkmcnt(6)
    v_mfma_f32_16x16x32_bf16 v[88:91], a[204:207], v[188:191], v[88:91]
    s_cbranch_vccnz L_xs7_l
L_xr7_l:
    v_mfma_f32_16x16x32_bf16 v[116:119], a[204:207], v[192:195], v[116:119]
    ds_read_b128 a[204:207], v39 offset:20736
    s_waitcnt lgkmcnt(6)
    v_mfma_f32_16x16x32_bf16 v[64:67], a[180:183], v[196:199], v[64:67]
    buffer_load_dwordx4 v[236:239], v10, s[40:43], s81 offen sc1
    v_mfma_f32_16x16x32_bf16 v[92:95], a[180:183], v[200:203], v[92:95]
    v_add_u32 v7, s54, v27
    v_add_u32 v39, s54, v8
    ds_read_b128 a[180:183], v7 offset:0
    s_waitcnt lgkmcnt(6)
    v_mfma_f32_16x16x32_bf16 v[68:71], a[184:187], v[196:199], v[68:71]
    v_mfma_f32_16x16x32_bf16 v[96:99], a[184:187], v[200:203], v[96:99]
    ds_read_b128 a[184:187], v7 offset:1024
    s_waitcnt lgkmcnt(6)
    v_mfma_f32_16x16x32_bf16 v[72:75], a[188:191], v[196:199], v[72:75]
    buffer_load_dwordx4 v[160:163], v250, s[40:43], s62 offen offset:0 sc1
    v_mfma_f32_16x16x32_bf16 v[100:103], a[188:191], v[200:203], v[100:103]
    ds_read_b128 a[188:191], v7 offset:2048
    s_waitcnt lgkmcnt(6)
    v_mfma_f32_16x16x32_bf16 v[76:79], a[192:195], v[196:199], v[76:79]
    v_mfma_f32_16x16x32_bf16 v[104:107], a[192:195], v[200:203], v[104:107]
    ds_read_b128 a[192:195], v7 offset:3072
    s_waitcnt lgkmcnt(6)
    v_mfma_f32_16x16x32_bf16 v[80:83], v[196:199], a[196:199], v[80:83]
    buffer_load_dwordx4 v[164:167], v251, s[40:43], s48 offen offset:0 sc1
    s_waitcnt vmcnt(13)
    v_mfma_f32_16x16x32_bf16 v[108:111], v[200:203], a[196:199], v[108:111]
    ds_read_b128 a[196:199], v7 offset:4096
    s_waitcnt lgkmcnt(6)
    v_mfma_f32_16x16x32_bf16 v[84:87], v[196:199], a[200:203], v[84:87]
    v_max_u32 v240, v204, v208
    v_cmp_eq_u32 vcc, -1, v240
    v_mfma_f32_16x16x32_bf16 v[112:115], v[200:203], a[200:203], v[112:115]
    ds_read_b128 a[200:203], v7 offset:5120
    s_waitcnt lgkmcnt(6)
    v_mfma_f32_16x16x32_bf16 v[88:91], a[204:207], v[196:199], v[88:91]
    s_cbranch_vccnz L_xs8_l
L_xr8_l:
    v_mfma_f32_16x16x32_bf16 v[116:119], a[204:207], v[200:203], v[116:119]
    ds_read_b128 a[204:207], v39 offset:0
    s_waitcnt lgkmcnt(6)
    v_mfma_f32_16x16x32_bf16 v[64:67], a[180:183], v[204:207], v[64:67]
    buffer_load_dwordx4 v[168:171], v251, s[40:43], s61 offen offset:0 sc1
    v_mfma_f32_16x16x32_bf16 v[92:95], a[180:183], v[208:211], v[92:95]
    ds_read_b128 a[180:183], v7 offset:6912
    s_waitcnt lgkmcnt(6)
    v_mfma_f32_16x16x32_bf16 v[68:71], a[184:187], v[204:207], v[68:71]
    v_mfma_f32_16x16x32_bf16 v[96:99], a[184:187], v[208:211], v[96:99]
    ds_read_b128 a[184:187], v7 offset:7936
    s_waitcnt lgkmcnt(6)
    v_mfma_f32_16x16x32_bf16 v[72:75], a[188:191], v[204:207], v[72:75]
    buffer_load_dwordx4 v[172:175], v251, s[40:43], s48 offen offset:1024 sc1
    v_mfma_f32_16x16x32_bf16 v[100:103], a[188:191], v[208:211], v[100:103]
    ds_read_b128 a[188:191], v7 offset:8960
    s_waitcnt lgkmcnt(6)
    v_mfma_f32_16x16x32_bf16 v[76:79], a[192:195], v[204:207], v[76:79]
    v_mfma_f32_16x16x32_bf16 v[104:107], a[192:195], v[208:211], v[104:107]
    ds_read_b128 a[192:195], v7 offset:9984
    s_waitcnt lgkmcnt(6)
    v_mfma_f32_16x16x32_bf16 v[80:83], v[204:207], a[196:199], v[80:83]
    buffer_load_dwordx4 v[176:179], v251, s[40:43], s61 offen offset:1024 sc1
    s_waitcnt vmcnt(13)
    v_mfma_f32_16x16x32_bf16 v[108:111], v[208:211], a[196:199], v[108:111]
    ds_read_b128 a[196:199], v7 offset:11008
    s_waitcnt lgkmcnt(6)
    v_mfma_f32_16x16x32_bf16 v[84:87], v[204:207], a[200:203], v[84:87]
    v_max_u32 v240, v212, v216
    v_cmp_eq_u32 vcc, -1, v240
    v_mfma_f32_16x16x32_bf16 v[112:115], v[208:211], a[200:203], v[112:115]
    ds_read_b128 a[200:203], v7 offset:12032
    s_waitcnt lgkmcnt(6)
    v_mfma_f32_16x16x32_bf16 v[88:91], a[204:207], v[204:207], v[88:91]
    s_cbranch_vccnz L_xs9_l
L_xr9_l:
    v_mfma_f32_16x16x32_bf16 v[116:119], a[204:207], v[208:211], v[116:119]
    ds_read_b128 a[204:207], v39 offset:6912
    s_waitcnt lgkmcnt(6)
    v_mfma_f32_16x16x32_bf16 v[64:67], a[180:183], v[212:215], v[64:67]
    buffer_load_dwordx4 v[180:183], v251, s[40:43], s48 offen offset:2048 sc1
    v_mfma_f32_16x16x32_bf16 v[92:95], a[180:183], v[216:219], v[92:95]
    ds_read_b128 a[180:183], v7 offset:13824
    s_waitcnt lgkmcnt(6)
    v_mfma_f32_16x16x32_bf16 v[68:71], a[184:187], v[212:215], v[68:71]
    v_mfma_f32_16x16x32_bf16 v[96:99], a[184:187], v[216:219], v[96:99]
    ds_read_b128 a[184:187], v7 offset:14848
    s_waitcnt lgkmcnt(6)
    v_mfma_f32_16x16x32_bf16 v[72:75], a[188:191], v[212:215], v[72:75]
    buffer_load_dwordx4 v[184:187], v251, s[40:43], s61 offen offset:2048 sc1
    v_mfma_f32_16x16x32_bf16 v[100:103], a[188:191], v[216:219], v[100:103]
    ds_read_b128 a[188:191], v7 offset:15872
    s_waitcnt lgkmcnt(6)
    v_mfma_f32_16x16x32_bf16 v[76:79], a[192:195], v[212:215], v[76:79]
    v_mfma_f32_16x16x32_bf16 v[104:107], a[192:195], v[216:219], v[104:107]
    ds_read_b128 a[192:195], v7 offset:16896
    s_waitcnt lgkmcnt(6)
    v_mfma_f32_16x16x32_bf16 v[80:83], v[212:215], a[196:199], v[80:83]
    buffer_load_dwordx4 v[188:191], v251, s[40:43], s48 offen offset:3072 sc1
    s_waitcnt vmcnt(13)
    v_mfma_f32_16x16x32_bf16 v[108:111], v[216:219], a[196:199], v[108:111]
    ds_read_b128 a[196:199], v7 offset:17920
    s_waitcnt lgkmcnt(6)
    v_mfma_f32_16x16x32_bf16 v[84:87], v[212:215], a[200:203], v[84:87]
    v_max3_u32 v240, v140, v144, v220
    v_cmp_eq_u32 vcc, -1, v240
    v_mfma_f32_16x16x32_bf16 v[112:115], v[216:219], a[200:203], v[112:115]
    ds_read_b128 a[200:203], v7 offset:18944
    s_waitcnt lgkmcnt(6)
    v_mfma_f32_16x16x32_bf16 v[88:91], a[204:207], v[212:215], v[88:91]
    s_cbranch_vccnz L_xs10_l
L_xr10_l:
    v_mfma_f32_16x16x32_bf16 v[116:119], a[204:207], v[216:219], v[116:119]
    ds_read_b128 a[204:207], v39 offset:13824
    s_waitcnt lgkmcnt(6)
    v_mfma_f32_16x16x32_bf16 v[64:67], a[180:183], v[140:143], v[64:67]
    buffer_load_dwordx4 v[192:195], v251, s[40:43], s61 offen offset:3072 sc1
    v_mfma_f32_16x16x32_bf16 v[92:95], a[180:183], v[144:147], v[92:95]
    ds_read_b128 a[180:183], v7 offset:20736
    s_waitcnt lgkmcnt(6)
    v_mfma_f32_16x16x32_bf16 v[68:71], a[184:187], v[140:143], v[68:71]
    v_mfma_f32_16x16x32_bf16 v[96:99], a[184:187], v[144:147], v[96:99]
    ds_read_b128 a[184:187], v7 offset:21760
    s_waitcnt lgkmcnt(6)
    v_mfma_f32_16x16x32_bf16 v[72:75], a[188:191], v[140:143], v[72:75]
    buffer_load_dwordx4 v[196:199], v251, s[40:43], s60 offen offset:0 sc1
    v_mfma_f32_16x16x32_bf16 v[100:103], a[188:191], v[144:147], v[100:103]
    v_mfma_f32_16x16x32_bf16 v[120:123], a[188:191], v[220:223], 0
    ds_read_b128 a[188:191], v7 offset:22784
    s_waitcnt lgkmcnt(6)
    v_mfma_f32_16x16x32_bf16 v[76:79], a[192:195], v[140:143], v[76:79]
    v_mfma_f32_16x16x32_bf16 v[104:107], a[192:195], v[144:147], v[104:107]
    buffer_load_dwordx4 v[200:203], v251, s[40:43], s62 offen offset:0 sc1
    v_mfma_f32_16x16x32_bf16 v[124:127], a[192:195], v[220:223], 0
    ds_read_b128 a[192:195], v7 offset:23808
    s_waitcnt lgkmcnt(6)
    v_mfma_f32_16x16x32_bf16 v[80:83], v[140:143], a[196:199], v[80:83]
    s_waitcnt vmcnt(13)
    v_max3_u32 v240, v148, v152, v224
    v_mfma_f32_16x16x32_bf16 v[108:111], v[144:147], a[196:199], v[108:111]
    v_cmp_eq_u32 vcc, -1, v240
    v_mfma_f32_16x16x32_bf16 v[128:131], v[220:223], a[196:199], 0
    ds_read_b128 a[196:199], v7 offset:24832
    s_waitcnt lgkmcnt(6)
    v_mfma_f32_16x16x32_bf16 v[84:87], v[140:143], a[200:203], v[84:87]
    s_cbranch_vccnz L_xs11_l
L_xr11_l:
    v_mfma_f32_16x16x32_bf16 v[112:115], v[144:147], a[200:203], v[112:115]
    v_mfma_f32_16x16x32_bf16 v[132:135], v[220:223], a[200:203], 0
    ds_read_b128 a[200:203], v7 offset:25856
    s_waitcnt lgkmcnt(6)
    v_mfma_f32_16x16x32_bf16 v[88:91], a[204:207], v[140:143], v[88:91]
    v_mfma_f32_16x16x32_bf16 v[116:119], a[204:207], v[144:147], v[116:119]
    v_mfma_f32_16x16x32_bf16 v[136:139], a[204:207], v[220:223], 0
    ds_read_b128 a[204:207], v39 offset:20736
    s_waitcnt lgkmcnt(6)
    v_mfma_f32_16x16x32_bf16 v[64:67], a[180:183], v[148:151], v[64:67]
    v_mfma_f32_16x16x32_bf16 v[92:95], a[180:183], v[152:155], v[92:95]
    ds_read_b128 a[180:183], v7 offset:27648
    s_waitcnt lgkmcnt(6)
    v_mfma_f32_16x16x32_bf16 v[68:71], a[184:187], v[148:151], v[68:71]
    v_mfma_f32_16x16x32_bf16 v[96:99], a[184:187], v[152:155], v[96:99]
    ds_read_b128 a[184:187], v7 offset:28672
    s_waitcnt lgkmcnt(6)
    v_mfma_f32_16x16x32_bf16 v[72:75], a[188:191], v[148:151], v[72:75]
    v_mfma_f32_16x16x32_bf16 v[100:103], a[188:191], v[152:155], v[100:103]
    v_mfma_f32_16x16x32_bf16 v[120:123], a[188:191], v[224:227], v[120:123]
    ds_read_b128 a[188:191], v7 offset:29696
    s_waitcnt lgkmcnt(6)
    v_mfma_f32_16x16x32_bf16 v[76:79], a[192:195], v[148:151], v[76:79]
    v_mfma_f32_16x16x32_bf16 v[104:107], a[192:195], v[152:155], v[104:107]
    v_mfma_f32_16x16x32_bf16 v[124:127], a[192:195], v[224:227], v[124:127]
    ds_read_b128 a[192:195], v7 offset:30720
    s_waitcnt lgkmcnt(6)
    v_mfma_f32_16x16x32_bf16 v[80:83], v[148:151], a[196:199], v[80:83]
    s_waitcnt vmcnt(10)
    v_max3_u32 v240, v156, v160, v228
    v_mfma_f32_16x16x32_bf16 v[108:111], v[152:155], a[196:199], v[108:111]
    v_cmp_eq_u32 vcc, -1, v240
    v_mfma_f32_16x16x32_bf16 v[128:131], v[224:227], a[196:199], v[128:131]
    ds_read_b128 a[196:199], v7 offset:31744
    s_waitcnt lgkmcnt(6)
    v_mfma_f32_16x16x32_bf16 v[84:87], v[148:151], a[200:203], v[84:87]
    s_cbranch_vccnz L_xs12_l
L_xr12_l:
    v_mfma_f32_16x16x32_bf16 v[112:115], v[152:155], a[200:203], v[112:115]
    v_mfma_f32_16x16x32_bf16 v[132:135], v[224:227], a[200:203], v[132:135]
    ds_read_b128 a[200:203], v7 offset:32768
    s_waitcnt lgkmcnt(6)
    v_mfma_f32_16x16x32_bf16 v[88:91], a[204:207], v[148:151], v[88:91]
    v_mfma_f32_16x16x32_bf16 v[116:119], a[204:207], v[152:155], v[116:119]
    v_mfma_f32_16x16x32_bf16 v[136:139], a[204:207], v[224:227], v[136:139]
    ds_read_b128 a[204:207], v39 offset:27648
    s_waitcnt lgkmcnt(6)
    v_mfma_f32_16x16x32_bf16 v[64:67], a[180:183], v[156:159], v[64:67]
    s_add_u32 s9, s57, 27648
    buffer_load_dword v254, v253, s[40:43], s9 offen sc1
    v_mfma_f32_16x16x32_bf16 v[92:95], a[180:183], v[160:163], v[92:95]
    v_add_u32 v7, s55, v27
    v_add_u32 v39, s55, v8
    ds_read_b128 a[180:183], v7 offset:0
    s_waitcnt lgkmcnt(6)
    v_mfma_f32_16x16x32_bf16 v[68:71], a[184:187], v[156:159], v[68:71]
    v_mfma_f32_16x16x32_bf16 v[96:99], a[184:187], v[160:163], v[96:99]
    ds_read_b128 a[184:187], v7 offset:1024
    s_waitcnt lgkmcnt(6)
    v_mfma_f32_16x16x32_bf16 v[72:75], a[188:191], v[156:159], v[72:75]
    v_mfma_f32_16x16x32_bf16 v[100:103], a[188:191], v[160:163], v[100:103]
    v_mfma_f32_16x16x32_bf16 v[120:123], a[188:191], v[228:231], v[120:123]
    ds_read_b128 a[188:191], v7 offset:2048
    s_waitcnt lgkmcnt(6)
    v_mfma_f32_16x16x32_bf16 v[76:79], a[192:195], v[156:159], v[76:79]
    v_mfma_f32_16x16x32_bf16 v[104:107], a[192:195], v[160:163], v[104:107]
    v_mfma_f32_16x16x32_bf16 v[124:127], a[192:195], v[228:231], v[124:127]
    ds_read_b128 a[192:195], v7 offset:3072
    s_waitcnt lgkmcnt(6)
    v_mfma_f32_16x16x32_bf16 v[80:83], v[156:159], a[196:199], v[80:83]
    s_waitcnt vmcnt(9)
    v_max3_u32 v240, v164, v168, v232
    v_mfma_f32_16x16x32_bf16 v[108:111], v[160:163], a[196:199], v[108:111]
    v_cmp_eq_u32 vcc, -1, v240
    v_mfma_f32_16x16x32_bf16 v[128:131], v[228:231], a[196:199], v[128:131]
    ds_read_b128 a[196:199], v7 offset:4096
    s_waitcnt lgkmcnt(6)
    v_mfma_f32_16x16x32_bf16 v[84:87], v[156:159], a[200:203], v[84:87]
    s_cbranch_vccnz L_xs13_l
L_xr13_l:
    v_mfma_f32_16x16x32_bf16 v[112:115], v[160:163], a[200:203], v[112:115]
    v_mfma_f32_16x16x32_bf16 v[132:135], v[228:231], a[200:203], v[132:135]
    ds_read_b128 a[200:203], v7 offset:5120
    s_waitcnt lgkmcnt(6)
    v_mfma_f32_16x16x32_bf16 v[88:91], a[204:207], v[156:159], v[88:91]
    v_mfma_f32_16x16x32_bf16 v[116:119], a[204:207], v[160:163], v[116:119]
    v_mfma_f32_16x16x32_bf16 v[136:139], a[204:207], v[228:231], v[136:139]
    ds_read_b128 a[204:207], v39 offset:0
    s_waitcnt lgkmcnt(6)
    v_mfma_f32_16x16x32_bf16 v[64:67], a[180:183], v[164:167], v[64:67]
    v_mfma_f32_16x16x32_bf16 v[92:95], a[180:183], v[168:171], v[92:95]
    ds_read_b128 a[180:183], v7 offset:6912
    s_waitcnt lgkmcnt(6)
    v_mfma_f32_16x16x32_bf16 v[68:71], a[184:187], v[164:167], v[68:71]
    v_mfma_f32_16x16x32_bf16 v[96:99], a[184:187], v[168:171], v[96:99]
    ds_read_b128 a[184:187], v7 offset:7936
    s_waitcnt lgkmcnt(6)
    v_mfma_f32_16x16x32_bf16 v[72:75], a[188:191], v[164:167], v[72:75]
    v_mfma_f32_16x16x32_bf16 v[100:103], a[188:191], v[168:171], v[100:103]
    v_mfma_f32_16x16x32_bf16 v[120:123], a[188:191], v[232:235], v[120:123]
    ds_read_b128 a[188:191], v7 offset:8960
    s_waitcnt lgkmcnt(6)
    v_mfma_f32_16x16x32_bf16 v[76:79], a[192:195], v[164:167], v[76:79]
    v_mfma_f32_16x16x32_bf16 v[104:107], a[192:195], v[168:171], v[104:107]
    v_mfma_f32_16x16x32_bf16 v[124:127], a[192:195], v[232:235], v[124:127]
    ds_read_b128 a[192:195], v7 offset:9984
    s_waitcnt lgkmcnt(6)
    v_mfma_f32_16x16x32_bf16 v[80:83], v[164:167], a[196:199], v[80:83]
    s_waitcnt vmcnt(7)
    v_max3_u32 v240, v172, v176, v236
    v_mfma_f32_16x16x32_bf16 v[108:111], v[168:171], a[196:199], v[108:111]
    v_cmp_eq_u32 vcc, -1, v240
    v_mfma_f32_16x16x32_bf16 v[128:131], v[232:235], a[196:199], v[128:131]
    ds_read_b128 a[196:199], v7 offset:11008
    s_waitcnt lgkmcnt(6)
    v_mfma_f32_16x16x32_bf16 v[84:87], v[164:167], a[200:203], v[84:87]
    s_cbranch_vccnz L_xs14_l
L_xr14_l:
    v_mfma_f32_16x16x32_bf16 v[112:115], v[168:171], a[200:203], v[112:115]
    v_mfma_f32_16x16x32_bf16 v[132:135], v[232:235], a[200:203], v[132:135]
    ds_read_b128 a[200:203], v7 offset:12032
    s_waitcnt lgkmcnt(6)
    v_mfma_f32_16x16x32_bf16 v[88:91], a[204:207], v[164:167], v[88:91]
    v_mfma_f32_16x16x32_bf16 v[116:119], a[204:207], v[168:171], v[116:119]
    v_mfma_f32_16x16x32_bf16 v[136:139], a[204:207], v[232:235], v[136:139]
    ds_read_b128 a[204:207], v39 offset:6912
    s_waitcnt lgkmcnt(6)
    v_mfma_f32_16x16x32_bf16 v[64:67], a[180:183], v[172:175], v[64:67]
    v_mfma_f32_16x16x32_bf16 v[92:95], a[180:183], v[176:179], v[92:95]
    ds_read_b128 a[180:183], v7 offset:13824
    s_waitcnt lgkmcnt(6)
    v_mfma_f32_16x16x32_bf16 v[68:71], a[184:187], v[172:175], v[68:71]
    v_mfma_f32_16x16x32_bf16 v[96:99], a[184:187], v[176:179], v[96:99]
    ds_read_b128 a[184:187], v7 offset:14848
    s_waitcnt lgkmcnt(6)
    v_mfma_f32_16x16x32_bf16 v[72:75], a[188:191], v[172:175], v[72:75]
    v_mfma_f32_16x16x32_bf16 v[100:103], a[188:191], v[176:179], v[100:103]
    v_mfma_f32_16x16x32_bf16 v[120:123], a[188:191], v[236:239], v[120:123]
    ds_read_b128 a[188:191], v7 offset:15872
    s_waitcnt lgkmcnt(6)
    v_mfma_f32_16x16x32_bf16 v[76:79], a[192:195], v[172:175], v[76:79]
    v_mfma_f32_16x16x32_bf16 v[104:107], a[192:195], v[176:179], v[104:107]
    v_mfma_f32_16x16x32_bf16 v[124:127], a[192:195], v[236:239], v[124:127]
    ds_read_b128 a[192:195], v7 offset:16896
    s_waitcnt lgkmcnt(6)
    v_mfma_f32_16x16x32_bf16 v[80:83], v[172:175], a[196:199], v[80:83]
    s_waitcnt vmcnt(5)
    v_max_u32 v240, v180, v184
    v_mfma_f32_16x16x32_bf16 v[108:111], v[176:179], a[196:199], v[108:111]
    v_cmp_eq_u32 vcc, -1, v240
    v_mfma_f32_16x16x32_bf16 v[128:131], v[236:239], a[196:199], v[128:131]
    ds_read_b128 a[196:199], v7 offset:17920
    s_waitcnt lgkmcnt(6)
    v_mfma_f32_16x16x32_bf16 v[84:87], v[172:175], a[200:203], v[84:87]
    s_cbranch_vccnz L_xs15_l
L_xr15_l:
    v_mfma_f32_16x16x32_bf16 v[112:115], v[176:179], a[200:203], v[112:115]
    v_mfma_f32_16x16x32_bf16 v[132:135], v[236:239], a[200:203], v[132:135]
    ds_read_b128 a[200:203], v7 offset:18944
    s_waitcnt lgkmcnt(6)
    v_mfma_f32_16x16x32_bf16 v[88:91], a[204:207], v[172:175], v[88:91]
    v_mfma_f32_16x16x32_bf16 v[116:119], a[204:207], v[176:179], v[116:119]
    v_mfma_f32_16x16x32_bf16 v[136:139], a[204:207], v[236:239], v[136:139]
    ds_read_b128 a[204:207], v39 offset:13824
    s_waitcnt lgkmcnt(6)
    v_mfma_f32_16x16x32_bf16 v[64:67], a[180:183], v[180:183], v[64:67]
    ds_write_b128 v36, v[120:123] offset:0
    v_mfma_f32_16x16x32_bf16 v[92:95], a[180:183], v[184:187], v[92:95]
    ds_read_b128 a[180:183], v7 offset:20736
    s_waitcnt lgkmcnt(7)
    v_mfma_f32_16x16x32_bf16 v[68:71], a[184:187], v[180:183], v[68:71]
    ds_write_b128 v36, v[124:127] offset:4096
    v_mfma_f32_16x16x32_bf16 v[96:99], a[184:187], v[184:187], v[96:99]
    ds_read_b128 a[184:187], v7 offset:21760
    s_waitcnt lgkmcnt(8)
    v_mfma_f32_16x16x32_bf16 v[72:75], a[188:191], v[180:183], v[72:75]
    ds_write_b128 v36, v[128:131] offset:8192
    v_mfma_f32_16x16x32_bf16 v[100:103], a[188:191], v[184:187], v[100:103]
    ds_read_b128 a[188:191], v7 offset:22784
    s_waitcnt lgkmcnt(9)
    v_mfma_f32_16x16x32_bf16 v[76:79], a[192:195], v[180:183], v[76:79]
    ds_write_b128 v36, v[132:135] offset:12288
    v_mfma_f32_16x16x32_bf16 v[104:107], a[192:195], v[184:187], v[104:107]
    ds_read_b128 a[192:195], v7 offset:23808
    s_waitcnt lgkmcnt(10)
    v_mfma_f32_16x16x32_bf16 v[80:83], v[180:183], a[196:199], v[80:83]
    ds_write_b128 v36, v[136:139] offset:16384
    s_waitcnt vmcnt(3)
    v_mfma_f32_16x16x32_bf16 v[108:111], v[184:187], a[196:199], v[108:111]
    ds_read_b128 a[196:199], v7 offset:24832
    s_waitcnt lgkmcnt(11)
    v_mfma_f32_16x16x32_bf16 v[84:87], v[180:183], a[200:203], v[84:87]
    v_max_u32 v240, v188, v192
    v_cmp_eq_u32 vcc, -1, v240
    v_mfma_f32_16x16x32_bf16 v[112:115], v[184:187], a[200:203], v[112:115]
    ds_read_b128 a[200:203], v7 offset:25856
    s_waitcnt lgkmcnt(11)
    v_mfma_f32_16x16x32_bf16 v[88:91], a[204:207], v[180:183], v[88:91]
    s_cbranch_vccnz L_xs16_l
L_xr16_l:
    v_mfma_f32_16x16x32_bf16 v[116:119], a[204:207], v[184:187], v[116:119]
    ds_read_b128 a[204:207], v39 offset:20736
    s_waitcnt lgkmcnt(10)
    v_mfma_f32_16x16x32_bf16 v[64:67], a[180:183], v[188:191], v[64:67]
    s_waitcnt lgkmcnt(3)
    s_barrier
    v_mfma_f32_16x16x32_bf16 v[92:95], a[180:183], v[192:195], v[92:95]
    ds_read_b128 a[180:183], v7 offset:27648
    v_mfma_f32_16x16x32_bf16 v[68:71], a[184:187], v[188:191], v[68:71]
    ds_read_b128 v[120:123], v12 offset:0
    v_mfma_f32_16x16x32_bf16 v[96:99], a[184:187], v[192:195], v[96:99]
    ds_read_b128 a[184:187], v7 offset:28672
    v_mfma_f32_16x16x32_bf16 v[72:75], a[188:191], v[188:191], v[72:75]
    ds_read_b128 v[124:127], v12 offset:1024
    v_mfma_f32_16x16x32_bf16 v[100:103], a[188:191], v[192:195], v[100:103]
    ds_read_b128 a[188:191], v7 offset:29696
    v_mfma_f32_16x16x32_bf16 v[76:79], a[192:195], v[188:191], v[76:79]
    ds_read_b128 v[128:131], v12 offset:2048
    v_mfma_f32_16x16x32_bf16 v[104:107], a[192:195], v[192:195], v[104:107]
    ds_read_b128 a[192:195], v7 offset:30720
    s_waitcnt lgkmcnt(9)
    v_mfma_f32_16x16x32_bf16 v[80:83], v[188:191], a[196:199], v[80:83]
    ds_read_b128 v[132:135], v12 offset:3072
    v_mfma_f32_16x16x32_bf16 v[108:111], v[192:195], a[196:199], v[108:111]
    ds_read_b128 a[196:199], v7 offset:31744
    s_waitcnt lgkmcnt(10)
    v_mfma_f32_16x16x32_bf16 v[84:87], v[188:191], a[200:203], v[84:87]
    ds_read_b128 v[220:223], v14 offset:0
    v_mfma_f32_16x16x32_bf16 v[112:115], v[192:195], a[200:203], v[112:115]
    ds_read_b128 a[200:203], v7 offset:32768
    s_waitcnt lgkmcnt(11)
    v_mfma_f32_16x16x32_bf16 v[88:91], a[204:207], v[188:191], v[88:91]
    ds_read_b128 v[224:227], v14 offset:1024
    v_mfma_f32_16x16x32_bf16 v[116:119], a[204:207], v[192:195], v[116:119]
    ds_read_b128 a[204:207], v39 offset:27648
    ds_read_b128 v[228:231], v14 offset:2048
    ds_read_b128 v[232:235], v14 offset:3072
    s_waitcnt vmcnt(1)
    v_max_u32 v240, v196, v200
    v_cmp_eq_u32 vcc, -1, v240
    s_cbranch_vccnz L_xs17_l
L_xr17_l:
    s_waitcnt lgkmcnt(14)
    v_mfma_f32_16x16x32_bf16 v[64:67], a[180:183], v[196:199], v[64:67]
    s_waitcnt lgkmcnt(0)
    v_pk_add_f32 v[120:121], v[120:121], v[124:125]
    v_mfma_f32_16x16x32_bf16 v[92:95], a[180:183], v[200:203], v[92:95]
    v_pk_add_f32 v[128:129], v[128:129], v[132:133]
    v_mfma_f32_16x16x32_bf16 v[68:71], a[184:187], v[196:199], v[68:71]
    v_pk_add_f32 v[122:123], v[122:123], v[126:127]
    v_pk_add_f32 v[130:131], v[130:131], v[134:135]
    v_mfma_f32_16x16x32_bf16 v[96:99], a[184:187], v[200:203], v[96:99]
    v_pk_add_f32 v[220:221], v[220:221], v[224:225]
    v_mfma_f32_16x16x32_bf16 v[72:75], a[188:191], v[196:199], v[72:75]
    v_pk_add_f32 v[228:229], v[228:229], v[232:233]
    v_mfma_f32_16x16x32_bf16 v[100:103], a[188:191], v[200:203], v[100:103]
    v_pk_add_f32 v[222:223], v[222:223], v[226:227]
    v_pk_add_f32 v[230:231], v[230:231], v[234:235]
    v_mfma_f32_16x16x32_bf16 v[76:79], a[192:195], v[196:199], v[76:79]
    v_pk_add_f32 v[120:121], v[120:121], v[128:129]
    v_pk_add_f32 v[122:123], v[122:123], v[130:131]
    v_mfma_f32_16x16x32_bf16 v[104:107], a[192:195], v[200:203], v[104:107]
    v_pk_add_f32 v[220:221], v[220:221], v[228:229]
    v_pk_add_f32 v[222:223], v[222:223], v[230:231]
    v_mfma_f32_16x16x32_bf16 v[80:83], v[196:199], a[196:199], v[80:83]
    v_cvt_pk_bf16_f32 v124, v120, v121
    v_cvt_pk_bf16_f32 v125, v122, v123
    v_mfma_f32_16x16x32_bf16 v[108:111], v[200:203], a[196:199], v[108:111]
    v_cvt_pk_bf16_f32 v244, v220, v221
    v_cvt_pk_bf16_f32 v245, v222, v223
    v_mfma_f32_16x16x32_bf16 v[84:87], v[196:199], a[200:203], v[84:87]
    ds_write_b64 v35, v[124:125]
    s_or_b32 s8, s5, s3
    v_mfma_f32_16x16x32_bf16 v[112:115], v[200:203], a[200:203], v[112:115]
    s_cmp_lg_u32 s8, 0
    v_mfma_f32_16x16x32_bf16 v[88:91], a[204:207], v[196:199], v[88:91]
    s_cbranch_scc1 L_nowb_l
    buffer_wbl2 sc1
L_nowb_l:
    v_mfma_f32_16x16x32_bf16 v[116:119], a[204:207], v[200:203], v[116:119]
    s_nop 3
L_attn_l:
    v_mov_b32 v196, v244
    v_mov_b32 v197, v245
    v_mov_b32 v190, 0
    v_mov_b32 v191, 0
    v_mov_b32 v194, 0
    v_mov_b32 v195, 0
    v_mov_b32 v198, 0
    v_mov_b32 v199, 0
    v_cvt_pk_bf16_f32 v192, v116, v117
    v_cvt_pk_bf16_f32 v193, v118, v119
    v_cvt_pk_bf16_f32 v188, v88, v89
    v_cvt_pk_bf16_f32 v189, v90, v91
    v_mfma_f32_16x16x32_bf16 v[216:219], v[196:199], v[40:43], 0
    v_mfma_f32_16x16x32_bf16 v[212:215], v[192:195], v[40:43], 0
    v_mfma_f32_16x16x32_bf16 v[208:211], v[188:191], v[40:43], 0
    s_cmp_lg_u32 s98, 0
    s_cbranch_scc1 L_wo8_l
    s_add_u32 s8, s51, 0
    buffer_load_dwordx4 a[40:43], v27, s[40:43], s8 offen offset:1024
    s_add_u32 s8, s51, 0
    buffer_load_dwordx4 a[44:47], v27, s[40:43], s8 offen offset:2048
    s_add_u32 s8, s51, 0
    buffer_load_dwordx4 a[48:51], v27, s[40:43], s8 offen offset:3072
    s_add_u32 s8, s51, 4096
    buffer_load_dwordx4 a[52:55], v27, s[40:43], s8 offen offset:0
L_wo8_l:
    v_cvt_pk_bf16_f32 v136, v92, v93
    v_cvt_pk_bf16_f32 v137, v94, v95
    v_cvt_pk_bf16_f32 v160, v100, v101
    v_cvt_pk_bf16_f32 v161, v102, v103
    v_mov_b32 v138, v192
    v_mov_b32 v162, v192
    s_nop 1
    v_permlane16_swap_b32 v138, v162
    v_cndmask_b32 v138, 0, v138, s[90:91]
    v_mov_b32 v139, 0
    v_mov_b32 v163, 0
    v_cvt_pk_bf16_f32 v172, v108, v109
    v_cvt_pk_bf16_f32 v173, v110, v111
    s_cmp_lg_u32 s98, 0
    s_cbranch_scc1 L_wo9_l
    s_add_u32 s8, s51, 4096
    buffer_load_dwordx4 a[56:59], v27, s[40:43], s8 offen offset:1024
    s_add_u32 s8, s51, 4096
    buffer_load_dwordx4 a[60:63], v27, s[40:43], s8 offen offset:2048
    s_add_u32 s8, s51, 4096
    buffer_load_dwordx4 a[64:67], v27, s[40:43], s8 offen offset:3072
    s_add_u32 s8, s51, 8192
    buffer_load_dwordx4 a[68:71], v27, s[40:43], s8 offen offset:0
L_wo9_l:
    v_cvt_pk_bf16_f32 v140, v96, v97
    v_cvt_pk_bf16_f32 v141, v98, v99
    v_cvt_pk_bf16_f32 v164, v104, v105
    v_cvt_pk_bf16_f32 v165, v106, v107
    v_mov_b32 v142, v193
    v_mov_b32 v166, v193
    s_nop 1
    v_permlane16_swap_b32 v142, v166
    v_cndmask_b32 v142, 0, v142, s[90:91]
    v_mov_b32 v143, 0
    v_mov_b32 v167, 0
    v_cvt_pk_bf16_f32 v178, v112, v113
    v_cvt_pk_bf16_f32 v179, v114, v115
    v_mov_b32 v204, v196
    v_mov_b32 v202, v196
    s_nop 1
    v_permlane16_swap_b32 v204, v202
    v_mov_b32 v147, 0
    v_mov_b32 v205, v197
    v_mov_b32 v203, v197
    s_nop 1
    v_permlane16_swap_b32 v205, v203
    v_mov_b32 v151, 0
    v_cvt_pk_bf16_f32 v184, v212, v213
    v_cvt_pk_bf16_f32 v185, v214, v215
    v_cvt_pk_bf16_f32 v216, v216, v217
    v_cvt_pk_bf16_f32 v217, v218, v219
    v_mov_b32 v204, v162
    v_mov_b32 v205, v166
    ds_write_b64 v34, v[160:161] offset:0
    ds_write_b64 v34, v[164:165] offset:512
    ds_write_b64 v34, v[172:173] offset:1024
    ds_write_b64 v34, v[178:179] offset:1536
    ds_write_b64 v34, v[184:185] offset:2048
    ds_write_b64 v34, v[204:205] offset:2560
    ds_write_b64 v37, v[216:217] offset:2048
    ds_write_b64 v37, v[202:203] offset:2560
    s_cmp_lg_u32 s98, 0
    s_cbranch_scc1 L_wo10_l
    s_add_u32 s8, s50, 16384
    buffer_load_dwordx4 a[72:75], v27, s[40:43], s8 offen offset:2048
    s_add_u32 s8, s50, 16384
    buffer_load_dwordx4 a[76:79], v27, s[40:43], s8 offen offset:3072
    s_add_u32 s8, s50, 20480
    buffer_load_dwordx4 a[80:83], v27, s[40:43], s8 offen offset:0
    s_add_u32 s8, s50, 20480
    buffer_load_dwordx4 a[84:87], v27, s[40:43], s8 offen offset:1024
L_wo10_l:
    v_cvt_pk_bf16_f32 v128, v64, v65
    v_cvt_pk_bf16_f32 v129, v66, v67
    v_cvt_pk_bf16_f32 v152, v72, v73
    v_cvt_pk_bf16_f32 v153, v74, v75
    v_mov_b32 v130, v188
    v_mov_b32 v154, v188
    s_nop 1
    v_permlane16_swap_b32 v130, v154
    v_cndmask_b32 v130, 0, v130, s[90:91]
    v_mov_b32 v131, 0
    v_mov_b32 v155, 0
    v_cvt_pk_bf16_f32 v170, v80, v81
    v_cvt_pk_bf16_f32 v171, v82, v83
    s_cmp_lg_u32 s98, 0
    s_cbranch_scc1 L_wo11_l
    s_add_u32 s8, s50, 20480
    buffer_load_dwordx4 a[88:91], v27, s[40:43], s8 offen offset:2048
    s_add_u32 s8, s50, 20480
    buffer_load_dwordx4 a[92:95], v27, s[40:43], s8 offen offset:3072
    s_add_u32 s8, s50, 24576
    buffer_load_dwordx4 a[96:99], v27, s[40:43], s8 offen offset:0
    s_add_u32 s8, s50, 24576
    buffer_load_dwordx4 a[100:103], v27, s[40:43], s8 offen offset:1024
L_wo11_l:
    v_cvt_pk_bf16_f32 v132, v68, v69
    v_cvt_pk_bf16_f32 v133, v70, v71
    v_cvt_pk_bf16_f32 v156, v76, v77
    v_cvt_pk_bf16_f32 v157, v78, v79
    v_mov_b32 v134, v189
    v_mov_b32 v158, v189
    s_nop 1
    v_permlane16_swap_b32 v134, v158
    v_cndmask_b32 v134, 0, v134, s[90:91]
    v_mov_b32 v135, 0
    v_mov_b32 v159, 0
    v_cvt_pk_bf16_f32 v176, v84, v85
    v_cvt_pk_bf16_f32 v177, v86, v87
    v_cvt_pk_bf16_f32 v182, v208, v209
    v_cvt_pk_bf16_f32 v183, v210, v211
    v_mfma_f32_16x16x32_bf16 v[84:87], v[160:163], v[136:139], 0
    v_mfma_f32_16x16x32_bf16 v[92:95], v[164:167], v[140:143], 0
    v_mfma_f32_16x16x32_bf16 v[68:71], v[152:155], v[128:131], 0
    v_mfma_f32_16x16x32_bf16 v[76:79], v[156:159], v[132:135], 0
    v_mfma_f32_16x16x32_bf16 v[80:83], v[152:155], v[136:139], 0
    v_mfma_f32_16x16x32_bf16 v[88:91], v[156:159], v[140:143], 0
    s_cmp_lg_u32 s98, 0
    s_cbranch_scc1 L_wo12_l
    s_add_u32 s8, s50, 24576
    buffer_load_dwordx4 a[104:107], v27, s[40:43], s8 offen offset:2048
    s_add_u32 s8, s51, 16384
    buffer_load_dwordx4 a[108:111], v27, s[40:43], s8 offen offset:2048
    s_add_u32 s8, s51, 16384
    buffer_load_dwordx4 a[112:115], v27, s[40:43], s8 offen offset:3072
    s_add_u32 s8, s51, 20480
    buffer_load_dwordx4 a[116:119], v27, s[40:43], s8 offen offset:0
L_wo12_l:
    s_waitcnt lgkmcnt(0)
    s_barrier
    ds_read_b64 v[144:145], v38 offset:0
    ds_read_b64 v[148:149], v38 offset:512
    ds_read_b64 v[204:205], v38 offset:2560
    ds_read_b64 v[168:169], v38 offset:1024
    ds_read_b64 v[174:175], v38 offset:1536
    ds_read_b64 v[180:181], v38 offset:2048
    v_mov_b32 v100, 0xf149f2ca
    v_accvgpr_read_b32 v120, a252
    v_accvgpr_read_b32 v121, a253
    v_accvgpr_read_b32 v122, a254
    v_accvgpr_read_b32 v123, a255
    s_waitcnt lgkmcnt(3)
    v_mov_b32 v146, v204
    v_mov_b32 v150, v205
    s_nop 0
    v_mfma_f32_16x16x32_bf16 v[64:67], v[144:147], v[128:131], 0
    v_mfma_f32_16x16x32_bf16 v[72:75], v[148:151], v[132:135], 0
    v_cndmask_b32 v84, v100, v84, s[16:17]
    v_cndmask_b32 v85, v100, v85, s[18:19]
    v_cndmask_b32 v86, v100, v86, s[20:21]
    v_cndmask_b32 v87, v100, v87, s[22:23]
    v_cndmask_b32 v92, v100, v92, s[16:17]
    v_cndmask_b32 v93, v100, v93, s[18:19]
    v_cndmask_b32 v94, v100, v94, s[20:21]
    v_cndmask_b32 v95, v100, v95, s[22:23]
    v_cndmask_b32 v84, v84, v80, s[24:25]
    v_cndmask_b32 v85, v85, v81, s[26:27]
    v_cndmask_b32 v86, v86, v82, s[28:29]
    v_cndmask_b32 v87, v87, v83, s[30:31]
    v_cndmask_b32 v92, v92, v88, s[24:25]
    v_cndmask_b32 v93, v93, v89, s[26:27]
    v_cndmask_b32 v94, v94, v90, s[28:29]
    v_cndmask_b32 v95, v95, v91, s[30:31]
    v_cvt_pk_bf16_f32 v84, 0, v84
    v_cvt_pk_bf16_f32 v85, 0, v85
    v_cvt_pk_bf16_f32 v86, 0, v86
    v_cvt_pk_bf16_f32 v87, 0, v87
    v_cvt_pk_bf16_f32 v92, 0, v92
    v_cvt_pk_bf16_f32 v93, 0, v93
    v_cvt_pk_bf16_f32 v94, 0, v94
    v_cvt_pk_bf16_f32 v95, 0, v95
    v_pk_mul_f32 v[84:85], v[84:85], s[96:97]
    v_pk_mul_f32 v[86:87], v[86:87], s[96:97]
    v_pk_mul_f32 v[92:93], v[92:93], s[96:97]
    v_pk_mul_f32 v[94:95], v[94:95], s[96:97]
    v_cvt_pk_bf16_f32 v84, 0, v84
    v_cvt_pk_bf16_f32 v85, 0, v85
    v_cvt_pk_bf16_f32 v86, 0, v86
    v_cvt_pk_bf16_f32 v87, 0, v87
    v_cvt_pk_bf16_f32 v92, 0, v92
    v_cvt_pk_bf16_f32 v93, 0, v93
    v_cvt_pk_bf16_f32 v94, 0, v94
    v_cvt_pk_bf16_f32 v95, 0, v95
    v_max3_f32 v102, v84, v85, v86
    v_max3_f32 v108, v92, v93, v94
    v_max_f32 v102, v102, v87
    v_max_f32 v108, v108, v95
    s_nop 1
    v_permlane16_swap_b32 v102, v108
    v_max_f32 v102, v102, v108
    v_mov_b32 v108, v102
    s_nop 1
    v_permlane32_swap_b32 v102, v108
    v_max_f32 v102, v102, v108
    v_mul_f32 v102, -s94, v102
    v_mov_b32 v108, v102
    s_nop 1
    v_permlane16_swap_b32 v102, v108
    v_pk_fma_f32 v[84:85], v[84:85], s[94:95], v[102:103] op_sel_hi:[1,1,0]
    v_pk_fma_f32 v[86:87], v[86:87], s[94:95], v[102:103] op_sel_hi:[1,1,0]
    v_pk_fma_f32 v[92:93], v[92:93], s[94:95], v[108:109] op_sel_hi:[1,1,0]
    v_pk_fma_f32 v[94:95], v[94:95], s[94:95], v[108:109] op_sel_hi:[1,1,0]
    v_exp_f32 v84, v84
    v_exp_f32 v85, v85
    v_exp_f32 v86, v86
    v_exp_f32 v87, v87
    v_exp_f32 v92, v92
    v_exp_f32 v93, v93
    v_exp_f32 v94, v94
    v_exp_f32 v95, v95
    v_pk_add_f32 v[102:103], v[84:85], v[86:87]
    v_pk_add_f32 v[108:109], v[92:93], v[94:95]
    v_add_f32 v102, v102, v103
    v_add_f32 v108, v108, v109
    s_nop 1
    v_permlane16_swap_b32 v102, v108
    v_add_f32 v102, v102, v108
    v_mov_b32 v108, v102
    s_nop 1
    v_permlane32_swap_b32 v102, v108
    v_add_f32 v102, v102, v108
    v_rcp_f32 v102, v102
    s_nop 0
    v_mov_b32 v108, v102
    s_nop 1
    v_permlane16_swap_b32 v102, v108
    v_pk_mul_f32 v[84:85], v[84:85], v[102:103] op_sel_hi:[1,0]
    v_pk_mul_f32 v[86:87], v[86:87], v[102:103] op_sel_hi:[1,0]
    v_pk_mul_f32 v[92:93], v[92:93], v[108:109] op_sel_hi:[1,0]
    v_pk_mul_f32 v[94:95], v[94:95], v[108:109] op_sel_hi:[1,0]
    v_cvt_pk_bf16_f32 v218, v84, v85
    v_cvt_pk_bf16_f32 v219, v86, v87
    v_cvt_pk_bf16_f32 v222, v92, v93
    v_cvt_pk_bf16_f32 v223, v94, v95
    v_and_b32 v216, v122, v218
    v_and_b32 v217, v123, v219
    v_and_b32 v220, v122, v222
    v_and_b32 v221, v123, v223
    v_bfi_b32 v218, v122, 0, v218
    v_bfi_b32 v219, v123, 0, v219
    v_bfi_b32 v222, v122, 0, v222
    v_bfi_b32 v223, v123, 0, v223
    s_cmp_lg_u32 s98, 0
    s_cbranch_scc1 L_fc_ni_l
    buffer_load_dwordx4 v[54:57], v15, s[40:43], s85 offen sc1
    buffer_load_dwordx4 v[58:61], v15, s[40:43], s85 offen offset:16 sc1
L_fc_ni_l:
    v_mfma_f32_16x16x32_bf16 v[232:235], v[170:173], v[216:219], 0
    v_mfma_f32_16x16x32_bf16 v[112:115], v[182:185], v[216:219], 0
    v_mfma_f32_16x16x32_bf16 v[236:239], v[176:179], v[220:223], 0
    v_mfma_f32_16x16x32_bf16 v[116:119], v[182:185], v[220:223], 0
    s_nop 4
    v_cvt_pk_bf16_f32 v246, v232, v233
    v_cvt_pk_bf16_f32 v247, v234, v235
    v_cvt_pk_bf16_f32 v248, v236, v237
    v_cvt_pk_bf16_f32 v249, v238, v239
    s_nop 0
    v_permlane16_swap_b32 v246, v248
    v_permlane16_swap_b32 v247, v249
    buffer_store_dwordx4 v[246:249], v32, s[40:43], s49 offen offset:2048
    v_cvt_pk_bf16_f32 v250, v112, v113
    v_cvt_pk_bf16_f32 v251, v118, v119
    s_mov_b64 exec, s[90:91]
    buffer_store_dwordx2 v[250:251], v33, s[40:43], s49 offen offset:256
    s_mov_b64 exec, -1
    s_waitcnt lgkmcnt(0)
    v_cndmask_b32 v68, v100, v68, s[16:17]
    v_cndmask_b32 v69, v100, v69, s[18:19]
    v_cndmask_b32 v70, v100, v70, s[20:21]
    v_cndmask_b32 v71, v100, v71, s[22:23]
    v_cndmask_b32 v76, v100, v76, s[16:17]
    v_cndmask_b32 v77, v100, v77, s[18:19]
    v_cndmask_b32 v78, v100, v78, s[20:21]
    v_cndmask_b32 v79, v100, v79, s[22:23]
    v_cndmask_b32 v68, v68, v64, s[32:33]
    v_cndmask_b32 v69, v69, v65, s[34:35]
    v_cndmask_b32 v70, v70, v66, s[36:37]
    v_cndmask_b32 v71, v71, v67, s[38:39]
    v_cndmask_b32 v76, v76, v72, s[32:33]
    v_cndmask_b32 v77, v77, v73, s[34:35]
    v_cndmask_b32 v78, v78, v74, s[36:37]
    v_cndmask_b32 v79, v79, v75, s[38:39]
    v_cvt_pk_bf16_f32 v68, 0, v68
    v_cvt_pk_bf16_f32 v69, 0, v69
    v_cvt_pk_bf16_f32 v70, 0, v70
    v_cvt_pk_bf16_f32 v71, 0, v71
    v_cvt_pk_bf16_f32 v76, 0, v76
    v_cvt_pk_bf16_f32 v77, 0, v77
    v_cvt_pk_bf16_f32 v78, 0, v78
    v_cvt_pk_bf16_f32 v79, 0, v79
    v_pk_mul_f32 v[68:69], v[68:69], s[96:97]
    v_pk_mul_f32 v[70:71], v[70:71], s[96:97]
    v_pk_mul_f32 v[76:77], v[76:77], s[96:97]
    v_pk_mul_f32 v[78:79], v[78:79], s[96:97]
    v_cvt_pk_bf16_f32 v68, 0, v68
    v_cvt_pk_bf16_f32 v69, 0, v69
    v_cvt_pk_bf16_f32 v70, 0, v70
    v_cvt_pk_bf16_f32 v71, 0, v71
    v_cvt_pk_bf16_f32 v76, 0, v76
    v_cvt_pk_bf16_f32 v77, 0, v77
    v_cvt_pk_bf16_f32 v78, 0, v78
    v_cvt_pk_bf16_f32 v79, 0, v79
    v_max3_f32 v102, v68, v69, v70
    v_max3_f32 v108, v76, v77, v78
    v_max_f32 v102, v102, v71
    v_max_f32 v108, v108, v79
    s_nop 1
    v_permlane16_swap_b32 v102, v108
    v_max_f32 v102, v102, v108
    v_mov_b32 v108, v102
    s_nop 1
    v_permlane32_swap_b32 v102, v108
    v_max_f32 v102, v102, v108
    v_mul_f32 v102, -s94, v102
    v_mov_b32 v108, v102
    s_nop 1
    v_permlane16_swap_b32 v102, v108
    v_pk_fma_f32 v[68:69], v[68:69], s[94:95], v[102:103] op_sel_hi:[1,1,0]
    v_pk_fma_f32 v[70:71], v[70:71], s[94:95], v[102:103] op_sel_hi:[1,1,0]
    v_pk_fma_f32 v[76:77], v[76:77], s[94:95], v[108:109] op_sel_hi:[1,1,0]
    v_pk_fma_f32 v[78:79], v[78:79], s[94:95], v[108:109] op_sel_hi:[1,1,0]
    v_exp_f32 v68, v68
    v_exp_f32 v69, v69
    v_exp_f32 v70, v70
    v_exp_f32 v71, v71
    v_exp_f32 v76, v76
    v_exp_f32 v77, v77
    v_exp_f32 v78, v78
    v_exp_f32 v79, v79
    v_pk_add_f32 v[102:103], v[68:69], v[70:71]
    v_pk_add_f32 v[108:109], v[76:77], v[78:79]
    v_add_f32 v102, v102, v103
    v_add_f32 v108, v108, v109
    s_nop 1
    v_permlane16_swap_b32 v102, v108
    v_add_f32 v102, v102, v108
    v_mov_b32 v108, v102
    s_nop 1
    v_permlane32_swap_b32 v102, v108
    v_add_f32 v102, v102, v108
    v_rcp_f32 v102, v102
    s_nop 0
    v_mov_b32 v108, v102
    s_nop 1
    v_permlane16_swap_b32 v102, v108
    v_pk_mul_f32 v[68:69], v[68:69], v[102:103] op_sel_hi:[1,0]
    v_pk_mul_f32 v[70:71], v[70:71], v[102:103] op_sel_hi:[1,0]
    v_pk_mul_f32 v[76:77], v[76:77], v[108:109] op_sel_hi:[1,0]
    v_pk_mul_f32 v[78:79], v[78:79], v[108:109] op_sel_hi:[1,0]
    v_cvt_pk_bf16_f32 v210, v68, v69
    v_cvt_pk_bf16_f32 v211, v70, v71
    v_cvt_pk_bf16_f32 v214, v76, v77
    v_cvt_pk_bf16_f32 v215, v78, v79
    v_and_b32 v208, v120, v210
    v_and_b32 v209, v121, v211
    v_and_b32 v212, v120, v214
    v_and_b32 v213, v121, v215
    v_bfi_b32 v210, v120, 0, v210
    v_bfi_b32 v211, v121, 0, v211
    v_bfi_b32 v214, v120, 0, v214
    v_bfi_b32 v215, v121, 0, v215
    v_mfma_f32_16x16x32_bf16 v[224:227], v[168:171], v[208:211], 0
    v_mfma_f32_16x16x32_bf16 v[112:115], v[180:183], v[208:211], 0
    v_mfma_f32_16x16x32_bf16 v[228:231], v[174:177], v[212:215], 0
    v_mfma_f32_16x16x32_bf16 v[116:119], v[180:183], v[212:215], 0
    s_nop 4
    v_cvt_pk_bf16_f32 v240, v224, v225
    v_cvt_pk_bf16_f32 v241, v226, v227
    v_cvt_pk_bf16_f32 v242, v228, v229
    v_cvt_pk_bf16_f32 v243, v230, v231
    s_nop 0
    v_permlane16_swap_b32 v240, v242
    v_permlane16_swap_b32 v241, v243
    buffer_store_dwordx4 v[240:243], v32, s[40:43], s49 offen offset:0
    v_cvt_pk_bf16_f32 v244, v112, v113
    v_cvt_pk_bf16_f32 v245, v118, v119
    s_mov_b64 exec, s[90:91]
    buffer_store_dwordx2 v[244:245], v33, s[40:43], s49 offen offset:0
    s_mov_b64 exec, -1
    s_cmp_lg_u32 s98, 0
    s_cbranch_scc1 L_fc_done_l
    s_waitcnt vmcnt(4)
    v_cmp_ne_u64 vcc, v[30:31], v[54:55]
    v_cmp_ne_u64 s[10:11], v[30:31], v[56:57]
    v_cmp_ne_u64 s[12:13], v[30:31], v[58:59]
    v_cmp_ne_u64 s[14:15], v[30:31], v[60:61]
    s_or_b64 s[10:11], s[10:11], vcc
    s_or_b64 s[12:13], s[12:13], s[14:15]
    s_or_b64 vcc, s[10:11], s[12:13]
    s_cmp_eq_u64 vcc, 0
    s_cbranch_scc1 L_pd14_l
    s_mov_b32 s93, 0
    s_nop 1
L_pl13_l:
    s_sleep 8
    buffer_load_dwordx4 v[54:57], v15, s[40:43], s85 offen sc1
    buffer_load_dwordx4 v[58:61], v15, s[40:43], s85 offen offset:16 sc1
    s_waitcnt vmcnt(0)
    v_cmp_ne_u64 vcc, v[30:31], v[54:55]
    v_cmp_ne_u64 s[10:11], v[30:31], v[56:57]
    v_cmp_ne_u64 s[12:13], v[30:31], v[58:59]
    v_cmp_ne_u64 s[14:15], v[30:31], v[60:61]
    s_or_b64 s[10:11], s[10:11], vcc
    s_or_b64 s[12:13], s[12:13], s[14:15]
    s_or_b64 vcc, s[10:11], s[12:13]
    s_cmp_eq_u64 vcc, 0
    s_cbranch_scc1 L_pd14_l
    s_add_u32 s93, s93, 1
    s_cmp_lt_u32 s93, 30000
    s_cbranch_scc1 L_pl13_l
L_pd14_l:
    s_nop 0
L_fc_done_l:
    s_nop 1
    s_lshl_b32 s8, s3, 12
    s_add_u32 s8, s8, 124416
    v_add_u32 v100, s8, v27
    s_mul_i32 s8, s6, 18432
    s_lshl_b32 s9, s7, 10
    s_add_u32 s9, s9, s8
    s_add_u32 s9, s9, 140800
    v_add_u32 v101, s9, v27
    s_mul_i32 s9, s7, 9216
    s_sub_u32 s10, 9216, s9
    s_sub_u32 s11, 18432, s8
    s_add_u32 s8, s8, 124416
    s_add_u32 s11, s11, 124416
    s_add_u32 s12, s8, s9
    v_add_u32 v102, s12, v27
    s_add_u32 s12, s11, s9
    v_add_u32 v103, s12, v27
    s_add_u32 s12, s8, s10
    v_add_u32 v104, s12, v27
    s_add_u32 s12, s11, s10
    v_add_u32 v105, s12, v27
    s_lshl_b32 s12, s6, 10
    s_add_u32 s12, s12, 161280
    v_add_u32 v106, s12, v27
    s_mov_b32 s93, 0
    s_barrier
L_p2r_l:
    s_add_u32 s8, s49, 0
    buffer_load_dwordx4 v[64:67], v25, s[40:43], s8 offen offset:0 sc1
    buffer_load_dwordx4 v[68:71], v25, s[40:43], s8 offen offset:1024 sc1
    s_add_u32 s8, s49, 36864
    buffer_load_dwordx4 v[72:75], v25, s[40:43], s8 offen offset:0 sc1
    buffer_load_dwordx4 v[76:79], v25, s[40:43], s8 offen offset:1024 sc1
    s_add_u32 s8, s49, 73728
    buffer_load_dwordx4 v[80:83], v25, s[40:43], s8 offen offset:0 sc1
    buffer_load_dwordx4 v[84:87], v25, s[40:43], s8 offen offset:1024 sc1
    s_add_u32 s8, s49, 110592
    buffer_load_dwordx4 v[88:91], v25, s[40:43], s8 offen offset:0 sc1
    buffer_load_dwordx4 v[92:95], v25, s[40:43], s8 offen offset:1024 sc1
    buffer_load_dwordx2 v[96:97], v26, s[40:43], s49 offen sc1
    s_add_u32 s8, s49, 36864
    buffer_load_dwordx2 v[98:99], v26, s[40:43], s8 offen sc1
    s_waitcnt vmcnt(9)
    ds_write_b128 v100, v[64:67] offset:0
    v_max3_u32 v107, v64, v65, v66
    v_max_u32 v107, v107, v67
    s_waitcnt vmcnt(8)
    ds_write_b128 v100, v[68:71] offset:18432
    v_max3_u32 v107, v107, v68, v69
    v_max3_u32 v107, v107, v70, v71
    s_waitcnt vmcnt(7)
    ds_write_b128 v100, v[72:75] offset:1024
    v_max3_u32 v107, v107, v72, v73
    v_max3_u32 v107, v107, v74, v75
    s_waitcnt vmcnt(6)
    ds_write_b128 v100, v[76:79] offset:19456
    v_max3_u32 v107, v107, v76, v77
    v_max3_u32 v107, v107, v78, v79
    s_waitcnt vmcnt(5)
    ds_write_b128 v100, v[80:83] offset:2048
    v_max3_u32 v107, v107, v80, v81
    v_max3_u32 v107, v107, v82, v83
    s_waitcnt vmcnt(4)
    ds_write_b128 v100, v[84:87] offset:20480
    v_max3_u32 v107, v107, v84, v85
    v_max3_u32 v107, v107, v86, v87
    s_waitcnt vmcnt(3)
    ds_write_b128 v100, v[88:91] offset:3072
    v_max3_u32 v107, v107, v88, v89
    v_max3_u32 v107, v107, v90, v91
    s_waitcnt vmcnt(2)
    ds_write_b128 v100, v[92:95] offset:21504
    v_max3_u32 v107, v107, v92, v93
    v_max3_u32 v107, v107, v94, v95
    s_waitcnt vmcnt(0)
    ds_write_b128 v101, v[96:99]
    v_max3_u32 v107, v107, v96, v97
    v_max3_u32 v107, v107, v98, v99
    v_cmp_eq_u32 vcc, -1, v107
    s_nop 0
    s_cmp_eq_u64 vcc, 0
    s_cbranch_scc1 L_sd15_l
    s_add_u32 s93, s93, 1
    s_cmp_lt_u32 s93, 30000
    s_cbranch_scc1 L_p2r_l
L_sd15_l:
    s_nop 0
    s_cmp_lg_u32 s98, 0
    s_cbranch_scc1 L_noyl_l
    v_lshlrev_b32 v156, 14, v0
    v_cmp_gt_u32 vcc, 144, v0
    s_nop 1
    v_cndmask_b32 v156, v63, v156, vcc
    s_add_u32 s8, s86, 0
    buffer_load_dwordx4 v[140:143], v156, s[40:43], s8 offen sc1
    s_add_u32 s8, s86, 4096
    buffer_load_dwordx4 v[144:147], v156, s[40:43], s8 offen sc1
    s_add_u32 s8, s86, 8192
    buffer_load_dwordx4 v[148:151], v156, s[40:43], s8 offen sc1
    s_add_u32 s8, s86, 12288
    buffer_load_dwordx4 v[152:155], v156, s[40:43], s8 offen sc1
L_noyl_l:
    s_waitcnt lgkmcnt(0)
    s_barrier
    ds_read_b128 v[108:111], v102 offset:0
    ds_read_b128 v[112:115], v103 offset:0
    ds_read_b128 v[116:119], v102 offset:1024
    ds_read_b128 v[120:123], v103 offset:1024
    ds_read_b128 v[124:127], v102 offset:2048
    ds_read_b128 v[128:131], v103 offset:2048
    s_waitcnt lgkmcnt(4)
    v_mfma_f32_16x16x32_bf16 v[64:67], a[0:3], v[108:111], 0
    v_mfma_f32_16x16x32_bf16 v[68:71], a[72:75], v[108:111], 0
    ds_read_b128 v[132:135], v102 offset:3072
    v_mfma_f32_16x16x32_bf16 v[72:75], a[0:3], v[112:115], 0
    v_mfma_f32_16x16x32_bf16 v[76:79], a[72:75], v[112:115], 0
    ds_read_b128 v[136:139], v103 offset:3072
    v_mfma_f32_16x16x32_bf16 v[80:83], a[144:147], v[108:111], 0
    s_waitcnt lgkmcnt(4)
    v_mfma_f32_16x16x32_bf16 v[64:67], a[4:7], v[116:119], v[64:67]
    v_mfma_f32_16x16x32_bf16 v[68:71], a[76:79], v[116:119], v[68:71]
    ds_read_b128 v[108:111], v102 offset:4096
    v_mfma_f32_16x16x32_bf16 v[72:75], a[4:7], v[120:123], v[72:75]
    v_mfma_f32_16x16x32_bf16 v[76:79], a[76:79], v[120:123], v[76:79]
    ds_read_b128 v[112:115], v103 offset:4096
    v_mfma_f32_16x16x32_bf16 v[80:83], a[148:151], v[116:119], v[80:83]
    s_waitcnt lgkmcnt(4)
    v_mfma_f32_16x16x32_bf16 v[64:67], a[8:11], v[124:127], v[64:67]
    v_mfma_f32_16x16x32_bf16 v[68:71], a[80:83], v[124:127], v[68:71]
    ds_read_b128 v[116:119], v102 offset:5120
    v_mfma_f32_16x16x32_bf16 v[72:75], a[8:11], v[128:131], v[72:75]
    v_mfma_f32_16x16x32_bf16 v[76:79], a[80:83], v[128:131], v[76:79]
    ds_read_b128 v[120:123], v103 offset:5120
    v_mfma_f32_16x16x32_bf16 v[80:83], a[152:155], v[124:127], v[80:83]
    s_waitcnt lgkmcnt(4)
    v_mfma_f32_16x16x32_bf16 v[64:67], a[12:15], v[132:135], v[64:67]
    v_mfma_f32_16x16x32_bf16 v[68:71], a[84:87], v[132:135], v[68:71]
    ds_read_b128 v[124:127], v102 offset:6144
    v_mfma_f32_16x16x32_bf16 v[72:75], a[12:15], v[136:139], v[72:75]
    v_mfma_f32_16x16x32_bf16 v[76:79], a[84:87], v[136:139], v[76:79]
    ds_read_b128 v[128:131], v103 offset:6144
    v_mfma_f32_16x16x32_bf16 v[80:83], a[156:159], v[132:135], v[80:83]
    s_waitcnt lgkmcnt(4)
    v_mfma_f32_16x16x32_bf16 v[64:67], a[16:19], v[108:111], v[64:67]
    v_mfma_f32_16x16x32_bf16 v[68:71], a[88:91], v[108:111], v[68:71]
    ds_read_b128 v[132:135], v102 offset:7168
    v_mfma_f32_16x16x32_bf16 v[72:75], a[16:19], v[112:115], v[72:75]
    v_mfma_f32_16x16x32_bf16 v[76:79], a[88:91], v[112:115], v[76:79]
    ds_read_b128 v[136:139], v103 offset:7168
    v_mfma_f32_16x16x32_bf16 v[80:83], a[160:163], v[108:111], v[80:83]
    s_waitcnt lgkmcnt(4)
    v_mfma_f32_16x16x32_bf16 v[64:67], a[20:23], v[116:119], v[64:67]
    v_mfma_f32_16x16x32_bf16 v[68:71], a[92:95], v[116:119], v[68:71]
    ds_read_b128 v[108:111], v102 offset:8192
    v_mfma_f32_16x16x32_bf16 v[72:75], a[20:23], v[120:123], v[72:75]
    v_mfma_f32_16x16x32_bf16 v[76:79], a[92:95], v[120:123], v[76:79]
    ds_read_b128 v[112:115], v103 offset:8192
    v_mfma_f32_16x16x32_bf16 v[80:83], a[164:167], v[116:119], v[80:83]
    s_waitcnt lgkmcnt(4)
    v_mfma_f32_16x16x32_bf16 v[64:67], a[24:27], v[124:127], v[64:67]
    v_mfma_f32_16x16x32_bf16 v[68:71], a[96:99], v[124:127], v[68:71]
    ds_read_b128 v[116:119], v104 offset:0
    v_mfma_f32_16x16x32_bf16 v[72:75], a[24:27], v[128:131], v[72:75]
    v_mfma_f32_16x16x32_bf16 v[76:79], a[96:99], v[128:131], v[76:79]
    ds_read_b128 v[120:123], v105 offset:0
    v_mfma_f32_16x16x32_bf16 v[80:83], a[168:171], v[124:127], v[80:83]
    s_waitcnt lgkmcnt(4)
    v_mfma_f32_16x16x32_bf16 v[64:67], a[28:31], v[132:135], v[64:67]
    v_mfma_f32_16x16x32_bf16 v[68:71], a[100:103], v[132:135], v[68:71]
    ds_read_b128 v[124:127], v104 offset:1024
    v_mfma_f32_16x16x32_bf16 v[72:75], a[28:31], v[136:139], v[72:75]
    v_mfma_f32_16x16x32_bf16 v[76:79], a[100:103], v[136:139], v[76:79]
    ds_read_b128 v[128:131], v105 offset:1024
    v_mfma_f32_16x16x32_bf16 v[80:83], a[172:175], v[132:135], v[80:83]
    s_waitcnt lgkmcnt(4)
    v_mfma_f32_16x16x32_bf16 v[64:67], a[32:35], v[108:111], v[64:67]
    v_mfma_f32_16x16x32_bf16 v[68:71], a[104:107], v[108:111], v[68:71]
    ds_read_b128 v[132:135], v104 offset:2048
    v_mfma_f32_16x16x32_bf16 v[72:75], a[32:35], v[112:115], v[72:75]
    v_mfma_f32_16x16x32_bf16 v[76:79], a[104:107], v[112:115], v[76:79]
    ds_read_b128 v[136:139], v105 offset:2048
    v_mfma_f32_16x16x32_bf16 v[80:83], a[176:179], v[108:111], v[80:83]
    s_waitcnt lgkmcnt(4)
    v_mfma_f32_16x16x32_bf16 v[64:67], a[36:39], v[116:119], v[64:67]
    v_mfma_f32_16x16x32_bf16 v[68:71], a[108:111], v[116:119], v[68:71]
    ds_read_b128 v[108:111], v104 offset:3072
    v_mfma_f32_16x16x32_bf16 v[72:75], a[36:39], v[120:123], v[72:75]
    v_mfma_f32_16x16x32_bf16 v[76:79], a[108:111], v[120:123], v[76:79]
    ds_read_b128 v[112:115], v105 offset:3072
    s_waitcnt lgkmcnt(4)
    v_mfma_f32_16x16x32_bf16 v[64:67], a[40:43], v[124:127], v[64:67]
    v_mfma_f32_16x16x32_bf16 v[68:71], a[112:115], v[124:127], v[68:71]
    ds_read_b128 v[116:119], v104 offset:4096
    v_mfma_f32_16x16x32_bf16 v[72:75], a[40:43], v[128:131], v[72:75]
    v_mfma_f32_16x16x32_bf16 v[76:79], a[112:115], v[128:131], v[76:79]
    ds_read_b128 v[120:123], v105 offset:4096
    s_cmp_lt_u32 s3, 2
    s_cbranch_scc1 L_no9w_l
    ds_write_b128 v106, v[80:83]
L_no9w_l:
    s_waitcnt lgkmcnt(4)
    v_mfma_f32_16x16x32_bf16 v[64:67], a[44:47], v[132:135], v[64:67]
    v_mfma_f32_16x16x32_bf16 v[68:71], a[116:119], v[132:135], v[68:71]
    ds_read_b128 v[124:127], v104 offset:5120
    v_mfma_f32_16x16x32_bf16 v[72:75], a[44:47], v[136:139], v[72:75]
    v_mfma_f32_16x16x32_bf16 v[76:79], a[116:119], v[136:139], v[76:79]
    ds_read_b128 v[128:131], v105 offset:5120
    s_waitcnt lgkmcnt(4)
    v_mfma_f32_16x16x32_bf16 v[64:67], a[48:51], v[108:111], v[64:67]
    v_mfma_f32_16x16x32_bf16 v[68:71], a[120:123], v[108:111], v[68:71]
    ds_read_b128 v[132:135], v104 offset:6144
    v_mfma_f32_16x16x32_bf16 v[72:75], a[48:51], v[112:115], v[72:75]
    v_mfma_f32_16x16x32_bf16 v[76:79], a[120:123], v[112:115], v[76:79]
    ds_read_b128 v[136:139], v105 offset:6144
    s_waitcnt lgkmcnt(4)
    v_mfma_f32_16x16x32_bf16 v[64:67], a[52:55], v[116:119], v[64:67]
    v_mfma_f32_16x16x32_bf16 v[68:71], a[124:127], v[116:119], v[68:71]
    ds_read_b128 v[108:111], v104 offset:7168
    v_mfma_f32_16x16x32_bf16 v[72:75], a[52:55], v[120:123], v[72:75]
    v_mfma_f32_16x16x32_bf16 v[76:79], a[124:127], v[120:123], v[76:79]
    ds_read_b128 v[112:115], v105 offset:7168
    s_waitcnt lgkmcnt(4)
    v_mfma_f32_16x16x32_bf16 v[64:67], a[56:59], v[124:127], v[64:67]
    v_mfma_f32_16x16x32_bf16 v[68:71], a[128:131], v[124:127], v[68:71]
    ds_read_b128 v[116:119], v104 offset:8192
    v_mfma_f32_16x16x32_bf16 v[72:75], a[56:59], v[128:131], v[72:75]
    v_mfma_f32_16x16x32_bf16 v[76:79], a[128:131], v[128:131], v[76:79]
    ds_read_b128 v[120:123], v105 offset:8192
    s_waitcnt lgkmcnt(4)
    v_mfma_f32_16x16x32_bf16 v[64:67], a[60:63], v[132:135], v[64:67]
    v_mfma_f32_16x16x32_bf16 v[68:71], a[132:135], v[132:135], v[68:71]
    v_mfma_f32_16x16x32_bf16 v[72:75], a[60:63], v[136:139], v[72:75]
    v_mfma_f32_16x16x32_bf16 v[76:79], a[132:135], v[136:139], v[76:79]
    s_waitcnt lgkmcnt(2)
    v_mfma_f32_16x16x32_bf16 v[64:67], a[64:67], v[108:111], v[64:67]
    v_mfma_f32_16x16x32_bf16 v[68:71], a[136:139], v[108:111], v[68:71]
    v_mfma_f32_16x16x32_bf16 v[72:75], a[64:67], v[112:115], v[72:75]
    v_mfma_f32_16x16x32_bf16 v[76:79], a[136:139], v[112:115], v[76:79]
    s_waitcnt lgkmcnt(0)
    v_mfma_f32_16x16x32_bf16 v[64:67], a[68:71], v[116:119], v[64:67]
    v_mfma_f32_16x16x32_bf16 v[68:71], a[140:143], v[116:119], v[68:71]
    v_mfma_f32_16x16x32_bf16 v[72:75], a[68:71], v[120:123], v[72:75]
    v_mfma_f32_16x16x32_bf16 v[76:79], a[140:143], v[120:123], v[76:79]
    s_waitcnt lgkmcnt(0)
    s_barrier
    ds_read_b128 v[100:103], v106
    s_nop 1
    v_cvt_pk_bf16_f32 v88, v64, v65
    v_cvt_pk_bf16_f32 v89, v66, v67
    v_cvt_pk_bf16_f32 v90, v68, v69
    v_cvt_pk_bf16_f32 v91, v70, v71
    buffer_store_dwordx4 v[88:91], v28, s[40:43], s49 offen
    v_cvt_pk_bf16_f32 v92, v72, v73
    v_cvt_pk_bf16_f32 v93, v74, v75
    v_cvt_pk_bf16_f32 v94, v76, v77
    v_cvt_pk_bf16_f32 v95, v78, v79
    buffer_store_dwordx4 v[92:95], v11, s[40:43], s49 offen
    s_cmp_ge_u32 s3, 2
    s_cbranch_scc1 L_no9_l
    s_waitcnt lgkmcnt(0)
    v_pk_add_f32 v[80:81], v[80:81], v[100:101]
    v_pk_add_f32 v[82:83], v[82:83], v[102:103]
    v_cvt_pk_bf16_f32 v96, v80, v81
    v_cvt_pk_bf16_f32 v97, v82, v83
    buffer_store_dwordx2 v[96:97], v29, s[40:43], s49 offen
    s_waitcnt vmcnt(3)
    s_nop 0
    s_branch L_no9b_l
L_no9_l:
    s_waitcnt vmcnt(2)
L_no9b_l:
    s_waitcnt lgkmcnt(0)
    s_cmp_lg_u32 s98, 0
    s_cbranch_scc1 L_y_done_l
    v_cmp_gt_u32 vcc, 144, v0
    v_lshlrev_b32 v157, 3, v0
    v_add_u32 v157, 124416, v157
    v_perm_b32 v160, v144, v140, s100
    v_perm_b32 v161, v152, v148, s100
    v_perm_b32 v162, v144, v140, s99
    v_perm_b32 v163, v152, v148, s99
    v_perm_b32 v164, v145, v141, s100
    v_perm_b32 v165, v153, v149, s100
    v_perm_b32 v166, v145, v141, s99
    v_perm_b32 v167, v153, v149, s99
    v_perm_b32 v168, v146, v142, s100
    v_perm_b32 v169, v154, v150, s100
    v_perm_b32 v170, v146, v142, s99
    v_perm_b32 v171, v154, v150, s99
    v_perm_b32 v172, v147, v143, s100
    v_perm_b32 v173, v155, v151, s100
    v_perm_b32 v174, v147, v143, s99
    v_perm_b32 v175, v155, v151, s99
    s_mov_b64 exec, vcc
    ds_write_b64 v157, v[160:161] offset:0
    ds_write_b64 v157, v[162:163] offset:1168
    ds_write_b64 v157, v[164:165] offset:2336
    ds_write_b64 v157, v[166:167] offset:3504
    ds_write_b64 v157, v[168:169] offset:4672
    ds_write_b64 v157, v[170:171] offset:5840
    ds_write_b64 v157, v[172:173] offset:7008
    ds_write_b64 v157, v[174:175] offset:8176
    s_mov_b64 exec, -1
    s_waitcnt lgkmcnt(0)
    s_barrier
    ds_read_b128 v[160:163], v21
    ds_read_b128 v[164:167], v21 offset:512
    ds_read_b32 v61, v22
    s_waitcnt lgkmcnt(0)
    v_mov_b32 v53, v160
    v_mov_b32 v54, v161
    v_mov_b32 v55, v162
    v_mov_b32 v56, v163
    v_mov_b32 v57, v164
    v_mov_b32 v58, v165
    v_mov_b32 v59, v166
    v_mov_b32 v60, v167
L_y_done_l:
    s_nop 1
    buffer_load_dwordx4 v[64:67], v18, s[40:43], s49 offen sc1
    buffer_load_dwordx4 v[68:71], v19, s[40:43], s49 offen sc1
    buffer_load_dword v72, v20, s[40:43], s49 offen sc1
    v_and_b32 v81, s101, v44
    v_lshlrev_b32 v80, 16, v44
    v_and_b32 v83, s101, v45
    v_lshlrev_b32 v82, 16, v45
    v_and_b32 v85, s101, v46
    v_lshlrev_b32 v84, 16, v46
    v_and_b32 v87, s101, v47
    v_lshlrev_b32 v86, 16, v47
    v_and_b32 v89, s101, v48
    v_lshlrev_b32 v88, 16, v48
    v_and_b32 v91, s101, v49
    v_lshlrev_b32 v90, 16, v49
    v_and_b32 v93, s101, v50
    v_lshlrev_b32 v92, 16, v50
    v_and_b32 v95, s101, v51
    v_lshlrev_b32 v94, 16, v51
    v_and_b32 v97, s101, v52
    v_lshlrev_b32 v96, 16, v52
    v_and_b32 v121, s101, v53
    v_lshlrev_b32 v120, 16, v53
    v_and_b32 v123, s101, v54
    v_lshlrev_b32 v122, 16, v54
    v_and_b32 v125, s101, v55
    v_lshlrev_b32 v124, 16, v55
    v_and_b32 v127, s101, v56
    v_lshlrev_b32 v126, 16, v56
    v_and_b32 v129, s101, v57
    v_lshlrev_b32 v128, 16, v57
    v_and_b32 v131, s101, v58
    v_lshlrev_b32 v130, 16, v58
    v_and_b32 v133, s101, v59
    v_lshlrev_b32 v132, 16, v59
    v_and_b32 v135, s101, v60
    v_lshlrev_b32 v134, 16, v60
    v_and_b32 v137, s101, v61
    v_lshlrev_b32 v136, 16, v61
    s_mov_b32 s93, 0
    s_nop 1
    s_branch L_ar2_l
L_ar_l:
    buffer_load_dwordx4 v[64:67], v18, s[40:43], s49 offen sc1
    buffer_load_dwordx4 v[68:71], v19, s[40:43], s49 offen sc1
    buffer_load_dword v72, v20, s[40:43], s49 offen sc1
L_ar2_l:
    s_waitcnt vmcnt(0)
    v_max3_u32 v74, v64, v65, v66
    v_max3_u32 v74, v74, v67, v68
    v_max3_u32 v74, v74, v69, v70
    v_max3_u32 v74, v74, v71, v72
    v_cmp_eq_u32 vcc, -1, v74
    s_nop 0
    s_cmp_eq_u64 vcc, 0
    s_cbranch_scc1 L_sd16_l
    s_add_u32 s93, s93, 1
    s_cmp_lt_u32 s93, 30000
    s_cbranch_scc1 L_ar_l
L_sd16_l:
    s_nop 0
    v_and_b32 v101, s101, v64
    v_lshlrev_b32 v100, 16, v64
    v_and_b32 v103, s101, v65
    v_lshlrev_b32 v102, 16, v65
    v_and_b32 v105, s101, v66
    v_lshlrev_b32 v104, 16, v66
    v_and_b32 v107, s101, v67
    v_lshlrev_b32 v106, 16, v67
    v_and_b32 v109, s101, v68
    v_lshlrev_b32 v108, 16, v68
    v_and_b32 v111, s101, v69
    v_lshlrev_b32 v110, 16, v69
    v_and_b32 v113, s101, v70
    v_lshlrev_b32 v112, 16, v70
    v_and_b32 v115, s101, v71
    v_lshlrev_b32 v114, 16, v71
    v_and_b32 v117, s101, v72
    v_lshlrev_b32 v116, 16, v72
    v_pk_add_f32 v[80:81], v[80:81], v[100:101]
    v_pk_add_f32 v[82:83], v[82:83], v[102:103]
    v_pk_add_f32 v[84:85], v[84:85], v[104:105]
    v_pk_add_f32 v[86:87], v[86:87], v[106:107]
    v_pk_add_f32 v[88:89], v[88:89], v[108:109]
    v_pk_add_f32 v[90:91], v[90:91], v[110:111]
    v_pk_add_f32 v[92:93], v[92:93], v[112:113]
    v_pk_add_f32 v[94:95], v[94:95], v[114:115]
    v_pk_add_f32 v[96:97], v[96:97], v[116:117]
    v_cvt_pk_bf16_f32 v80, 0, v80
    v_cvt_pk_bf16_f32 v81, 0, v81
    v_cvt_pk_bf16_f32 v82, 0, v82
    v_cvt_pk_bf16_f32 v83, 0, v83
    v_cvt_pk_bf16_f32 v84, 0, v84
    v_cvt_pk_bf16_f32 v85, 0, v85
    v_cvt_pk_bf16_f32 v86, 0, v86
    v_cvt_pk_bf16_f32 v87, 0, v87
    v_cvt_pk_bf16_f32 v88, 0, v88
    v_cvt_pk_bf16_f32 v89, 0, v89
    v_cvt_pk_bf16_f32 v90, 0, v90
    v_cvt_pk_bf16_f32 v91, 0, v91
    v_cvt_pk_bf16_f32 v92, 0, v92
    v_cvt_pk_bf16_f32 v93, 0, v93
    v_cvt_pk_bf16_f32 v94, 0, v94
    v_cvt_pk_bf16_f32 v95, 0, v95
    v_cvt_pk_bf16_f32 v96, 0, v96
    v_cvt_pk_bf16_f32 v97, 0, v97
    v_pk_mul_f32 v[146:147], v[80:81], v[80:81]
    v_pk_add_f32 v[144:145], v[80:81], v[82:83]
    v_pk_fma_f32 v[146:147], v[82:83], v[82:83], v[146:147]
    v_pk_add_f32 v[144:145], v[144:145], v[84:85]
    v_pk_fma_f32 v[146:147], v[84:85], v[84:85], v[146:147]
    v_pk_add_f32 v[144:145], v[144:145], v[86:87]
    v_pk_fma_f32 v[146:147], v[86:87], v[86:87], v[146:147]
    v_pk_add_f32 v[144:145], v[144:145], v[88:89]
    v_pk_fma_f32 v[146:147], v[88:89], v[88:89], v[146:147]
    v_pk_add_f32 v[144:145], v[144:145], v[90:91]
    v_pk_fma_f32 v[146:147], v[90:91], v[90:91], v[146:147]
    v_pk_add_f32 v[144:145], v[144:145], v[92:93]
    v_pk_fma_f32 v[146:147], v[92:93], v[92:93], v[146:147]
    v_pk_add_f32 v[144:145], v[144:145], v[94:95]
    v_pk_fma_f32 v[146:147], v[94:95], v[94:95], v[146:147]
    v_pk_add_f32 v[144:145], v[144:145], v[96:97]
    v_pk_fma_f32 v[146:147], v[96:97], v[96:97], v[146:147]
    v_add_f32 v144, v144, v145
    v_add_f32 v146, v146, v147
    s_nop 0
    v_add_f32_dpp v144, v144, v144 quad_perm:[1,0,3,2] row_mask:0xf bank_mask:0xf
    v_add_f32_dpp v146, v146, v146 quad_perm:[1,0,3,2] row_mask:0xf bank_mask:0xf
    s_nop 0
    v_add_f32_dpp v144, v144, v144 quad_perm:[2,3,0,1] row_mask:0xf bank_mask:0xf
    v_add_f32_dpp v146, v146, v146 quad_perm:[2,3,0,1] row_mask:0xf bank_mask:0xf
    s_nop 0
    v_add_f32_dpp v144, v144, v144 row_half_mirror row_mask:0xf bank_mask:0xf
    v_add_f32_dpp v146, v146, v146 row_half_mirror row_mask:0xf bank_mask:0xf
    s_nop 0
    v_add_f32_dpp v144, v144, v144 row_mirror row_mask:0xf bank_mask:0xf
    v_add_f32_dpp v146, v146, v146 row_mirror row_mask:0xf bank_mask:0xf
    v_mov_b32 v145, v144
    v_mov_b32 v147, v146
    s_nop 0
    v_permlane16_swap_b32 v144, v145
    v_permlane16_swap_b32 v146, v147
    v_add_f32 v144, v144, v145
    v_add_f32 v146, v146, v147
    v_mul_f32 v144, 0x3ae38e39, v144
    v_mul_f32 v146, 0x3ae38e39, v146
    v_fma_f32 v146, -v144, v144, v146
    v_max_f32 v146, 0, v146
    v_cvt_pk_bf16_f32 v148, v144, v146
    v_and_b32 v146, s101, v148
    v_lshlrev_b32 v144, 16, v148
    v_add_f32 v146, 0x3727c5ac, v146
    v_cvt_pk_bf16_f32 v148, v146, v146
    v_lshlrev_b32 v146, 16, v148
    v_sqrt_f32 v146, v146
    s_nop 0
    v_cvt_pk_bf16_f32 v148, v146, v146
    v_lshlrev_b32 v146, 16, v148
    v_rcp_f32 v142, v146
    v_sub_f32 v140, 0, v144
    v_sub_f32 v141, 0, v144
    v_fma_f32 v148, -v146, v142, 2.0
    v_mul_f32 v142, v142, v148
    v_mov_b32 v143, v142
    v_pk_add_f32 v[100:101], v[80:81], v[140:141]
    v_pk_add_f32 v[102:103], v[82:83], v[140:141]
    v_pk_add_f32 v[104:105], v[84:85], v[140:141]
    v_pk_add_f32 v[106:107], v[86:87], v[140:141]
    v_pk_add_f32 v[108:109], v[88:89], v[140:141]
    v_pk_add_f32 v[110:111], v[90:91], v[140:141]
    v_pk_add_f32 v[112:113], v[92:93], v[140:141]
    v_pk_add_f32 v[114:115], v[94:95], v[140:141]
    v_pk_add_f32 v[116:117], v[96:97], v[140:141]
    v_cvt_pk_bf16_f32 v100, 0, v100
    v_cvt_pk_bf16_f32 v101, 0, v101
    v_cvt_pk_bf16_f32 v102, 0, v102
    v_cvt_pk_bf16_f32 v103, 0, v103
    v_cvt_pk_bf16_f32 v104, 0, v104
    v_cvt_pk_bf16_f32 v105, 0, v105
    v_cvt_pk_bf16_f32 v106, 0, v106
    v_cvt_pk_bf16_f32 v107, 0, v107
    v_cvt_pk_bf16_f32 v108, 0, v108
    v_cvt_pk_bf16_f32 v109, 0, v109
    v_cvt_pk_bf16_f32 v110, 0, v110
    v_cvt_pk_bf16_f32 v111, 0, v111
    v_cvt_pk_bf16_f32 v112, 0, v112
    v_cvt_pk_bf16_f32 v113, 0, v113
    v_cvt_pk_bf16_f32 v114, 0, v114
    v_cvt_pk_bf16_f32 v115, 0, v115
    v_cvt_pk_bf16_f32 v116, 0, v116
    v_cvt_pk_bf16_f32 v117, 0, v117
    v_pk_mul_f32 v[100:101], v[100:101], v[142:143]
    v_pk_mul_f32 v[102:103], v[102:103], v[142:143]
    v_pk_mul_f32 v[104:105], v[104:105], v[142:143]
    v_pk_mul_f32 v[106:107], v[106:107], v[142:143]
    v_pk_mul_f32 v[108:109], v[108:109], v[142:143]
    v_pk_mul_f32 v[110:111], v[110:111], v[142:143]
    v_pk_mul_f32 v[112:113], v[112:113], v[142:143]
    v_pk_mul_f32 v[114:115], v[114:115], v[142:143]
    v_pk_mul_f32 v[116:117], v[116:117], v[142:143]
    v_cvt_pk_bf16_f32 v100, 0, v100
    v_cvt_pk_bf16_f32 v101, 0, v101
    v_cvt_pk_bf16_f32 v102, 0, v102
    v_cvt_pk_bf16_f32 v103, 0, v103
    v_cvt_pk_bf16_f32 v104, 0, v104
    v_cvt_pk_bf16_f32 v105, 0, v105
    v_cvt_pk_bf16_f32 v106, 0, v106
    v_cvt_pk_bf16_f32 v107, 0, v107
    v_cvt_pk_bf16_f32 v108, 0, v108
    v_cvt_pk_bf16_f32 v109, 0, v109
    v_cvt_pk_bf16_f32 v110, 0, v110
    v_cvt_pk_bf16_f32 v111, 0, v111
    v_cvt_pk_bf16_f32 v112, 0, v112
    v_cvt_pk_bf16_f32 v113, 0, v113
    v_cvt_pk_bf16_f32 v114, 0, v114
    v_cvt_pk_bf16_f32 v115, 0, v115
    v_cvt_pk_bf16_f32 v116, 0, v116
    v_cvt_pk_bf16_f32 v117, 0, v117
    v_pk_mul_f32 v[100:101], v[100:101], v[120:121]
    v_pk_mul_f32 v[102:103], v[102:103], v[122:123]
    v_pk_mul_f32 v[104:105], v[104:105], v[124:125]
    v_pk_mul_f32 v[106:107], v[106:107], v[126:127]
    v_pk_mul_f32 v[108:109], v[108:109], v[128:129]
    v_pk_mul_f32 v[110:111], v[110:111], v[130:131]
    v_pk_mul_f32 v[112:113], v[112:113], v[132:133]
    v_pk_mul_f32 v[114:115], v[114:115], v[134:135]
    v_pk_mul_f32 v[116:117], v[116:117], v[136:137]
    v_cvt_pk_bf16_f32 v100, 0, v100
    v_cvt_pk_bf16_f32 v101, 0, v101
    v_cvt_pk_bf16_f32 v102, 0, v102
    v_cvt_pk_bf16_f32 v103, 0, v103
    v_cvt_pk_bf16_f32 v104, 0, v104
    v_cvt_pk_bf16_f32 v105, 0, v105
    v_cvt_pk_bf16_f32 v106, 0, v106
    v_cvt_pk_bf16_f32 v107, 0, v107
    v_cvt_pk_bf16_f32 v108, 0, v108
    v_cvt_pk_bf16_f32 v109, 0, v109
    v_cvt_pk_bf16_f32 v110, 0, v110
    v_cvt_pk_bf16_f32 v111, 0, v111
    v_cvt_pk_bf16_f32 v112, 0, v112
    v_cvt_pk_bf16_f32 v113, 0, v113
    v_cvt_pk_bf16_f32 v114, 0, v114
    v_cvt_pk_bf16_f32 v115, 0, v115
    v_cvt_pk_bf16_f32 v116, 0, v116
    v_cvt_pk_bf16_f32 v117, 0, v117
    v_pk_add_f32 v[80:81], v[80:81], v[100:101]
    v_pk_add_f32 v[82:83], v[82:83], v[102:103]
    v_pk_add_f32 v[84:85], v[84:85], v[104:105]
    v_pk_add_f32 v[86:87], v[86:87], v[106:107]
    v_pk_add_f32 v[88:89], v[88:89], v[108:109]
    v_pk_add_f32 v[90:91], v[90:91], v[110:111]
    v_pk_add_f32 v[92:93], v[92:93], v[112:113]
    v_pk_add_f32 v[94:95], v[94:95], v[114:115]
    v_pk_add_f32 v[96:97], v[96:97], v[116:117]
    v_cvt_pk_bf16_f32 v44, v80, v81
    v_cvt_pk_bf16_f32 v45, v82, v83
    v_cvt_pk_bf16_f32 v46, v84, v85
    v_cvt_pk_bf16_f32 v47, v86, v87
    v_cvt_pk_bf16_f32 v48, v88, v89
    v_cvt_pk_bf16_f32 v49, v90, v91
    v_cvt_pk_bf16_f32 v50, v92, v93
    v_cvt_pk_bf16_f32 v51, v94, v95
    v_cvt_pk_bf16_f32 v52, v96, v97
    s_cmp_lg_u32 s98, 0
    s_cbranch_scc1 L_final_l
    v_and_b32 v81, s101, v44
    v_lshlrev_b32 v80, 16, v44
    v_and_b32 v83, s101, v45
    v_lshlrev_b32 v82, 16, v45
    v_and_b32 v85, s101, v46
    v_lshlrev_b32 v84, 16, v46
    v_and_b32 v87, s101, v47
    v_lshlrev_b32 v86, 16, v47
    v_and_b32 v89, s101, v48
    v_lshlrev_b32 v88, 16, v48
    v_and_b32 v91, s101, v49
    v_lshlrev_b32 v90, 16, v49
    v_and_b32 v93, s101, v50
    v_lshlrev_b32 v92, 16, v50
    v_and_b32 v95, s101, v51
    v_lshlrev_b32 v94, 16, v51
    v_and_b32 v97, s101, v52
    v_lshlrev_b32 v96, 16, v52
    v_pk_mul_f32 v[146:147], v[80:81], v[80:81]
    v_pk_add_f32 v[144:145], v[80:81], v[82:83]
    v_pk_fma_f32 v[146:147], v[82:83], v[82:83], v[146:147]
    v_pk_add_f32 v[144:145], v[144:145], v[84:85]
    v_pk_fma_f32 v[146:147], v[84:85], v[84:85], v[146:147]
    v_pk_add_f32 v[144:145], v[144:145], v[86:87]
    v_pk_fma_f32 v[146:147], v[86:87], v[86:87], v[146:147]
    v_pk_add_f32 v[144:145], v[144:145], v[88:89]
    v_pk_fma_f32 v[146:147], v[88:89], v[88:89], v[146:147]
    v_pk_add_f32 v[144:145], v[144:145], v[90:91]
    v_pk_fma_f32 v[146:147], v[90:91], v[90:91], v[146:147]
    v_pk_add_f32 v[144:145], v[144:145], v[92:93]
    v_pk_fma_f32 v[146:147], v[92:93], v[92:93], v[146:147]
    v_pk_add_f32 v[144:145], v[144:145], v[94:95]
    v_pk_fma_f32 v[146:147], v[94:95], v[94:95], v[146:147]
    v_pk_add_f32 v[144:145], v[144:145], v[96:97]
    v_pk_fma_f32 v[146:147], v[96:97], v[96:97], v[146:147]
    v_add_f32 v144, v144, v145
    v_add_f32 v146, v146, v147
    s_nop 0
    v_add_f32_dpp v144, v144, v144 quad_perm:[1,0,3,2] row_mask:0xf bank_mask:0xf
    v_add_f32_dpp v146, v146, v146 quad_perm:[1,0,3,2] row_mask:0xf bank_mask:0xf
    s_nop 0
    v_add_f32_dpp v144, v144, v144 quad_perm:[2,3,0,1] row_mask:0xf bank_mask:0xf
    v_add_f32_dpp v146, v146, v146 quad_perm:[2,3,0,1] row_mask:0xf bank_mask:0xf
    s_nop 0
    v_add_f32_dpp v144, v144, v144 row_half_mirror row_mask:0xf bank_mask:0xf
    v_add_f32_dpp v146, v146, v146 row_half_mirror row_mask:0xf bank_mask:0xf
    s_nop 0
    v_add_f32_dpp v144, v144, v144 row_mirror row_mask:0xf bank_mask:0xf
    v_add_f32_dpp v146, v146, v146 row_mirror row_mask:0xf bank_mask:0xf
    v_mov_b32 v145, v144
    v_mov_b32 v147, v146
    s_nop 0
    v_permlane16_swap_b32 v144, v145
    v_permlane16_swap_b32 v146, v147
    v_add_f32 v144, v144, v145
    v_add_f32 v146, v146, v147
    v_mul_f32 v144, 0x3ae38e39, v144
    v_mul_f32 v146, 0x3ae38e39, v146
    v_fma_f32 v146, -v144, v144, v146
    v_max_f32 v146, 0, v146
    v_cvt_pk_bf16_f32 v148, v144, v146
    v_and_b32 v146, s101, v148
    v_lshlrev_b32 v144, 16, v148
    v_add_f32 v146, 0x3727c5ac, v146
    v_cvt_pk_bf16_f32 v148, v146, v146
    v_lshlrev_b32 v146, 16, v148
    v_sqrt_f32 v146, v146
    s_nop 0
    v_cvt_pk_bf16_f32 v148, v146, v146
    v_lshlrev_b32 v146, 16, v148
    v_rcp_f32 v142, v146
    v_sub_f32 v140, 0, v144
    v_sub_f32 v141, 0, v144
    v_fma_f32 v148, -v146, v142, 2.0
    v_mul_f32 v142, v142, v148
    v_mov_b32 v143, v142
    v_pk_add_f32 v[80:81], v[80:81], v[140:141]
    v_pk_add_f32 v[82:83], v[82:83], v[140:141]
    v_pk_add_f32 v[84:85], v[84:85], v[140:141]
    v_pk_add_f32 v[86:87], v[86:87], v[140:141]
    v_pk_add_f32 v[88:89], v[88:89], v[140:141]
    v_pk_add_f32 v[90:91], v[90:91], v[140:141]
    v_pk_add_f32 v[92:93], v[92:93], v[140:141]
    v_pk_add_f32 v[94:95], v[94:95], v[140:141]
    v_pk_add_f32 v[96:97], v[96:97], v[140:141]
    v_cvt_pk_bf16_f32 v80, 0, v80
    v_cvt_pk_bf16_f32 v81, 0, v81
    v_cvt_pk_bf16_f32 v82, 0, v82
    v_cvt_pk_bf16_f32 v83, 0, v83
    v_cvt_pk_bf16_f32 v84, 0, v84
    v_cvt_pk_bf16_f32 v85, 0, v85
    v_cvt_pk_bf16_f32 v86, 0, v86
    v_cvt_pk_bf16_f32 v87, 0, v87
    v_cvt_pk_bf16_f32 v88, 0, v88
    v_cvt_pk_bf16_f32 v89, 0, v89
    v_cvt_pk_bf16_f32 v90, 0, v90
    v_cvt_pk_bf16_f32 v91, 0, v91
    v_cvt_pk_bf16_f32 v92, 0, v92
    v_cvt_pk_bf16_f32 v93, 0, v93
    v_cvt_pk_bf16_f32 v94, 0, v94
    v_cvt_pk_bf16_f32 v95, 0, v95
    v_cvt_pk_bf16_f32 v96, 0, v96
    v_cvt_pk_bf16_f32 v97, 0, v97
    v_pk_mul_f32 v[80:81], v[80:81], v[142:143]
    v_pk_mul_f32 v[82:83], v[82:83], v[142:143]
    v_pk_mul_f32 v[84:85], v[84:85], v[142:143]
    v_pk_mul_f32 v[86:87], v[86:87], v[142:143]
    v_pk_mul_f32 v[88:89], v[88:89], v[142:143]
    v_pk_mul_f32 v[90:91], v[90:91], v[142:143]
    v_pk_mul_f32 v[92:93], v[92:93], v[142:143]
    v_pk_mul_f32 v[94:95], v[94:95], v[142:143]
    v_pk_mul_f32 v[96:97], v[96:97], v[142:143]
    v_cvt_pk_bf16_f32 v64, v80, v81
    v_cvt_pk_bf16_f32 v65, v82, v83
    v_cvt_pk_bf16_f32 v66, v84, v85
    v_cvt_pk_bf16_f32 v67, v86, v87
    v_cvt_pk_bf16_f32 v68, v88, v89
    v_cvt_pk_bf16_f32 v69, v90, v91
    v_cvt_pk_bf16_f32 v70, v92, v93
    v_cvt_pk_bf16_f32 v71, v94, v95
    v_cvt_pk_bf16_f32 v72, v96, v97
    s_mov_b32 s8, 2359296
    ds_write_b128 v21, v[64:67]
    ds_write_b128 v21, v[68:71] offset:512
    ds_write_b32 v22, v72
    s_waitcnt lgkmcnt(0)
    s_barrier
    ds_read_b128 v[200:203], v23
    ds_read_b128 v[204:207], v23 offset:512
    ds_read_b128 v[208:211], v23 offset:1024
    s_add_u32 s9, s8, 8192
    s_add_u32 s10, s8, 16384
    s_waitcnt lgkmcnt(2)
    buffer_store_dwordx4 v[200:203], v24, s[40:43], s8 offen
    s_waitcnt lgkmcnt(1)
    buffer_store_dwordx4 v[204:207], v24, s[40:43], s9 offen
    s_waitcnt lgkmcnt(0)
    buffer_store_dwordx4 v[208:211], v9, s[40:43], s10 offen
    s_cmp_eq_u32 s70, 0
    s_cbranch_scc1 L_xh17_l
    s_add_u32 s9, s69, 8192
    s_add_u32 s10, s69, 16384
    buffer_store_dwordx4 v[200:203], v24, s[40:43], s69 offen sc1
    buffer_store_dwordx4 v[204:207], v24, s[40:43], s9 offen sc1
    buffer_store_dwordx4 v[208:211], v9, s[40:43], s10 offen sc1
L_xh17_l:
    s_mov_b32 s98, 1
    s_mov_b32 s48, 0x240000
    s_mov_b32 s49, 0x4800
    s_mov_b32 s60, 0x241000
    s_mov_b32 s61, 0x249000
    s_mov_b32 s62, 0x24a000
    v_add_u32 v248, s72, v5
    s_nop 3
    s_branch L_layer1_l
L_final_l:
    buffer_store_dwordx4 v[44:47], v16, s[44:47], 0 offen sc1
    buffer_store_dwordx4 v[48:51], v16, s[44:47], 0 offen offset:512 sc1
    buffer_store_dword v52, v17, s[44:47], 0 offen sc1
    s_or_b32 s8, s2, s3
    s_cmp_lg_u32 s8, 0
    s_cbranch_scc1 L_noep_l
    s_memrealtime s[8:9]
    s_mov_b32 s10, 0x158e000
    s_waitcnt lgkmcnt(0)
    v_mov_b32 v64, s8
    v_mov_b32 v65, s9
    s_mov_b64 exec, 1
    buffer_store_dwordx2 v[64:65], off, s[40:43], s10 sc1
    s_mov_b64 exec, -1
L_noep_l:
    s_waitcnt vmcnt(0)
L_end:
    s_endpgm
L_xs4_l:
    s_mov_b32 s93, 0
L_xl4_l:
    buffer_load_dwordx4 v[172:175], v249, s[40:43], s48 offen offset:0 sc1
    buffer_load_dwordx4 v[176:179], v249, s[40:43], s61 offen offset:0 sc1
    s_waitcnt vmcnt(0)
    v_max_u32 v240, v172, v176
    v_cmp_eq_u32 vcc, -1, v240
    s_nop 0
    s_cmp_eq_u64 vcc, 0
    s_nop 2
    s_cbranch_scc1 L_xr4_l
    s_add_u32 s93, s93, 1
    s_cmp_lt_u32 s93, 30000
    s_cbranch_scc1 L_xl4_l
    s_branch L_xr4_l
L_xs5_l:
    s_mov_b32 s93, 0
L_xl5_l:
    buffer_load_dwordx4 v[180:183], v249, s[40:43], s48 offen offset:1024 sc1
    buffer_load_dwordx4 v[184:187], v249, s[40:43], s61 offen offset:1024 sc1
    s_waitcnt vmcnt(0)
    v_max_u32 v240, v180, v184
    v_cmp_eq_u32 vcc, -1, v240
    s_nop 0
    s_cmp_eq_u64 vcc, 0
    s_nop 2
    s_cbranch_scc1 L_xr5_l
    s_add_u32 s93, s93, 1
    s_cmp_lt_u32 s93, 30000
    s_cbranch_scc1 L_xl5_l
    s_branch L_xr5_l
L_xs6_l:
    s_mov_b32 s93, 0
L_xl6_l:
    buffer_load_dwordx4 v[188:191], v249, s[40:43], s48 offen offset:2048 sc1
    buffer_load_dwordx4 v[192:195], v249, s[40:43], s61 offen offset:2048 sc1
    s_waitcnt vmcnt(0)
    v_max_u32 v240, v188, v192
    v_cmp_eq_u32 vcc, -1, v240
    s_nop 0
    s_cmp_eq_u64 vcc, 0
    s_nop 2
    s_cbranch_scc1 L_xr6_l
    s_add_u32 s93, s93, 1
    s_cmp_lt_u32 s93, 30000
    s_cbranch_scc1 L_xl6_l
    s_branch L_xr6_l
L_xs7_l:
    s_mov_b32 s93, 0
L_xl7_l:
    buffer_load_dwordx4 v[196:199], v249, s[40:43], s48 offen offset:3072 sc1
    buffer_load_dwordx4 v[200:203], v249, s[40:43], s61 offen offset:3072 sc1
    s_waitcnt vmcnt(0)
    v_max_u32 v240, v196, v200
    v_cmp_eq_u32 vcc, -1, v240
    s_nop 0
    s_cmp_eq_u64 vcc, 0
    s_nop 2
    s_cbranch_scc1 L_xr7_l
    s_add_u32 s93, s93, 1
    s_cmp_lt_u32 s93, 30000
    s_cbranch_scc1 L_xl7_l
    s_branch L_xr7_l
L_xs8_l:
    s_mov_b32 s93, 0
L_xl8_l:
    buffer_load_dwordx4 v[204:207], v250, s[40:43], s48 offen offset:0 sc1
    buffer_load_dwordx4 v[208:211], v250, s[40:43], s61 offen offset:0 sc1
    s_waitcnt vmcnt(0)
    v_max_u32 v240, v204, v208
    v_cmp_eq_u32 vcc, -1, v240
    s_nop 0
    s_cmp_eq_u64 vcc, 0
    s_nop 2
    s_cbranch_scc1 L_xr8_l
    s_add_u32 s93, s93, 1
    s_cmp_lt_u32 s93, 30000
    s_cbranch_scc1 L_xl8_l
    s_branch L_xr8_l
L_xs9_l:
    s_mov_b32 s93, 0
L_xl9_l:
    buffer_load_dwordx4 v[212:215], v250, s[40:43], s48 offen offset:1024 sc1
    buffer_load_dwordx4 v[216:219], v250, s[40:43], s61 offen offset:1024 sc1
    s_waitcnt vmcnt(0)
    v_max_u32 v240, v212, v216
    v_cmp_eq_u32 vcc, -1, v240
    s_nop 0
    s_cmp_eq_u64 vcc, 0
    s_nop 2
    s_cbranch_scc1 L_xr9_l
    s_add_u32 s93, s93, 1
    s_cmp_lt_u32 s93, 30000
    s_cbranch_scc1 L_xl9_l
    s_branch L_xr9_l
L_xs10_l:
    s_mov_b32 s93, 0
L_xl10_l:
    buffer_load_dwordx4 v[140:143], v250, s[40:43], s48 offen offset:2048 sc1
    buffer_load_dwordx4 v[144:147], v250, s[40:43], s61 offen offset:2048 sc1
    buffer_load_dwordx4 v[220:223], v6, s[40:43], s77 offen sc1
    s_waitcnt vmcnt(0)
    v_max3_u32 v240, v140, v144, v220
    v_cmp_eq_u32 vcc, -1, v240
    s_nop 0
    s_cmp_eq_u64 vcc, 0
    s_nop 2
    s_cbranch_scc1 L_xr10_l
    s_add_u32 s93, s93, 1
    s_cmp_lt_u32 s93, 30000
    s_cbranch_scc1 L_xl10_l
    s_branch L_xr10_l
L_xs11_l:
    s_mov_b32 s93, 0
L_xl11_l:
    buffer_load_dwordx4 v[148:151], v250, s[40:43], s48 offen offset:3072 sc1
    buffer_load_dwordx4 v[152:155], v250, s[40:43], s61 offen offset:3072 sc1
    buffer_load_dwordx4 v[224:227], v6, s[40:43], s78 offen sc1
    s_waitcnt vmcnt(0)
    v_max3_u32 v240, v148, v152, v224
    v_cmp_eq_u32 vcc, -1, v240
    s_nop 0
    s_cmp_eq_u64 vcc, 0
    s_nop 2
    s_cbranch_scc1 L_xr11_l
    s_add_u32 s93, s93, 1
    s_cmp_lt_u32 s93, 30000
    s_cbranch_scc1 L_xl11_l
    s_branch L_xr11_l
L_xs12_l:
    s_mov_b32 s93, 0
L_xl12_l:
    buffer_load_dwordx4 v[156:159], v250, s[40:43], s60 offen offset:0 sc1
    buffer_load_dwordx4 v[160:163], v250, s[40:43], s62 offen offset:0 sc1
    buffer_load_dwordx4 v[228:231], v6, s[40:43], s79 offen sc1
    s_waitcnt vmcnt(0)
    v_max3_u32 v240, v156, v160, v228
    v_cmp_eq_u32 vcc, -1, v240
    s_nop 0
    s_cmp_eq_u64 vcc, 0
    s_nop 2
    s_cbranch_scc1 L_xr12_l
    s_add_u32 s93, s93, 1
    s_cmp_lt_u32 s93, 30000
    s_cbranch_scc1 L_xl12_l
    s_branch L_xr12_l
L_xs13_l:
    s_mov_b32 s93, 0
L_xl13_l:
    buffer_load_dwordx4 v[164:167], v251, s[40:43], s48 offen offset:0 sc1
    buffer_load_dwordx4 v[168:171], v251, s[40:43], s61 offen offset:0 sc1
    buffer_load_dwordx4 v[232:235], v6, s[40:43], s80 offen sc1
    s_waitcnt vmcnt(0)
    v_max3_u32 v240, v164, v168, v232
    v_cmp_eq_u32 vcc, -1, v240
    s_nop 0
    s_cmp_eq_u64 vcc, 0
    s_nop 2
    s_cbranch_scc1 L_xr13_l
    s_add_u32 s93, s93, 1
    s_cmp_lt_u32 s93, 30000
    s_cbranch_scc1 L_xl13_l
    s_branch L_xr13_l
L_xs14_l:
    s_mov_b32 s93, 0
L_xl14_l:
    buffer_load_dwordx4 v[172:175], v251, s[40:43], s48 offen offset:1024 sc1
    buffer_load_dwordx4 v[176:179], v251, s[40:43], s61 offen offset:1024 sc1
    buffer_load_dwordx4 v[236:239], v10, s[40:43], s81 offen sc1
    s_waitcnt vmcnt(0)
    v_max3_u32 v240, v172, v176, v236
    v_cmp_eq_u32 vcc, -1, v240
    s_nop 0
    s_cmp_eq_u64 vcc, 0
    s_nop 2
    s_cbranch_scc1 L_xr14_l
    s_add_u32 s93, s93, 1
    s_cmp_lt_u32 s93, 30000
    s_cbranch_scc1 L_xl14_l
    s_branch L_xr14_l
L_xs15_l:
    s_mov_b32 s93, 0
L_xl15_l:
    buffer_load_dwordx4 v[180:183], v251, s[40:43], s48 offen offset:2048 sc1
    buffer_load_dwordx4 v[184:187], v251, s[40:43], s61 offen offset:2048 sc1
    s_waitcnt vmcnt(0)
    v_max_u32 v240, v180, v184
    v_cmp_eq_u32 vcc, -1, v240
    s_nop 0
    s_cmp_eq_u64 vcc, 0
    s_nop 2
    s_cbranch_scc1 L_xr15_l
    s_add_u32 s93, s93, 1
    s_cmp_lt_u32 s93, 30000
    s_cbranch_scc1 L_xl15_l
    s_branch L_xr15_l
L_xs16_l:
    s_mov_b32 s93, 0
L_xl16_l:
    buffer_load_dwordx4 v[188:191], v251, s[40:43], s48 offen offset:3072 sc1
    buffer_load_dwordx4 v[192:195], v251, s[40:43], s61 offen offset:3072 sc1
    s_waitcnt vmcnt(0)
    v_max_u32 v240, v188, v192
    v_cmp_eq_u32 vcc, -1, v240
    s_nop 0
    s_cmp_eq_u64 vcc, 0
    s_nop 2
    s_cbranch_scc1 L_xr16_l
    s_add_u32 s93, s93, 1
    s_cmp_lt_u32 s93, 30000
    s_cbranch_scc1 L_xl16_l
    s_branch L_xr16_l
L_xs17_l:
    s_mov_b32 s93, 0
L_xl17_l:
    buffer_load_dwordx4 v[196:199], v251, s[40:43], s60 offen offset:0 sc1
    buffer_load_dwordx4 v[200:203], v251, s[40:43], s62 offen offset:0 sc1
    s_waitcnt vmcnt(0)
    v_max_u32 v240, v196, v200
    v_cmp_eq_u32 vcc, -1, v240
    s_nop 0
    s_cmp_eq_u64 vcc, 0
    s_nop 2
    s_cbranch_scc1 L_xr17_l
    s_add_u32 s93, s93, 1
    s_cmp_lt_u32 s93, 30000
    s_cbranch_scc1 L_xl17_l
    s_branch L_xr17_l
L_tail_n:
    s_mov_b32 s49, 0x2000000
    v_add_u32 v7, s52, v27
    v_add_u32 v39, s52, v8
    ds_read_b128 a[180:183], v7 offset:0
    ds_read_b128 a[184:187], v7 offset:1024
    ds_read_b128 a[188:191], v7 offset:2048
    ds_read_b128 a[192:195], v7 offset:3072
    ds_read_b128 a[196:199], v7 offset:4096
    ds_read_b128 a[200:203], v7 offset:5120
    ds_read_b128 a[204:207], v39 offset:0
    s_waitcnt vmcnt(22)
    s_waitcnt lgkmcnt(6)
    v_mfma_f32_16x16x32_bf16 v[64:67], a[180:183], a[0:3], 0
    buffer_load_dwordx2 v[54:55], v15, s[40:43], s85 offen sc1
    v_mfma_f32_16x16x32_bf16 v[92:95], a[180:183], a[4:7], 0
    ds_read_b128 a[180:183], v7 offset:6912
    s_waitcnt lgkmcnt(6)
    v_mfma_f32_16x16x32_bf16 v[68:71], a[184:187], a[0:3], 0
    v_mov_b32 v140, -1
    v_mov_b32 v141, -1
    v_mfma_f32_16x16x32_bf16 v[96:99], a[184:187], a[4:7], 0
    ds_read_b128 a[184:187], v7 offset:7936
    s_waitcnt lgkmcnt(6)
    v_mfma_f32_16x16x32_bf16 v[72:75], a[188:191], a[0:3], 0
    v_mov_b32 v142, -1
    v_mov_b32 v143, -1
    v_mfma_f32_16x16x32_bf16 v[100:103], a[188:191], a[4:7], 0
    ds_read_b128 a[188:191], v7 offset:8960
    s_waitcnt lgkmcnt(6)
    v_mfma_f32_16x16x32_bf16 v[76:79], a[192:195], a[0:3], 0
    s_mov_b32 s9, 0x2240000
    v_mfma_f32_16x16x32_bf16 v[104:107], a[192:195], a[4:7], 0
    ds_read_b128 a[192:195], v7 offset:9984
    s_waitcnt lgkmcnt(6)
    v_mfma_f32_16x16x32_bf16 v[80:83], a[0:3], a[196:199], 0
    buffer_store_dwordx4 v[140:143], v24, s[40:43], s9 offen sc1
    v_mfma_f32_16x16x32_bf16 v[108:111], a[4:7], a[196:199], 0
    ds_read_b128 a[196:199], v7 offset:11008
    s_waitcnt lgkmcnt(6)
    v_mfma_f32_16x16x32_bf16 v[84:87], a[0:3], a[200:203], 0
    s_mov_b32 s9, 0x2242000
    v_mfma_f32_16x16x32_bf16 v[112:115], a[4:7], a[200:203], 0
    ds_read_b128 a[200:203], v7 offset:12032
    s_waitcnt lgkmcnt(6)
    v_mfma_f32_16x16x32_bf16 v[88:91], a[204:207], a[0:3], 0
    v_mfma_f32_16x16x32_bf16 v[116:119], a[204:207], a[4:7], 0
    ds_read_b128 a[204:207], v39 offset:6912
    buffer_store_dwordx4 v[140:143], v24, s[40:43], s9 offen sc1
    s_add_u32 s8, s51, 20480
    buffer_load_dwordx4 a[120:123], v27, s[40:43], s8 offen offset:1024
    s_add_u32 s8, s51, 20480
    buffer_load_dwordx4 a[124:127], v27, s[40:43], s8 offen offset:2048
    s_add_u32 s8, s51, 20480
    buffer_load_dwordx4 a[128:131], v27, s[40:43], s8 offen offset:3072
    s_waitcnt vmcnt(26)
    s_waitcnt lgkmcnt(6)
    v_mfma_f32_16x16x32_bf16 v[64:67], a[180:183], a[8:11], v[64:67]
    s_mov_b32 s9, 0x2244000
    v_mfma_f32_16x16x32_bf16 v[92:95], a[180:183], a[12:15], v[92:95]
    ds_read_b128 a[180:183], v7 offset:13824
    s_waitcnt lgkmcnt(6)
    v_mfma_f32_16x16x32_bf16 v[68:71], a[184:187], a[8:11], v[68:71]
    v_mfma_f32_16x16x32_bf16 v[96:99], a[184:187], a[12:15], v[96:99]
    ds_read_b128 a[184:187], v7 offset:14848
    s_waitcnt lgkmcnt(6)
    v_mfma_f32_16x16x32_bf16 v[72:75], a[188:191], a[8:11], v[72:75]
    v_mfma_f32_16x16x32_bf16 v[100:103], a[188:191], a[12:15], v[100:103]
    ds_read_b128 a[188:191], v7 offset:15872
    s_waitcnt lgkmcnt(6)
    v_mfma_f32_16x16x32_bf16 v[76:79], a[192:195], a[8:11], v[76:79]
    v_mfma_f32_16x16x32_bf16 v[104:107], a[192:195], a[12:15], v[104:107]
    ds_read_b128 a[192:195], v7 offset:16896
    s_waitcnt lgkmcnt(6)
    v_mfma_f32_16x16x32_bf16 v[80:83], a[8:11], a[196:199], v[80:83]
    v_mfma_f32_16x16x32_bf16 v[108:111], a[12:15], a[196:199], v[108:111]
    ds_read_b128 a[196:199], v7 offset:17920
    s_waitcnt lgkmcnt(6)
    v_mfma_f32_16x16x32_bf16 v[84:87], a[8:11], a[200:203], v[84:87]
    buffer_store_dwordx4 v[140:143], v9, s[40:43], s9 offen sc1
    v_mfma_f32_16x16x32_bf16 v[112:115], a[12:15], a[200:203], v[112:115]
    ds_read_b128 a[200:203], v7 offset:18944
    s_waitcnt lgkmcnt(6)
    v_mfma_f32_16x16x32_bf16 v[88:91], a[204:207], a[8:11], v[88:91]
    s_add_u32 s9, s57, 0x2000000
    v_mfma_f32_16x16x32_bf16 v[116:119], a[204:207], a[12:15], v[116:119]
    ds_read_b128 a[204:207], v39 offset:13824
    buffer_store_dwordx4 v[140:143], v13, s[40:43], s9 offen sc1
    s_add_u32 s8, s51, 24576
    buffer_load_dwordx4 a[132:135], v27, s[40:43], s8 offen offset:0
    s_add_u32 s8, s51, 24576
    buffer_load_dwordx4 a[136:139], v27, s[40:43], s8 offen offset:1024
    s_add_u32 s8, s51, 24576
    buffer_load_dwordx4 a[140:143], v27, s[40:43], s8 offen offset:2048
    s_waitcnt vmcnt(29)
    s_waitcnt lgkmcnt(6)
    v_mfma_f32_16x16x32_bf16 v[64:67], a[180:183], a[16:19], v[64:67]
    s_add_u32 s9, s57, 0x2001000
    v_mfma_f32_16x16x32_bf16 v[92:95], a[180:183], a[20:23], v[92:95]
    ds_read_b128 a[180:183], v7 offset:20736
    s_waitcnt lgkmcnt(6)
    v_mfma_f32_16x16x32_bf16 v[68:71], a[184:187], a[16:19], v[68:71]
    v_mfma_f32_16x16x32_bf16 v[96:99], a[184:187], a[20:23], v[96:99]
    ds_read_b128 a[184:187], v7 offset:21760
    s_waitcnt lgkmcnt(6)
    v_mfma_f32_16x16x32_bf16 v[72:75], a[188:191], a[16:19], v[72:75]
    v_mfma_f32_16x16x32_bf16 v[100:103], a[188:191], a[20:23], v[100:103]
    ds_read_b128 a[188:191], v7 offset:22784
    s_waitcnt lgkmcnt(6)
    v_mfma_f32_16x16x32_bf16 v[76:79], a[192:195], a[16:19], v[76:79]
    v_mfma_f32_16x16x32_bf16 v[104:107], a[192:195], a[20:23], v[104:107]
    ds_read_b128 a[192:195], v7 offset:23808
    s_waitcnt lgkmcnt(6)
    v_mfma_f32_16x16x32_bf16 v[80:83], a[16:19], a[196:199], v[80:83]
    v_mfma_f32_16x16x32_bf16 v[108:111], a[20:23], a[196:199], v[108:111]
    ds_read_b128 a[196:199], v7 offset:24832
    s_waitcnt lgkmcnt(6)
    v_mfma_f32_16x16x32_bf16 v[84:87], a[16:19], a[200:203], v[84:87]
    buffer_store_dwordx4 v[140:143], v13, s[40:43], s9 offen sc1
    v_mfma_f32_16x16x32_bf16 v[112:115], a[20:23], a[200:203], v[112:115]
    ds_read_b128 a[200:203], v7 offset:25856
    s_waitcnt lgkmcnt(6)
    v_mfma_f32_16x16x32_bf16 v[88:91], a[204:207], a[16:19], v[88:91]
    s_add_u32 s9, s57, 0x2002000
    v_mfma_f32_16x16x32_bf16 v[116:119], a[204:207], a[20:23], v[116:119]
    ds_read_b128 a[204:207], v39 offset:20736
    buffer_store_dwordx4 v[140:143], v13, s[40:43], s9 offen sc1
    buffer_load_dwordx4 a[80:83], v250, s[40:43], s48 offen offset:2048 sc1
    buffer_load_dwordx4 a[84:87], v250, s[40:43], s61 offen offset:2048 sc1
    s_add_u32 s8, s92, 0
    buffer_load_dwordx4 a[144:147], v27, s[40:43], s8 offen offset:0
    s_waitcnt vmcnt(32)
    s_waitcnt lgkmcnt(6)
    v_mfma_f32_16x16x32_bf16 v[64:67], a[180:183], a[24:27], v[64:67]
    s_add_u32 s9, s57, 0x2003000
    v_mfma_f32_16x16x32_bf16 v[92:95], a[180:183], a[28:31], v[92:95]
    v_add_u32 v7, s53, v27
    v_add_u32 v39, s53, v8
    ds_read_b128 a[180:183], v7 offset:0
    s_waitcnt lgkmcnt(6)
    v_mfma_f32_16x16x32_bf16 v[68:71], a[184:187], a[24:27], v[68:71]
    v_mfma_f32_16x16x32_bf16 v[96:99], a[184:187], a[28:31], v[96:99]
    ds_read_b128 a[184:187], v7 offset:1024
    s_waitcnt lgkmcnt(6)
    v_mfma_f32_16x16x32_bf16 v[72:75], a[188:191], a[24:27], v[72:75]
    v_mfma_f32_16x16x32_bf16 v[100:103], a[188:191], a[28:31], v[100:103]
    ds_read_b128 a[188:191], v7 offset:2048
    s_waitcnt lgkmcnt(6)
    v_mfma_f32_16x16x32_bf16 v[76:79], a[192:195], a[24:27], v[76:79]
    v_mfma_f32_16x16x32_bf16 v[104:107], a[192:195], a[28:31], v[104:107]
    ds_read_b128 a[192:195], v7 offset:3072
    s_waitcnt lgkmcnt(6)
    v_mfma_f32_16x16x32_bf16 v[80:83], a[24:27], a[196:199], v[80:83]
    v_mfma_f32_16x16x32_bf16 v[108:111], a[28:31], a[196:199], v[108:111]
    ds_read_b128 a[196:199], v7 offset:4096
    s_waitcnt lgkmcnt(6)
    v_mfma_f32_16x16x32_bf16 v[84:87], a[24:27], a[200:203], v[84:87]
    buffer_store_dwordx4 v[140:143], v13, s[40:43], s9 offen sc1
    v_mfma_f32_16x16x32_bf16 v[112:115], a[28:31], a[200:203], v[112:115]
    ds_read_b128 a[200:203], v7 offset:5120
    s_waitcnt lgkmcnt(6)
    v_mfma_f32_16x16x32_bf16 v[88:91], a[204:207], a[24:27], v[88:91]
    s_add_u32 s9, s57, 0x2004000
    v_mfma_f32_16x16x32_bf16 v[116:119], a[204:207], a[28:31], v[116:119]
    ds_read_b128 a[204:207], v39 offset:0
    buffer_store_dwordx4 v[140:143], v13, s[40:43], s9 offen sc1
    buffer_load_dwordx4 a[88:91], v250, s[40:43], s48 offen offset:3072 sc1
    buffer_load_dwordx4 a[92:95], v250, s[40:43], s61 offen offset:3072 sc1
    s_add_u32 s8, s92, 0
    buffer_load_dwordx4 a[148:151], v27, s[40:43], s8 offen offset:1024
    s_waitcnt vmcnt(20)
    v_cmp_ne_u64 vcc, v[30:31], v[54:55]
    s_nop 0
    s_cmp_eq_u64 vcc, 0
    s_cbranch_scc1 L_pd19_n
    s_mov_b32 s93, 0
    s_nop 1
L_pl18_n:
    s_sleep 2
    buffer_load_dwordx2 v[54:55], v15, s[40:43], s85 offen sc1
    s_waitcnt vmcnt(0)
    v_cmp_ne_u64 vcc, v[30:31], v[54:55]
    s_nop 0
    s_cmp_eq_u64 vcc, 0
    s_cbranch_scc1 L_pd19_n
    s_add_u32 s93, s93, 1
    s_cmp_lt_u32 s93, 30000
    s_cbranch_scc1 L_pl18_n
L_pd19_n:
    s_nop 0
    s_waitcnt lgkmcnt(6)
    v_mfma_f32_16x16x32_bf16 v[64:67], a[180:183], a[32:35], v[64:67]
    s_add_u32 s9, s57, 0x2005000
    v_mfma_f32_16x16x32_bf16 v[92:95], a[180:183], a[36:39], v[92:95]
    ds_read_b128 a[180:183], v7 offset:6912
    s_waitcnt lgkmcnt(6)
    v_mfma_f32_16x16x32_bf16 v[68:71], a[184:187], a[32:35], v[68:71]
    v_mfma_f32_16x16x32_bf16 v[96:99], a[184:187], a[36:39], v[96:99]
    ds_read_b128 a[184:187], v7 offset:7936
    s_waitcnt lgkmcnt(6)
    v_mfma_f32_16x16x32_bf16 v[72:75], a[188:191], a[32:35], v[72:75]
    v_mfma_f32_16x16x32_bf16 v[100:103], a[188:191], a[36:39], v[100:103]
    ds_read_b128 a[188:191], v7 offset:8960
    s_waitcnt lgkmcnt(6)
    v_mfma_f32_16x16x32_bf16 v[76:79], a[192:195], a[32:35], v[76:79]
    v_mfma_f32_16x16x32_bf16 v[104:107], a[192:195], a[36:39], v[104:107]
    ds_read_b128 a[192:195], v7 offset:9984
    s_waitcnt lgkmcnt(6)
    v_mfma_f32_16x16x32_bf16 v[80:83], a[32:35], a[196:199], v[80:83]
    v_mfma_f32_16x16x32_bf16 v[108:111], a[36:39], a[196:199], v[108:111]
    ds_read_b128 a[196:199], v7 offset:11008
    s_waitcnt lgkmcnt(6)
    v_mfma_f32_16x16x32_bf16 v[84:87], a[32:35], a[200:203], v[84:87]
    buffer_store_dwordx4 v[140:143], v13, s[40:43], s9 offen sc1
    v_mfma_f32_16x16x32_bf16 v[112:115], a[36:39], a[200:203], v[112:115]
    ds_read_b128 a[200:203], v7 offset:12032
    s_waitcnt lgkmcnt(6)
    v_mfma_f32_16x16x32_bf16 v[88:91], a[204:207], a[32:35], v[88:91]
    s_add_u32 s9, s57, 0x2006000
    v_mfma_f32_16x16x32_bf16 v[116:119], a[204:207], a[36:39], v[116:119]
    ds_read_b128 a[204:207], v39 offset:6912
    buffer_store_dwordx4 v[140:143], v13, s[40:43], s9 offen sc1
    buffer_load_dwordx4 a[96:99], v250, s[40:43], s60 offen offset:0 sc1
    buffer_load_dwordx4 a[100:103], v250, s[40:43], s62 offen offset:0 sc1
    buffer_load_dwordx4 a[208:211], v246, s[40:43], s77 offen sc1
    s_waitcnt lgkmcnt(6)
    v_mfma_f32_16x16x32_bf16 v[64:67], a[180:183], a[40:43], v[64:67]
    s_add_u32 s9, s57, 0x2007000
    v_mfma_f32_16x16x32_bf16 v[92:95], a[180:183], a[44:47], v[92:95]
    ds_read_b128 a[180:183], v7 offset:13824
    s_waitcnt lgkmcnt(6)
    v_mfma_f32_16x16x32_bf16 v[68:71], a[184:187], a[40:43], v[68:71]
    v_mfma_f32_16x16x32_bf16 v[96:99], a[184:187], a[44:47], v[96:99]
    ds_read_b128 a[184:187], v7 offset:14848
    s_waitcnt lgkmcnt(6)
    v_mfma_f32_16x16x32_bf16 v[72:75], a[188:191], a[40:43], v[72:75]
    v_mfma_f32_16x16x32_bf16 v[100:103], a[188:191], a[44:47], v[100:103]
    ds_read_b128 a[188:191], v7 offset:15872
    s_waitcnt lgkmcnt(6)
    v_mfma_f32_16x16x32_bf16 v[76:79], a[192:195], a[40:43], v[76:79]
    v_mfma_f32_16x16x32_bf16 v[104:107], a[192:195], a[44:47], v[104:107]
    ds_read_b128 a[192:195], v7 offset:16896
    s_waitcnt lgkmcnt(6)
    v_mfma_f32_16x16x32_bf16 v[80:83], a[40:43], a[196:199], v[80:83]
    v_mfma_f32_16x16x32_bf16 v[108:111], a[44:47], a[196:199], v[108:111]
    ds_read_b128 a[196:199], v7 offset:17920
    s_waitcnt lgkmcnt(6)
    v_mfma_f32_16x16x32_bf16 v[84:87], a[40:43], a[200:203], v[84:87]
    buffer_store_dwordx4 v[140:143], v13, s[40:43], s9 offen sc1
    v_mfma_f32_16x16x32_bf16 v[112:115], a[44:47], a[200:203], v[112:115]
    ds_read_b128 a[200:203], v7 offset:18944
    s_waitcnt lgkmcnt(6)
    v_mfma_f32_16x16x32_bf16 v[88:91], a[204:207], a[40:43], v[88:91]
    s_add_u32 s9, s57, 0x2008000
    v_mfma_f32_16x16x32_bf16 v[116:119], a[204:207], a[44:47], v[116:119]
    ds_read_b128 a[204:207], v39 offset:13824
    buffer_store_dwordx4 v[140:143], v13, s[40:43], s9 offen sc1
    buffer_load_dwordx4 a[104:107], v251, s[40:43], s48 offen offset:0 sc1
    buffer_load_dwordx4 a[108:111], v251, s[40:43], s61 offen offset:0 sc1
    buffer_load_dwordx4 a[212:215], v246, s[40:43], s78 offen sc1
    s_waitcnt lgkmcnt(6)
    v_mfma_f32_16x16x32_bf16 v[64:67], a[180:183], a[48:51], v[64:67]
    v_mfma_f32_16x16x32_bf16 v[92:95], a[180:183], a[52:55], v[92:95]
    ds_read_b128 a[180:183], v7 offset:20736
    s_waitcnt lgkmcnt(6)
    v_mfma_f32_16x16x32_bf16 v[68:71], a[184:187], a[48:51], v[68:71]
    v_mfma_f32_16x16x32_bf16 v[96:99], a[184:187], a[52:55], v[96:99]
    ds_read_b128 a[184:187], v7 offset:21760
    s_waitcnt lgkmcnt(6)
    v_mfma_f32_16x16x32_bf16 v[72:75], a[188:191], a[48:51], v[72:75]
    buffer_load_dwordx4 a[112:115], v251, s[40:43], s48 offen offset:1024 sc1
    v_mfma_f32_16x16x32_bf16 v[100:103], a[188:191], a[52:55], v[100:103]
    ds_read_b128 a[188:191], v7 offset:22784
    s_waitcnt lgkmcnt(6)
    v_mfma_f32_16x16x32_bf16 v[76:79], a[192:195], a[48:51], v[76:79]
    v_mfma_f32_16x16x32_bf16 v[104:107], a[192:195], a[52:55], v[104:107]
    ds_read_b128 a[192:195], v7 offset:23808
    s_waitcnt lgkmcnt(6)
    v_mfma_f32_16x16x32_bf16 v[80:83], a[48:51], a[196:199], v[80:83]
    buffer_load_dwordx4 a[116:119], v251, s[40:43], s61 offen offset:1024 sc1
    v_mfma_f32_16x16x32_bf16 v[108:111], a[52:55], a[196:199], v[108:111]
    ds_read_b128 a[196:199], v7 offset:24832
    s_waitcnt lgkmcnt(6)
    v_mfma_f32_16x16x32_bf16 v[84:87], a[48:51], a[200:203], v[84:87]
    v_mfma_f32_16x16x32_bf16 v[112:115], a[52:55], a[200:203], v[112:115]
    ds_read_b128 a[200:203], v7 offset:25856
    s_waitcnt lgkmcnt(6)
    v_mfma_f32_16x16x32_bf16 v[88:91], a[204:207], a[48:51], v[88:91]
    buffer_load_dwordx4 a[216:219], v246, s[40:43], s79 offen sc1
    v_mfma_f32_16x16x32_bf16 v[116:119], a[204:207], a[52:55], v[116:119]
    ds_read_b128 a[204:207], v39 offset:20736
    s_waitcnt lgkmcnt(6)
    v_mfma_f32_16x16x32_bf16 v[64:67], a[180:183], a[56:59], v[64:67]
    v_mfma_f32_16x16x32_bf16 v[92:95], a[180:183], a[60:63], v[92:95]
    v_add_u32 v7, s54, v27
    v_add_u32 v39, s54, v8
    ds_read_b128 a[180:183], v7 offset:0
    s_waitcnt lgkmcnt(6)
    v_mfma_f32_16x16x32_bf16 v[68:71], a[184:187], a[56:59], v[68:71]
    buffer_load_dwordx4 a[228:231], v251, s[40:43], s48 offen offset:2048 sc1
    v_mfma_f32_16x16x32_bf16 v[96:99], a[184:187], a[60:63], v[96:99]
    ds_read_b128 a[184:187], v7 offset:1024
    s_waitcnt lgkmcnt(6)
    v_mfma_f32_16x16x32_bf16 v[72:75], a[188:191], a[56:59], v[72:75]
    v_mfma_f32_16x16x32_bf16 v[100:103], a[188:191], a[60:63], v[100:103]
    ds_read_b128 a[188:191], v7 offset:2048
    s_waitcnt lgkmcnt(6)
    v_mfma_f32_16x16x32_bf16 v[76:79], a[192:195], a[56:59], v[76:79]
    buffer_load_dwordx4 a[232:235], v251, s[40:43], s61 offen offset:2048 sc1
    v_mfma_f32_16x16x32_bf16 v[104:107], a[192:195], a[60:63], v[104:107]
    ds_read_b128 a[192:195], v7 offset:3072
    s_waitcnt lgkmcnt(6)
    v_mfma_f32_16x16x32_bf16 v[80:83], a[56:59], a[196:199], v[80:83]
    v_mfma_f32_16x16x32_bf16 v[108:111], a[60:63], a[196:199], v[108:111]
    ds_read_b128 a[196:199], v7 offset:4096
    s_waitcnt lgkmcnt(6)
    v_mfma_f32_16x16x32_bf16 v[84:87], a[56:59], a[200:203], v[84:87]
    buffer_load_dwordx4 a[220:223], v246, s[40:43], s80 offen sc1
    v_mfma_f32_16x16x32_bf16 v[112:115], a[60:63], a[200:203], v[112:115]
    ds_read_b128 a[200:203], v7 offset:5120
    s_waitcnt lgkmcnt(6)
    v_mfma_f32_16x16x32_bf16 v[88:91], a[204:207], a[56:59], v[88:91]
    v_mfma_f32_16x16x32_bf16 v[116:119], a[204:207], a[60:63], v[116:119]
    ds_read_b128 a[204:207], v39 offset:0
    s_waitcnt lgkmcnt(6)
    v_mfma_f32_16x16x32_bf16 v[64:67], a[180:183], a[64:67], v[64:67]
    buffer_load_dwordx4 a[236:239], v251, s[40:43], s48 offen offset:3072 sc1
    v_mfma_f32_16x16x32_bf16 v[92:95], a[180:183], a[68:71], v[92:95]
    ds_read_b128 a[180:183], v7 offset:6912
    s_waitcnt lgkmcnt(6)
    v_mfma_f32_16x16x32_bf16 v[68:71], a[184:187], a[64:67], v[68:71]
    v_mfma_f32_16x16x32_bf16 v[96:99], a[184:187], a[68:71], v[96:99]
    ds_read_b128 a[184:187], v7 offset:7936
    s_waitcnt lgkmcnt(6)
    v_mfma_f32_16x16x32_bf16 v[72:75], a[188:191], a[64:67], v[72:75]
    buffer_load_dwordx4 a[240:243], v251, s[40:43], s61 offen offset:3072 sc1
    v_mfma_f32_16x16x32_bf16 v[100:103], a[188:191], a[68:71], v[100:103]
    ds_read_b128 a[188:191], v7 offset:8960
    s_waitcnt lgkmcnt(6)
    v_mfma_f32_16x16x32_bf16 v[76:79], a[192:195], a[64:67], v[76:79]
    v_mfma_f32_16x16x32_bf16 v[104:107], a[192:195], a[68:71], v[104:107]
    ds_read_b128 a[192:195], v7 offset:9984
    s_waitcnt lgkmcnt(6)
    v_mfma_f32_16x16x32_bf16 v[80:83], a[64:67], a[196:199], v[80:83]
    buffer_load_dwordx4 a[224:227], v247, s[40:43], s81 offen sc1
    v_mfma_f32_16x16x32_bf16 v[108:111], a[68:71], a[196:199], v[108:111]
    ds_read_b128 a[196:199], v7 offset:11008
    s_waitcnt lgkmcnt(6)
    v_mfma_f32_16x16x32_bf16 v[84:87], a[64:67], a[200:203], v[84:87]
    v_mfma_f32_16x16x32_bf16 v[112:115], a[68:71], a[200:203], v[112:115]
    ds_read_b128 a[200:203], v7 offset:12032
    s_waitcnt lgkmcnt(6)
    v_mfma_f32_16x16x32_bf16 v[88:91], a[204:207], a[64:67], v[88:91]
    v_mfma_f32_16x16x32_bf16 v[116:119], a[204:207], a[68:71], v[116:119]
    ds_read_b128 a[204:207], v39 offset:6912
    s_waitcnt lgkmcnt(6)
    v_mfma_f32_16x16x32_bf16 v[64:67], a[180:183], a[72:75], v[64:67]
    buffer_load_dwordx4 a[244:247], v251, s[40:43], s60 offen offset:0 sc1
    v_mfma_f32_16x16x32_bf16 v[92:95], a[180:183], a[76:79], v[92:95]
    ds_read_b128 a[180:183], v7 offset:13824
    s_waitcnt lgkmcnt(6)
    v_mfma_f32_16x16x32_bf16 v[68:71], a[184:187], a[72:75], v[68:71]
    v_mfma_f32_16x16x32_bf16 v[96:99], a[184:187], a[76:79], v[96:99]
    ds_read_b128 a[184:187], v7 offset:14848
    s_waitcnt lgkmcnt(6)
    v_mfma_f32_16x16x32_bf16 v[72:75], a[188:191], a[72:75], v[72:75]
    buffer_load_dwordx4 a[248:251], v251, s[40:43], s62 offen offset:0 sc1
    s_add_u32 s8, s92, 0
    v_mfma_f32_16x16x32_bf16 v[100:103], a[188:191], a[76:79], v[100:103]
    ds_read_b128 a[188:191], v7 offset:15872
    s_waitcnt lgkmcnt(6)
    v_mfma_f32_16x16x32_bf16 v[76:79], a[192:195], a[72:75], v[76:79]
    v_mfma_f32_16x16x32_bf16 v[104:107], a[192:195], a[76:79], v[104:107]
    ds_read_b128 a[192:195], v7 offset:16896
    s_waitcnt lgkmcnt(6)
    v_mfma_f32_16x16x32_bf16 v[80:83], a[72:75], a[196:199], v[80:83]
    buffer_load_dwordx4 a[152:155], v27, s[40:43], s8 offen offset:2048
    v_mfma_f32_16x16x32_bf16 v[108:111], a[76:79], a[196:199], v[108:111]
    ds_read_b128 a[196:199], v7 offset:17920
    s_waitcnt lgkmcnt(6)
    v_mfma_f32_16x16x32_bf16 v[84:87], a[72:75], a[200:203], v[84:87]
    v_mfma_f32_16x16x32_bf16 v[112:115], a[76:79], a[200:203], v[112:115]
    ds_read_b128 a[200:203], v7 offset:18944
    s_waitcnt lgkmcnt(6)
    v_mfma_f32_16x16x32_bf16 v[88:91], a[204:207], a[72:75], v[88:91]
    v_mfma_f32_16x16x32_bf16 v[116:119], a[204:207], a[76:79], v[116:119]
    ds_read_b128 a[204:207], v39 offset:13824
    s_waitcnt vmcnt(17)
    s_waitcnt lgkmcnt(6)
    v_mfma_f32_16x16x32_bf16 v[64:67], a[180:183], a[80:83], v[64:67]
    s_add_u32 s8, s92, 0
    buffer_load_dwordx4 a[156:159], v27, s[40:43], s8 offen offset:3072
    v_mfma_f32_16x16x32_bf16 v[92:95], a[180:183], a[84:87], v[92:95]
    ds_read_b128 a[180:183], v7 offset:20736
    s_waitcnt lgkmcnt(6)
    v_mfma_f32_16x16x32_bf16 v[68:71], a[184:187], a[80:83], v[68:71]
    s_add_u32 s8, s92, 4096
    v_mfma_f32_16x16x32_bf16 v[96:99], a[184:187], a[84:87], v[96:99]
    ds_read_b128 a[184:187], v7 offset:21760
    s_waitcnt lgkmcnt(6)
    v_mfma_f32_16x16x32_bf16 v[72:75], a[188:191], a[80:83], v[72:75]
    buffer_load_dwordx4 a[160:163], v27, s[40:43], s8 offen offset:0
    s_add_u32 s8, s92, 4096
    v_mfma_f32_16x16x32_bf16 v[100:103], a[188:191], a[84:87], v[100:103]
    v_mfma_f32_16x16x32_bf16 v[120:123], a[188:191], a[208:211], 0
    ds_read_b128 a[188:191], v7 offset:22784
    s_waitcnt lgkmcnt(6)
    v_mfma_f32_16x16x32_bf16 v[76:79], a[192:195], a[80:83], v[76:79]
    v_mfma_f32_16x16x32_bf16 v[104:107], a[192:195], a[84:87], v[104:107]
    buffer_load_dwordx4 a[164:167], v27, s[40:43], s8 offen offset:1024
    s_add_u32 s8, s92, 4096
    v_mfma_f32_16x16x32_bf16 v[124:127], a[192:195], a[208:211], 0
    ds_read_b128 a[192:195], v7 offset:23808
    s_waitcnt lgkmcnt(6)
    v_mfma_f32_16x16x32_bf16 v[80:83], a[80:83], a[196:199], v[80:83]
    v_mfma_f32_16x16x32_bf16 v[108:111], a[84:87], a[196:199], v[108:111]
    v_mfma_f32_16x16x32_bf16 v[128:131], a[208:211], a[196:199], 0
    ds_read_b128 a[196:199], v7 offset:24832
    s_waitcnt lgkmcnt(6)
    v_mfma_f32_16x16x32_bf16 v[84:87], a[80:83], a[200:203], v[84:87]
    buffer_load_dwordx4 a[168:171], v27, s[40:43], s8 offen offset:2048
    v_mfma_f32_16x16x32_bf16 v[112:115], a[84:87], a[200:203], v[112:115]
    v_mfma_f32_16x16x32_bf16 v[132:135], a[208:211], a[200:203], 0
    ds_read_b128 a[200:203], v7 offset:25856
    s_waitcnt lgkmcnt(6)
    v_mfma_f32_16x16x32_bf16 v[88:91], a[204:207], a[80:83], v[88:91]
    v_mfma_f32_16x16x32_bf16 v[116:119], a[204:207], a[84:87], v[116:119]
    v_mfma_f32_16x16x32_bf16 v[136:139], a[204:207], a[208:211], 0
    ds_read_b128 a[204:207], v39 offset:20736
    s_waitcnt vmcnt(16)
    s_waitcnt lgkmcnt(6)
    v_mfma_f32_16x16x32_bf16 v[64:67], a[180:183], a[88:91], v[64:67]
    s_add_u32 s8, s92, 4096
    buffer_load_dwordx4 a[172:175], v27, s[40:43], s8 offen offset:3072
    v_mfma_f32_16x16x32_bf16 v[92:95], a[180:183], a[92:95], v[92:95]
    ds_read_b128 a[180:183], v7 offset:27648
    s_waitcnt lgkmcnt(6)
    v_mfma_f32_16x16x32_bf16 v[68:71], a[184:187], a[88:91], v[68:71]
    s_add_u32 s8, s92, 8192
    v_mfma_f32_16x16x32_bf16 v[96:99], a[184:187], a[92:95], v[96:99]
    ds_read_b128 a[184:187], v7 offset:28672
    s_waitcnt lgkmcnt(6)
    v_mfma_f32_16x16x32_bf16 v[72:75], a[188:191], a[88:91], v[72:75]
    buffer_load_dwordx4 a[176:179], v27, s[40:43], s8 offen offset:0
    s_add_u32 s8, s50, 0
    v_mfma_f32_16x16x32_bf16 v[100:103], a[188:191], a[92:95], v[100:103]
    v_mfma_f32_16x16x32_bf16 v[120:123], a[188:191], a[212:215], v[120:123]
    ds_read_b128 a[188:191], v7 offset:29696
    s_waitcnt lgkmcnt(6)
    v_mfma_f32_16x16x32_bf16 v[76:79], a[192:195], a[88:91], v[76:79]
    v_mfma_f32_16x16x32_bf16 v[104:107], a[192:195], a[92:95], v[104:107]
    buffer_load_dwordx4 a[0:3], v27, s[40:43], s8 offen offset:0
    s_add_u32 s8, s50, 0
    v_mfma_f32_16x16x32_bf16 v[124:127], a[192:195], a[212:215], v[124:127]
    ds_read_b128 a[192:195], v7 offset:30720
    s_waitcnt lgkmcnt(6)
    v_mfma_f32_16x16x32_bf16 v[80:83], a[88:91], a[196:199], v[80:83]
    v_mfma_f32_16x16x32_bf16 v[108:111], a[92:95], a[196:199], v[108:111]
    v_mfma_f32_16x16x32_bf16 v[128:131], a[212:215], a[196:199], v[128:131]
    ds_read_b128 a[196:199], v7 offset:31744
    s_waitcnt lgkmcnt(6)
    v_mfma_f32_16x16x32_bf16 v[84:87], a[88:91], a[200:203], v[84:87]
    buffer_load_dwordx4 a[4:7], v27, s[40:43], s8 offen offset:1024
    v_mfma_f32_16x16x32_bf16 v[112:115], a[92:95], a[200:203], v[112:115]
    v_mfma_f32_16x16x32_bf16 v[132:135], a[212:215], a[200:203], v[132:135]
    ds_read_b128 a[200:203], v7 offset:32768
    s_waitcnt lgkmcnt(6)
    v_mfma_f32_16x16x32_bf16 v[88:91], a[204:207], a[88:91], v[88:91]
    v_mfma_f32_16x16x32_bf16 v[116:119], a[204:207], a[92:95], v[116:119]
    v_mfma_f32_16x16x32_bf16 v[136:139], a[204:207], a[212:215], v[136:139]
    ds_read_b128 a[204:207], v39 offset:27648
    s_waitcnt vmcnt(17)
    s_waitcnt lgkmcnt(6)
    v_mfma_f32_16x16x32_bf16 v[64:67], a[180:183], a[96:99], v[64:67]
    s_add_u32 s8, s50, 0
    buffer_load_dwordx4 a[8:11], v27, s[40:43], s8 offen offset:2048
    v_mfma_f32_16x16x32_bf16 v[92:95], a[180:183], a[100:103], v[92:95]
    v_add_u32 v7, s55, v27
    v_add_u32 v39, s55, v8
    ds_read_b128 a[180:183], v7 offset:0
    s_waitcnt lgkmcnt(6)
    v_mfma_f32_16x16x32_bf16 v[68:71], a[184:187], a[96:99], v[68:71]
    s_add_u32 s8, s50, 0
    v_mfma_f32_16x16x32_bf16 v[96:99], a[184:187], a[100:103], v[96:99]
    ds_read_b128 a[184:187], v7 offset:1024
    s_waitcnt lgkmcnt(6)
    v_mfma_f32_16x16x32_bf16 v[72:75], a[188:191], a[96:99], v[72:75]
    buffer_load_dwordx4 a[12:15], v27, s[40:43], s8 offen offset:3072
    s_add_u32 s8, s50, 4096
    v_mfma_f32_16x16x32_bf16 v[100:103], a[188:191], a[100:103], v[100:103]
    v_mfma_f32_16x16x32_bf16 v[120:123], a[188:191], a[216:219], v[120:123]
    ds_read_b128 a[188:191], v7 offset:2048
    s_waitcnt lgkmcnt(6)
    v_mfma_f32_16x16x32_bf16 v[76:79], a[192:195], a[96:99], v[76:79]
    v_mfma_f32_16x16x32_bf16 v[104:107], a[192:195], a[100:103], v[104:107]
    buffer_load_dwordx4 a[16:19], v27, s[40:43], s8 offen offset:0
    s_add_u32 s8, s50, 4096
    v_mfma_f32_16x16x32_bf16 v[124:127], a[192:195], a[216:219], v[124:127]
    ds_read_b128 a[192:195], v7 offset:3072
    s_waitcnt lgkmcnt(6)
    v_mfma_f32_16x16x32_bf16 v[80:83], a[96:99], a[196:199], v[80:83]
    v_mfma_f32_16x16x32_bf16 v[108:111], a[100:103], a[196:199], v[108:111]
    v_mfma_f32_16x16x32_bf16 v[128:131], a[216:219], a[196:199], v[128:131]
    ds_read_b128 a[196:199], v7 offset:4096
    s_waitcnt lgkmcnt(6)
    v_mfma_f32_16x16x32_bf16 v[84:87], a[96:99], a[200:203], v[84:87]
    buffer_load_dwordx4 a[20:23], v27, s[40:43], s8 offen offset:1024
    v_mfma_f32_16x16x32_bf16 v[112:115], a[100:103], a[200:203], v[112:115]
    v_mfma_f32_16x16x32_bf16 v[132:135], a[216:219], a[200:203], v[132:135]
    ds_read_b128 a[200:203], v7 offset:5120
    s_waitcnt lgkmcnt(6)
    v_mfma_f32_16x16x32_bf16 v[88:91], a[204:207], a[96:99], v[88:91]
    v_mfma_f32_16x16x32_bf16 v[116:119], a[204:207], a[100:103], v[116:119]
    v_mfma_f32_16x16x32_bf16 v[136:139], a[204:207], a[216:219], v[136:139]
    ds_read_b128 a[204:207], v39 offset:0
    s_waitcnt vmcnt(18)
    s_waitcnt lgkmcnt(6)
    v_mfma_f32_16x16x32_bf16 v[64:67], a[180:183], a[104:107], v[64:67]
    s_add_u32 s8, s50, 4096
    buffer_load_dwordx4 a[24:27], v27, s[40:43], s8 offen offset:2048
    v_mfma_f32_16x16x32_bf16 v[92:95], a[180:183], a[108:111], v[92:95]
    ds_read_b128 a[180:183], v7 offset:6912
    s_waitcnt lgkmcnt(6)
    v_mfma_f32_16x16x32_bf16 v[68:71], a[184:187], a[104:107], v[68:71]
    s_add_u32 s8, s50, 4096
    v_mfma_f32_16x16x32_bf16 v[96:99], a[184:187], a[108:111], v[96:99]
    ds_read_b128 a[184:187], v7 offset:7936
    s_waitcnt lgkmcnt(6)
    v_mfma_f32_16x16x32_bf16 v[72:75], a[188:191], a[104:107], v[72:75]
    buffer_load_dwordx4 a[28:31], v27, s[40:43], s8 offen offset:3072
    s_add_u32 s8, s50, 8192
    v_mfma_f32_16x16x32_bf16 v[100:103], a[188:191], a[108:111], v[100:103]
    v_mfma_f32_16x16x32_bf16 v[120:123], a[188:191], a[220:223], v[120:123]
    ds_read_b128 a[188:191], v7 offset:8960
    s_waitcnt lgkmcnt(6)
    v_mfma_f32_16x16x32_bf16 v[76:79], a[192:195], a[104:107], v[76:79]
    v_mfma_f32_16x16x32_bf16 v[104:107], a[192:195], a[108:111], v[104:107]
    buffer_load_dwordx4 a[32:35], v27, s[40:43], s8 offen offset:0
    s_add_u32 s8, s51, 0
    v_mfma_f32_16x16x32_bf16 v[124:127], a[192:195], a[220:223], v[124:127]
    ds_read_b128 a[192:195], v7 offset:9984
    s_waitcnt lgkmcnt(6)
    v_mfma_f32_16x16x32_bf16 v[80:83], a[104:107], a[196:199], v[80:83]
    v_mfma_f32_16x16x32_bf16 v[108:111], a[108:111], a[196:199], v[108:111]
    v_mfma_f32_16x16x32_bf16 v[128:131], a[220:223], a[196:199], v[128:131]
    ds_read_b128 a[196:199], v7 offset:11008
    s_waitcnt lgkmcnt(6)
    v_mfma_f32_16x16x32_bf16 v[84:87], a[104:107], a[200:203], v[84:87]
    buffer_load_dwordx4 a[36:39], v27, s[40:43], s8 offen offset:0
    v_mfma_f32_16x16x32_bf16 v[112:115], a[108:111], a[200:203], v[112:115]
    v_mfma_f32_16x16x32_bf16 v[132:135], a[220:223], a[200:203], v[132:135]
    ds_read_b128 a[200:203], v7 offset:12032
    s_waitcnt lgkmcnt(6)
    v_mfma_f32_16x16x32_bf16 v[88:91], a[204:207], a[104:107], v[88:91]
    v_mfma_f32_16x16x32_bf16 v[116:119], a[204:207], a[108:111], v[116:119]
    v_mfma_f32_16x16x32_bf16 v[136:139], a[204:207], a[220:223], v[136:139]
    ds_read_b128 a[204:207], v39 offset:6912
    s_waitcnt vmcnt(19)
    s_waitcnt lgkmcnt(6)
    v_mfma_f32_16x16x32_bf16 v[64:67], a[180:183], a[112:115], v[64:67]
    v_mfma_f32_16x16x32_bf16 v[92:95], a[180:183], a[116:119], v[92:95]
    ds_read_b128 a[180:183], v7 offset:13824
    s_waitcnt lgkmcnt(6)
    v_mfma_f32_16x16x32_bf16 v[68:71], a[184:187], a[112:115], v[68:71]
    v_mfma_f32_16x16x32_bf16 v[96:99], a[184:187], a[116:119], v[96:99]
    ds_read_b128 a[184:187], v7 offset:14848
    s_waitcnt lgkmcnt(6)
    v_mfma_f32_16x16x32_bf16 v[72:75], a[188:191], a[112:115], v[72:75]
    v_mfma_f32_16x16x32_bf16 v[100:103], a[188:191], a[116:119], v[100:103]
    v_mfma_f32_16x16x32_bf16 v[120:123], a[188:191], a[224:227], v[120:123]
    ds_read_b128 a[188:191], v7 offset:15872
    s_waitcnt lgkmcnt(6)
    v_mfma_f32_16x16x32_bf16 v[76:79], a[192:195], a[112:115], v[76:79]
    v_mfma_f32_16x16x32_bf16 v[104:107], a[192:195], a[116:119], v[104:107]
    v_mfma_f32_16x16x32_bf16 v[124:127], a[192:195], a[224:227], v[124:127]
    ds_read_b128 a[192:195], v7 offset:16896
    s_waitcnt lgkmcnt(6)
    v_mfma_f32_16x16x32_bf16 v[80:83], a[112:115], a[196:199], v[80:83]
    v_mfma_f32_16x16x32_bf16 v[108:111], a[116:119], a[196:199], v[108:111]
    v_mfma_f32_16x16x32_bf16 v[128:131], a[224:227], a[196:199], v[128:131]
    ds_read_b128 a[196:199], v7 offset:17920
    s_waitcnt lgkmcnt(6)
    v_mfma_f32_16x16x32_bf16 v[84:87], a[112:115], a[200:203], v[84:87]
    v_mfma_f32_16x16x32_bf16 v[112:115], a[116:119], a[200:203], v[112:115]
    v_mfma_f32_16x16x32_bf16 v[132:135], a[224:227], a[200:203], v[132:135]
    ds_read_b128 a[200:203], v7 offset:18944
    s_waitcnt lgkmcnt(6)
    v_mfma_f32_16x16x32_bf16 v[88:91], a[204:207], a[112:115], v[88:91]
    v_mfma_f32_16x16x32_bf16 v[116:119], a[204:207], a[116:119], v[116:119]
    v_mfma_f32_16x16x32_bf16 v[136:139], a[204:207], a[224:227], v[136:139]
    ds_read_b128 a[204:207], v39 offset:13824
    s_waitcnt lgkmcnt(6)
    v_mfma_f32_16x16x32_bf16 v[64:67], a[180:183], a[228:231], v[64:67]
    ds_write_b128 v36, v[120:123] offset:0
    v_mfma_f32_16x16x32_bf16 v[92:95], a[180:183], a[232:235], v[92:95]
    ds_read_b128 a[180:183], v7 offset:20736
    s_waitcnt lgkmcnt(7)
    v_mfma_f32_16x16x32_bf16 v[68:71], a[184:187], a[228:231], v[68:71]
    ds_write_b128 v36, v[124:127] offset:4096
    v_mfma_f32_16x16x32_bf16 v[96:99], a[184:187], a[232:235], v[96:99]
    ds_read_b128 a[184:187], v7 offset:21760
    s_waitcnt lgkmcnt(8)
    v_mfma_f32_16x16x32_bf16 v[72:75], a[188:191], a[228:231], v[72:75]
    ds_write_b128 v36, v[128:131] offset:8192
    v_mfma_f32_16x16x32_bf16 v[100:103], a[188:191], a[232:235], v[100:103]
    ds_read_b128 a[188:191], v7 offset:22784
    s_waitcnt lgkmcnt(9)
    v_mfma_f32_16x16x32_bf16 v[76:79], a[192:195], a[228:231], v[76:79]
    ds_write_b128 v36, v[132:135] offset:12288
    v_mfma_f32_16x16x32_bf16 v[104:107], a[192:195], a[232:235], v[104:107]
    ds_read_b128 a[192:195], v7 offset:23808
    s_waitcnt lgkmcnt(10)
    v_mfma_f32_16x16x32_bf16 v[80:83], a[228:231], a[196:199], v[80:83]
    ds_write_b128 v36, v[136:139] offset:16384
    v_mfma_f32_16x16x32_bf16 v[108:111], a[232:235], a[196:199], v[108:111]
    ds_read_b128 a[196:199], v7 offset:24832
    s_waitcnt lgkmcnt(11)
    v_mfma_f32_16x16x32_bf16 v[84:87], a[228:231], a[200:203], v[84:87]
    v_mfma_f32_16x16x32_bf16 v[112:115], a[232:235], a[200:203], v[112:115]
    ds_read_b128 a[200:203], v7 offset:25856
    s_waitcnt lgkmcnt(11)
    v_mfma_f32_16x16x32_bf16 v[88:91], a[204:207], a[228:231], v[88:91]
    v_mfma_f32_16x16x32_bf16 v[116:119], a[204:207], a[232:235], v[116:119]
    ds_read_b128 a[204:207], v39 offset:20736
    s_waitcnt lgkmcnt(10)
    v_mfma_f32_16x16x32_bf16 v[64:67], a[180:183], a[236:239], v[64:67]
    s_waitcnt lgkmcnt(3)
    v_mfma_f32_16x16x32_bf16 v[92:95], a[180:183], a[240:243], v[92:95]
    ds_read_b128 a[180:183], v7 offset:27648
    v_mfma_f32_16x16x32_bf16 v[68:71], a[184:187], a[236:239], v[68:71]
    s_barrier
    s_cmp_lg_u32 s3, 3
    v_mfma_f32_16x16x32_bf16 v[96:99], a[184:187], a[240:243], v[96:99]
    ds_read_b128 a[184:187], v7 offset:28672
    v_mfma_f32_16x16x32_bf16 v[72:75], a[188:191], a[236:239], v[72:75]
    s_cbranch_scc1 L_nofc_n
    s_add_u32 s9, s84, 0x15b0000
    v_mul_u32_u24 v56, 4352, v1
    s_mov_b64 exec, 0xff
    buffer_store_dwordx2 v[30:31], v56, s[40:43], s9 offen sc1
    s_mov_b64 exec, -1
L_nofc_n:
    v_mfma_f32_16x16x32_bf16 v[100:103], a[188:191], a[240:243], v[100:103]
    ds_read_b128 a[188:191], v7 offset:29696
    v_mfma_f32_16x16x32_bf16 v[76:79], a[192:195], a[236:239], v[76:79]
    ds_read_b128 v[120:123], v12 offset:0
    v_mfma_f32_16x16x32_bf16 v[104:107], a[192:195], a[240:243], v[104:107]
    ds_read_b128 a[192:195], v7 offset:30720
    s_waitcnt lgkmcnt(7)
    v_mfma_f32_16x16x32_bf16 v[80:83], a[236:239], a[196:199], v[80:83]
    ds_read_b128 v[124:127], v12 offset:1024
    v_mfma_f32_16x16x32_bf16 v[108:111], a[240:243], a[196:199], v[108:111]
    ds_read_b128 a[196:199], v7 offset:31744
    s_waitcnt lgkmcnt(8)
    v_mfma_f32_16x16x32_bf16 v[84:87], a[236:239], a[200:203], v[84:87]
    ds_read_b128 v[128:131], v12 offset:2048
    v_mfma_f32_16x16x32_bf16 v[112:115], a[240:243], a[200:203], v[112:115]
    ds_read_b128 a[200:203], v7 offset:32768
    s_waitcnt lgkmcnt(9)
    v_mfma_f32_16x16x32_bf16 v[88:91], a[204:207], a[236:239], v[88:91]
    ds_read_b128 v[132:135], v12 offset:3072
    v_mfma_f32_16x16x32_bf16 v[116:119], a[204:207], a[240:243], v[116:119]
    ds_read_b128 a[204:207], v39 offset:27648
    ds_read_b128 v[220:223], v14 offset:0
    ds_read_b128 v[224:227], v14 offset:1024
    ds_read_b128 v[228:231], v14 offset:2048
    ds_read_b128 v[232:235], v14 offset:3072
    s_waitcnt vmcnt(17)
    s_waitcnt lgkmcnt(14)
    v_mfma_f32_16x16x32_bf16 v[64:67], a[180:183], a[244:247], v[64:67]
    s_waitcnt lgkmcnt(0)
    v_pk_add_f32 v[120:121], v[120:121], v[124:125]
    v_mfma_f32_16x16x32_bf16 v[92:95], a[180:183], a[248:251], v[92:95]
    v_pk_add_f32 v[128:129], v[128:129], v[132:133]
    v_mfma_f32_16x16x32_bf16 v[68:71], a[184:187], a[244:247], v[68:71]
    v_pk_add_f32 v[122:123], v[122:123], v[126:127]
    v_pk_add_f32 v[130:131], v[130:131], v[134:135]
    v_mfma_f32_16x16x32_bf16 v[96:99], a[184:187], a[248:251], v[96:99]
    v_pk_add_f32 v[220:221], v[220:221], v[224:225]
    v_mfma_f32_16x16x32_bf16 v[72:75], a[188:191], a[244:247], v[72:75]
    v_pk_add_f32 v[228:229], v[228:229], v[232:233]
    v_mfma_f32_16x16x32_bf16 v[100:103], a[188:191], a[248:251], v[100:103]
    v_pk_add_f32 v[222:223], v[222:223], v[226:227]
    v_pk_add_f32 v[230:231], v[230:231], v[234:235]
    v_mfma_f32_16x16x32_bf16 v[76:79], a[192:195], a[244:247], v[76:79]
    v_pk_add_f32 v[120:121], v[120:121], v[128:129]
    v_pk_add_f32 v[122:123], v[122:123], v[130:131]
    v_mfma_f32_16x16x32_bf16 v[104:107], a[192:195], a[248:251], v[104:107]
    v_pk_add_f32 v[220:221], v[220:221], v[228:229]
    v_pk_add_f32 v[222:223], v[222:223], v[230:231]
    v_mfma_f32_16x16x32_bf16 v[80:83], a[244:247], a[196:199], v[80:83]
    v_cvt_pk_bf16_f32 v124, v120, v121
    v_cvt_pk_bf16_f32 v125, v122, v123
    v_mfma_f32_16x16x32_bf16 v[108:111], a[248:251], a[196:199], v[108:111]
    v_cvt_pk_bf16_f32 v244, v220, v221
    v_cvt_pk_bf16_f32 v245, v222, v223
    v_mfma_f32_16x16x32_bf16 v[84:87], a[244:247], a[200:203], v[84:87]
    ds_write_b64 v35, v[124:125]
    v_mfma_f32_16x16x32_bf16 v[112:115], a[248:251], a[200:203], v[112:115]
    v_mfma_f32_16x16x32_bf16 v[88:91], a[204:207], a[244:247], v[88:91]
    v_mfma_f32_16x16x32_bf16 v[116:119], a[204:207], a[248:251], v[116:119]
    v_lshlrev_b32 v15, 5, v1
    s_add_u32 s85, s83, 0x10000
    s_nop 3
    s_branch L_attn_n
L_layer1_n:
    v_add_u32 v7, s52, v27
    v_add_u32 v39, s52, v8
    ds_read_b128 a[180:183], v7 offset:0
    ds_read_b128 a[184:187], v7 offset:1024
    ds_read_b128 a[188:191], v7 offset:2048
    ds_read_b128 a[192:195], v7 offset:3072
    ds_read_b128 a[196:199], v7 offset:4096
    ds_read_b128 a[200:203], v7 offset:5120
    ds_read_b128 a[204:207], v39 offset:0
    s_mov_b32 s93, 0
    s_nop 1
L_xp_n:
    buffer_load_dwordx4 v[140:143], v248, s[40:43], s48 offen offset:0 sc1
    buffer_load_dwordx4 v[144:147], v248, s[40:43], s61 offen offset:0 sc1
    buffer_load_dwordx4 v[148:151], v248, s[40:43], s48 offen offset:1024 sc1
    buffer_load_dwordx4 v[152:155], v248, s[40:43], s61 offen offset:1024 sc1
    buffer_load_dwordx4 v[156:159], v248, s[40:43], s48 offen offset:2048 sc1
    buffer_load_dwordx4 v[160:163], v248, s[40:43], s61 offen offset:2048 sc1
    buffer_load_dwordx4 v[164:167], v248, s[40:43], s48 offen offset:3072 sc1
    buffer_load_dwordx4 v[168:171], v248, s[40:43], s61 offen offset:3072 sc1
    v_add_u32 v249, s73, v5
    v_add_u32 v250, s74, v5
    v_add_u32 v251, s75, v5
    s_waitcnt vmcnt(0)
    v_max3_u32 v240, v140, v144, v148
    v_max3_u32 v240, v240, v152, v156
    v_max3_u32 v240, v240, v160, v164
    v_max_u32 v240, v240, v168
    v_cmp_eq_u32 vcc, -1, v240
    s_nop 0
    s_cmp_eq_u64 vcc, 0
    s_cbranch_scc1 L_sd20_n
    s_add_u32 s93, s93, 1
    s_cmp_lt_u32 s93, 30000
    s_cbranch_scc1 L_xp_n
L_sd20_n:
    s_nop 0
    s_waitcnt lgkmcnt(6)
    v_mfma_f32_16x16x32_bf16 v[64:67], a[180:183], v[140:143], 0
    buffer_load_dwordx4 v[172:175], v249, s[40:43], s48 offen offset:0 sc1
    v_mfma_f32_16x16x32_bf16 v[92:95], a[180:183], v[144:147], 0
    ds_read_b128 a[180:183], v7 offset:6912
    s_waitcnt lgkmcnt(6)
    v_mfma_f32_16x16x32_bf16 v[68:71], a[184:187], v[140:143], 0
    v_mfma_f32_16x16x32_bf16 v[96:99], a[184:187], v[144:147], 0
    ds_read_b128 a[184:187], v7 offset:7936
    s_waitcnt lgkmcnt(6)
    v_mfma_f32_16x16x32_bf16 v[72:75], a[188:191], v[140:143], 0
    buffer_load_dwordx4 v[176:179], v249, s[40:43], s61 offen offset:0 sc1
    v_mfma_f32_16x16x32_bf16 v[100:103], a[188:191], v[144:147], 0
    ds_read_b128 a[188:191], v7 offset:8960
    s_waitcnt lgkmcnt(6)
    v_mfma_f32_16x16x32_bf16 v[76:79], a[192:195], v[140:143], 0
    v_mfma_f32_16x16x32_bf16 v[104:107], a[192:195], v[144:147], 0
    ds_read_b128 a[192:195], v7 offset:9984
    s_waitcnt lgkmcnt(6)
    v_mfma_f32_16x16x32_bf16 v[80:83], v[140:143], a[196:199], 0
    buffer_load_dwordx4 v[180:183], v249, s[40:43], s48 offen offset:1024 sc1
    v_mfma_f32_16x16x32_bf16 v[108:111], v[144:147], a[196:199], 0
    ds_read_b128 a[196:199], v7 offset:11008
    s_waitcnt lgkmcnt(6)
    v_mfma_f32_16x16x32_bf16 v[84:87], v[140:143], a[200:203], 0
    v_mfma_f32_16x16x32_bf16 v[112:115], v[144:147], a[200:203], 0
    ds_read_b128 a[200:203], v7 offset:12032
    s_waitcnt lgkmcnt(6)
    v_mfma_f32_16x16x32_bf16 v[88:91], a[204:207], v[140:143], 0
    v_mfma_f32_16x16x32_bf16 v[116:119], a[204:207], v[144:147], 0
    ds_read_b128 a[204:207], v39 offset:6912
    s_waitcnt lgkmcnt(6)
    v_mfma_f32_16x16x32_bf16 v[64:67], a[180:183], v[148:151], v[64:67]
    buffer_load_dwordx4 v[184:187], v249, s[40:43], s61 offen offset:1024 sc1
    v_mfma_f32_16x16x32_bf16 v[92:95], a[180:183], v[152:155], v[92:95]
    ds_read_b128 a[180:183], v7 offset:13824
    s_waitcnt lgkmcnt(6)
    v_mfma_f32_16x16x32_bf16 v[68:71], a[184:187], v[148:151], v[68:71]
    v_mfma_f32_16x16x32_bf16 v[96:99], a[184:187], v[152:155], v[96:99]
    ds_read_b128 a[184:187], v7 offset:14848
    s_waitcnt lgkmcnt(6)
    v_mfma_f32_16x16x32_bf16 v[72:75], a[188:191], v[148:151], v[72:75]
    buffer_load_dwordx4 v[188:191], v249, s[40:43], s48 offen offset:2048 sc1
    v_mfma_f32_16x16x32_bf16 v[100:103], a[188:191], v[152:155], v[100:103]
    ds_read_b128 a[188:191], v7 offset:15872
    s_waitcnt lgkmcnt(6)
    v_mfma_f32_16x16x32_bf16 v[76:79], a[192:195], v[148:151], v[76:79]
    v_mfma_f32_16x16x32_bf16 v[104:107], a[192:195], v[152:155], v[104:107]
    ds_read_b128 a[192:195], v7 offset:16896
    s_waitcnt lgkmcnt(6)
    v_mfma_f32_16x16x32_bf16 v[80:83], v[148:151], a[196:199], v[80:83]
    buffer_load_dwordx4 v[192:195], v249, s[40:43], s61 offen offset:2048 sc1
    v_mfma_f32_16x16x32_bf16 v[108:111], v[152:155], a[196:199], v[108:111]
    ds_read_b128 a[196:199], v7 offset:17920
    s_waitcnt lgkmcnt(6)
    v_mfma_f32_16x16x32_bf16 v[84:87], v[148:151], a[200:203], v[84:87]
    v_mfma_f32_16x16x32_bf16 v[112:115], v[152:155], a[200:203], v[112:115]
    ds_read_b128 a[200:203], v7 offset:18944
    s_waitcnt lgkmcnt(6)
    v_mfma_f32_16x16x32_bf16 v[88:91], a[204:207], v[148:151], v[88:91]
    v_mfma_f32_16x16x32_bf16 v[116:119], a[204:207], v[152:155], v[116:119]
    ds_read_b128 a[204:207], v39 offset:13824
    s_waitcnt lgkmcnt(6)
    v_mfma_f32_16x16x32_bf16 v[64:67], a[180:183], v[156:159], v[64:67]
    buffer_load_dwordx4 v[196:199], v249, s[40:43], s48 offen offset:3072 sc1
    v_mfma_f32_16x16x32_bf16 v[92:95], a[180:183], v[160:163], v[92:95]
    ds_read_b128 a[180:183], v7 offset:20736
    s_waitcnt lgkmcnt(6)
    v_mfma_f32_16x16x32_bf16 v[68:71], a[184:187], v[156:159], v[68:71]
    v_mfma_f32_16x16x32_bf16 v[96:99], a[184:187], v[160:163], v[96:99]
    ds_read_b128 a[184:187], v7 offset:21760
    s_waitcnt lgkmcnt(6)
    v_mfma_f32_16x16x32_bf16 v[72:75], a[188:191], v[156:159], v[72:75]
    buffer_load_dwordx4 v[200:203], v249, s[40:43], s61 offen offset:3072 sc1
    v_mfma_f32_16x16x32_bf16 v[100:103], a[188:191], v[160:163], v[100:103]
    ds_read_b128 a[188:191], v7 offset:22784
    s_waitcnt lgkmcnt(6)
    v_mfma_f32_16x16x32_bf16 v[76:79], a[192:195], v[156:159], v[76:79]
    v_mfma_f32_16x16x32_bf16 v[104:107], a[192:195], v[160:163], v[104:107]
    ds_read_b128 a[192:195], v7 offset:23808
    s_waitcnt lgkmcnt(6)
    v_mfma_f32_16x16x32_bf16 v[80:83], v[156:159], a[196:199], v[80:83]
    buffer_load_dwordx4 v[204:207], v250, s[40:43], s48 offen offset:0 sc1
    v_mfma_f32_16x16x32_bf16 v[108:111], v[160:163], a[196:199], v[108:111]
    ds_read_b128 a[196:199], v7 offset:24832
    s_waitcnt lgkmcnt(6)
    v_mfma_f32_16x16x32_bf16 v[84:87], v[156:159], a[200:203], v[84:87]
    v_mfma_f32_16x16x32_bf16 v[112:115], v[160:163], a[200:203], v[112:115]
    ds_read_b128 a[200:203], v7 offset:25856
    s_waitcnt lgkmcnt(6)
    v_mfma_f32_16x16x32_bf16 v[88:91], a[204:207], v[156:159], v[88:91]
    v_mfma_f32_16x16x32_bf16 v[116:119], a[204:207], v[160:163], v[116:119]
    ds_read_b128 a[204:207], v39 offset:20736
    s_waitcnt lgkmcnt(6)
    v_mfma_f32_16x16x32_bf16 v[64:67], a[180:183], v[164:167], v[64:67]
    buffer_load_dwordx4 v[220:223], v6, s[40:43], s77 offen sc1
    v_mfma_f32_16x16x32_bf16 v[92:95], a[180:183], v[168:171], v[92:95]
    v_add_u32 v7, s53, v27
    v_add_u32 v39, s53, v8
    ds_read_b128 a[180:183], v7 offset:0
    s_waitcnt lgkmcnt(6)
    v_mfma_f32_16x16x32_bf16 v[68:71], a[184:187], v[164:167], v[68:71]
    v_mfma_f32_16x16x32_bf16 v[96:99], a[184:187], v[168:171], v[96:99]
    ds_read_b128 a[184:187], v7 offset:1024
    s_waitcnt lgkmcnt(6)
    v_mfma_f32_16x16x32_bf16 v[72:75], a[188:191], v[164:167], v[72:75]
    buffer_load_dwordx4 v[208:211], v250, s[40:43], s61 offen offset:0 sc1
    v_mfma_f32_16x16x32_bf16 v[100:103], a[188:191], v[168:171], v[100:103]
    ds_read_b128 a[188:191], v7 offset:2048
    s_waitcnt lgkmcnt(6)
    v_mfma_f32_16x16x32_bf16 v[76:79], a[192:195], v[164:167], v[76:79]
    v_mfma_f32_16x16x32_bf16 v[104:107], a[192:195], v[168:171], v[104:107]
    ds_read_b128 a[192:195], v7 offset:3072
    s_waitcnt lgkmcnt(6)
    v_mfma_f32_16x16x32_bf16 v[80:83], v[164:167], a[196:199], v[80:83]
    buffer_load_dwordx4 v[212:215], v250, s[40:43], s48 offen offset:1024 sc1
    s_waitcnt vmcnt(10)
    v_mfma_f32_16x16x32_bf16 v[108:111], v[168:171], a[196:199], v[108:111]
    ds_read_b128 a[196:199], v7 offset:4096
    s_waitcnt lgkmcnt(6)
    v_mfma_f32_16x16x32_bf16 v[84:87], v[164:167], a[200:203], v[84:87]
    v_max_u32 v240, v172, v176
    v_cmp_eq_u32 vcc, -1, v240
    v_mfma_f32_16x16x32_bf16 v[112:115], v[168:171], a[200:203], v[112:115]
    ds_read_b128 a[200:203], v7 offset:5120
    s_waitcnt lgkmcnt(6)
    v_mfma_f32_16x16x32_bf16 v[88:91], a[204:207], v[164:167], v[88:91]
    s_cbranch_vccnz L_xs4_n
L_xr4_n:
    v_mfma_f32_16x16x32_bf16 v[116:119], a[204:207], v[168:171], v[116:119]
    ds_read_b128 a[204:207], v39 offset:0
    s_waitcnt lgkmcnt(6)
    v_mfma_f32_16x16x32_bf16 v[64:67], a[180:183], v[172:175], v[64:67]
    buffer_load_dwordx4 v[224:227], v6, s[40:43], s78 offen sc1
    v_mfma_f32_16x16x32_bf16 v[92:95], a[180:183], v[176:179], v[92:95]
    ds_read_b128 a[180:183], v7 offset:6912
    s_waitcnt lgkmcnt(6)
    v_mfma_f32_16x16x32_bf16 v[68:71], a[184:187], v[172:175], v[68:71]
    v_mfma_f32_16x16x32_bf16 v[96:99], a[184:187], v[176:179], v[96:99]
    ds_read_b128 a[184:187], v7 offset:7936
    s_waitcnt lgkmcnt(6)
    v_mfma_f32_16x16x32_bf16 v[72:75], a[188:191], v[172:175], v[72:75]
    buffer_load_dwordx4 v[216:219], v250, s[40:43], s61 offen offset:1024 sc1
    v_mfma_f32_16x16x32_bf16 v[100:103], a[188:191], v[176:179], v[100:103]
    ds_read_b128 a[188:191], v7 offset:8960
    s_waitcnt lgkmcnt(6)
    v_mfma_f32_16x16x32_bf16 v[76:79], a[192:195], v[172:175], v[76:79]
    v_mfma_f32_16x16x32_bf16 v[104:107], a[192:195], v[176:179], v[104:107]
    ds_read_b128 a[192:195], v7 offset:9984
    s_waitcnt lgkmcnt(6)
    v_mfma_f32_16x16x32_bf16 v[80:83], v[172:175], a[196:199], v[80:83]
    buffer_load_dwordx4 v[140:143], v250, s[40:43], s48 offen offset:2048 sc1
    s_waitcnt vmcnt(11)
    v_mfma_f32_16x16x32_bf16 v[108:111], v[176:179], a[196:199], v[108:111]
    ds_read_b128 a[196:199], v7 offset:11008
    s_waitcnt lgkmcnt(6)
    v_mfma_f32_16x16x32_bf16 v[84:87], v[172:175], a[200:203], v[84:87]
    v_max_u32 v240, v180, v184
    v_cmp_eq_u32 vcc, -1, v240
    v_mfma_f32_16x16x32_bf16 v[112:115], v[176:179], a[200:203], v[112:115]
    ds_read_b128 a[200:203], v7 offset:12032
    s_waitcnt lgkmcnt(6)
    v_mfma_f32_16x16x32_bf16 v[88:91], a[204:207], v[172:175], v[88:91]
    s_cbranch_vccnz L_xs5_n
L_xr5_n:
    v_mfma_f32_16x16x32_bf16 v[116:119], a[204:207], v[176:179], v[116:119]
    ds_read_b128 a[204:207], v39 offset:6912
    s_waitcnt lgkmcnt(6)
    v_mfma_f32_16x16x32_bf16 v[64:67], a[180:183], v[180:183], v[64:67]
    buffer_load_dwordx4 v[228:231], v6, s[40:43], s79 offen sc1
    v_mfma_f32_16x16x32_bf16 v[92:95], a[180:183], v[184:187], v[92:95]
    ds_read_b128 a[180:183], v7 offset:13824
    s_waitcnt lgkmcnt(6)
    v_mfma_f32_16x16x32_bf16 v[68:71], a[184:187], v[180:183], v[68:71]
    v_mfma_f32_16x16x32_bf16 v[96:99], a[184:187], v[184:187], v[96:99]
    ds_read_b128 a[184:187], v7 offset:14848
    s_waitcnt lgkmcnt(6)
    v_mfma_f32_16x16x32_bf16 v[72:75], a[188:191], v[180:183], v[72:75]
    buffer_load_dwordx4 v[144:147], v250, s[40:43], s61 offen offset:2048 sc1
    v_mfma_f32_16x16x32_bf16 v[100:103], a[188:191], v[184:187], v[100:103]
    ds_read_b128 a[188:191], v7 offset:15872
    s_waitcnt lgkmcnt(6)
    v_mfma_f32_16x16x32_bf16 v[76:79], a[192:195], v[180:183], v[76:79]
    v_mfma_f32_16x16x32_bf16 v[104:107], a[192:195], v[184:187], v[104:107]
    ds_read_b128 a[192:195], v7 offset:16896
    s_waitcnt lgkmcnt(6)
    v_mfma_f32_16x16x32_bf16 v[80:83], v[180:183], a[196:199], v[80:83]
    buffer_load_dwordx4 v[148:151], v250, s[40:43], s48 offen offset:3072 sc1
    s_waitcnt vmcnt(12)
    v_mfma_f32_16x16x32_bf16 v[108:111], v[184:187], a[196:199], v[108:111]
    ds_read_b128 a[196:199], v7 offset:17920
    s_waitcnt lgkmcnt(6)
    v_mfma_f32_16x16x32_bf16 v[84:87], v[180:183], a[200:203], v[84:87]
    v_max_u32 v240, v188, v192
    v_cmp_eq_u32 vcc, -1, v240
    v_mfma_f32_16x16x32_bf16 v[112:115], v[184:187], a[200:203], v[112:115]
    ds_read_b128 a[200:203], v7 offset:18944
    s_waitcnt lgkmcnt(6)
    v_mfma_f32_16x16x32_bf16 v[88:91], a[204:207], v[180:183], v[88:91]
    s_cbranch_vccnz L_xs6_n
L_xr6_n:
    v_mfma_f32_16x16x32_bf16 v[116:119], a[204:207], v[184:187], v[116:119]
    ds_read_b128 a[204:207], v39 offset:13824
    s_waitcnt lgkmcnt(6)
    v_mfma_f32_16x16x32_bf16 v[64:67], a[180:183], v[188:191], v[64:67]
    buffer_load_dwordx4 v[232:235], v6, s[40:43], s80 offen sc1
    v_mfma_f32_16x16x32_bf16 v[92:95], a[180:183], v[192:195], v[92:95]
    ds_read_b128 a[180:183], v7 offset:20736
    s_waitcnt lgkmcnt(6)
    v_mfma_f32_16x16x32_bf16 v[68:71], a[184:187], v[188:191], v[68:71]
    v_mfma_f32_16x16x32_bf16 v[96:99], a[184:187], v[192:195], v[96:99]
    ds_read_b128 a[184:187], v7 offset:21760
    s_waitcnt lgkmcnt(6)
    v_mfma_f32_16x16x32_bf16 v[72:75], a[188:191], v[188:191], v[72:75]
    buffer_load_dwordx4 v[152:155], v250, s[40:43], s61 offen offset:3072 sc1
    v_mfma_f32_16x16x32_bf16 v[100:103], a[188:191], v[192:195], v[100:103]
    ds_read_b128 a[188:191], v7 offset:22784
    s_waitcnt lgkmcnt(6)
    v_mfma_f32_16x16x32_bf16 v[76:79], a[192:195], v[188:191], v[76:79]
    v_mfma_f32_16x16x32_bf16 v[104:107], a[192:195], v[192:195], v[104:107]
    ds_read_b128 a[192:195], v7 offset:23808
    s_waitcnt lgkmcnt(6)
    v_mfma_f32_16x16x32_bf16 v[80:83], v[188:191], a[196:199], v[80:83]
    buffer_load_dwordx4 v[156:159], v250, s[40:43], s60 offen offset:0 sc1
    s_waitcnt vmcnt(13)
    v_mfma_f32_16x16x32_bf16 v[108:111], v[192:195], a[196:199], v[108:111]
    ds_read_b128 a[196:199], v7 offset:24832
    s_waitcnt lgkmcnt(6)
    v_mfma_f32_16x16x32_bf16 v[84:87], v[188:191], a[200:203], v[84:87]
    v_max_u32 v240, v196, v200
    v_cmp_eq_u32 vcc, -1, v240
    v_mfma_f32_16x16x32_bf16 v[112:115], v[192:195], a[200:203], v[112:115]
    ds_read_b128 a[200:203], v7 offset:25856
    s_waitcnt lgkmcnt(6)
    v_mfma_f32_16x16x32_bf16 v[88:91], a[204:207], v[188:191], v[88:91]
    s_cbranch_vccnz L_xs7_n
L_xr7_n:
    v_mfma_f32_16x16x32_bf16 v[116:119], a[204:207], v[192:195], v[116:119]
    ds_read_b128 a[204:207], v39 offset:20736
    s_waitcnt lgkmcnt(6)
    v_mfma_f32_16x16x32_bf16 v[64:67], a[180:183], v[196:199], v[64:67]
    buffer_load_dwordx4 v[236:239], v10, s[40:43], s81 offen sc1
    v_mfma_f32_16x16x32_bf16 v[92:95], a[180:183], v[200:203], v[92:95]
    v_add_u32 v7, s54, v27
    v_add_u32 v39, s54, v8
    ds_read_b128 a[180:183], v7 offset:0
    s_waitcnt lgkmcnt(6)
    v_mfma_f32_16x16x32_bf16 v[68:71], a[184:187], v[196:199], v[68:71]
    v_mfma_f32_16x16x32_bf16 v[96:99], a[184:187], v[200:203], v[96:99]
    ds_read_b128 a[184:187], v7 offset:1024
    s_waitcnt lgkmcnt(6)
    v_mfma_f32_16x16x32_bf16 v[72:75], a[188:191], v[196:199], v[72:75]
    buffer_load_dwordx4 v[160:163], v250, s[40:43], s62 offen offset:0 sc1
    v_mfma_f32_16x16x32_bf16 v[100:103], a[188:191], v[200:203], v[100:103]
    ds_read_b128 a[188:191], v7 offset:2048
    s_waitcnt lgkmcnt(6)
    v_mfma_f32_16x16x32_bf16 v[76:79], a[192:195], v[196:199], v[76:79]
    v_mfma_f32_16x16x32_bf16 v[104:107], a[192:195], v[200:203], v[104:107]
    ds_read_b128 a[192:195], v7 offset:3072
    s_waitcnt lgkmcnt(6)
    v_mfma_f32_16x16x32_bf16 v[80:83], v[196:199], a[196:199], v[80:83]
    buffer_load_dwordx4 v[164:167], v251, s[40:43], s48 offen offset:0 sc1
    s_waitcnt vmcnt(13)
    v_mfma_f32_16x16x32_bf16 v[108:111], v[200:203], a[196:199], v[108:111]
    ds_read_b128 a[196:199], v7 offset:4096
    s_waitcnt lgkmcnt(6)
    v_mfma_f32_16x16x32_bf16 v[84:87], v[196:199], a[200:203], v[84:87]
    v_max_u32 v240, v204, v208
    v_cmp_eq_u32 vcc, -1, v240
    v_mfma_f32_16x16x32_bf16 v[112:115], v[200:203], a[200:203], v[112:115]
    ds_read_b128 a[200:203], v7 offset:5120
    s_waitcnt lgkmcnt(6)
    v_mfma_f32_16x16x32_bf16 v[88:91], a[204:207], v[196:199], v[88:91]
    s_cbranch_vccnz L_xs8_n
L_xr8_n:
    v_mfma_f32_16x16x32_bf16 v[116:119], a[204:207], v[200:203], v[116:119]
    ds_read_b128 a[204:207], v39 offset:0
    s_waitcnt lgkmcnt(6)
    v_mfma_f32_16x16x32_bf16 v[64:67], a[180:183], v[204:207], v[64:67]
    buffer_load_dwordx4 v[168:171], v251, s[40:43], s61 offen offset:0 sc1
    v_mfma_f32_16x16x32_bf16 v[92:95], a[180:183], v[208:211], v[92:95]
    ds_read_b128 a[180:183], v7 offset:6912
    s_waitcnt lgkmcnt(6)
    v_mfma_f32_16x16x32_bf16 v[68:71], a[184:187], v[204:207], v[68:71]
    v_mfma_f32_16x16x32_bf16 v[96:99], a[184:187], v[208:211], v[96:99]
    ds_read_b128 a[184:187], v7 offset:7936
    s_waitcnt lgkmcnt(6)
    v_mfma_f32_16x16x32_bf16 v[72:75], a[188:191], v[204:207], v[72:75]
    buffer_load_dwordx4 v[172:175], v251, s[40:43], s48 offen offset:1024 sc1
    v_mfma_f32_16x16x32_bf16 v[100:103], a[188:191], v[208:211], v[100:103]
    ds_read_b128 a[188:191], v7 offset:8960
    s_waitcnt lgkmcnt(6)
    v_mfma_f32_16x16x32_bf16 v[76:79], a[192:195], v[204:207], v[76:79]
    v_mfma_f32_16x16x32_bf16 v[104:107], a[192:195], v[208:211], v[104:107]
    ds_read_b128 a[192:195], v7 offset:9984
    s_waitcnt lgkmcnt(6)
    v_mfma_f32_16x16x32_bf16 v[80:83], v[204:207], a[196:199], v[80:83]
    buffer_load_dwordx4 v[176:179], v251, s[40:43], s61 offen offset:1024 sc1
    s_waitcnt vmcnt(13)
    v_mfma_f32_16x16x32_bf16 v[108:111], v[208:211], a[196:199], v[108:111]
    ds_read_b128 a[196:199], v7 offset:11008
    s_waitcnt lgkmcnt(6)
    v_mfma_f32_16x16x32_bf16 v[84:87], v[204:207], a[200:203], v[84:87]
    v_max_u32 v240, v212, v216
    v_cmp_eq_u32 vcc, -1, v240
    v_mfma_f32_16x16x32_bf16 v[112:115], v[208:211], a[200:203], v[112:115]
    ds_read_b128 a[200:203], v7 offset:12032
    s_waitcnt lgkmcnt(6)
    v_mfma_f32_16x16x32_bf16 v[88:91], a[204:207], v[204:207], v[88:91]
    s_cbranch_vccnz L_xs9_n
L_xr9_n:
    v_mfma_f32_16x16x32_bf16 v[116:119], a[204:207], v[208:211], v[116:119]
    ds_read_b128 a[204:207], v39 offset:6912
    s_waitcnt lgkmcnt(6)
    v_mfma_f32_16x16x32_bf16 v[64:67], a[180:183], v[212:215], v[64:67]
    buffer_load_dwordx4 v[180:183], v251, s[40:43], s48 offen offset:2048 sc1
    v_mfma_f32_16x16x32_bf16 v[92:95], a[180:183], v[216:219], v[92:95]
    ds_read_b128 a[180:183], v7 offset:13824
    s_waitcnt lgkmcnt(6)
    v_mfma_f32_16x16x32_bf16 v[68:71], a[184:187], v[212:215], v[68:71]
    v_mfma_f32_16x16x32_bf16 v[96:99], a[184:187], v[216:219], v[96:99]
    ds_read_b128 a[184:187], v7 offset:14848
    s_waitcnt lgkmcnt(6)
    v_mfma_f32_16x16x32_bf16 v[72:75], a[188:191], v[212:215], v[72:75]
    buffer_load_dwordx4 v[184:187], v251, s[40:43], s61 offen offset:2048 sc1
    v_mfma_f32_16x16x32_bf16 v[100:103], a[188:191], v[216:219], v[100:103]
    ds_read_b128 a[188:191], v7 offset:15872
    s_waitcnt lgkmcnt(6)
    v_mfma_f32_16x16x32_bf16 v[76:79], a[192:195], v[212:215], v[76:79]
    v_mfma_f32_16x16x32_bf16 v[104:107], a[192:195], v[216:219], v[104:107]
    ds_read_b128 a[192:195], v7 offset:16896
    s_waitcnt lgkmcnt(6)
    v_mfma_f32_16x16x32_bf16 v[80:83], v[212:215], a[196:199], v[80:83]
    buffer_load_dwordx4 v[188:191], v251, s[40:43], s48 offen offset:3072 sc1
    s_waitcnt vmcnt(13)
    v_mfma_f32_16x16x32_bf16 v[108:111], v[216:219], a[196:199], v[108:111]
    ds_read_b128 a[196:199], v7 offset:17920
    s_waitcnt lgkmcnt(6)
    v_mfma_f32_16x16x32_bf16 v[84:87], v[212:215], a[200:203], v[84:87]
    v_max3_u32 v240, v140, v144, v220
    v_cmp_eq_u32 vcc, -1, v240
    v_mfma_f32_16x16x32_bf16 v[112:115], v[216:219], a[200:203], v[112:115]
    ds_read_b128 a[200:203], v7 offset:18944
    s_waitcnt lgkmcnt(6)
    v_mfma_f32_16x16x32_bf16 v[88:91], a[204:207], v[212:215], v[88:91]
    s_cbranch_vccnz L_xs10_n
L_xr10_n:
    v_mfma_f32_16x16x32_bf16 v[116:119], a[204:207], v[216:219], v[116:119]
    ds_read_b128 a[204:207], v39 offset:13824
    s_waitcnt lgkmcnt(6)
    v_mfma_f32_16x16x32_bf16 v[64:67], a[180:183], v[140:143], v[64:67]
    buffer_load_dwordx4 v[192:195], v251, s[40:43], s61 offen offset:3072 sc1
    v_mfma_f32_16x16x32_bf16 v[92:95], a[180:183], v[144:147], v[92:95]
    ds_read_b128 a[180:183], v7 offset:20736
    s_waitcnt lgkmcnt(6)
    v_mfma_f32_16x16x32_bf16 v[68:71], a[184:187], v[140:143], v[68:71]
    v_mfma_f32_16x16x32_bf16 v[96:99], a[184:187], v[144:147], v[96:99]
    ds_read_b128 a[184:187], v7 offset:21760
    s_waitcnt lgkmcnt(6)
    v_mfma_f32_16x16x32_bf16 v[72:75], a[188:191], v[140:143], v[72:75]
    buffer_load_dwordx4 v[196:199], v251, s[40:43], s60 offen offset:0 sc1
    v_mfma_f32_16x16x32_bf16 v[100:103], a[188:191], v[144:147], v[100:103]
    v_mfma_f32_16x16x32_bf16 v[120:123], a[188:191], v[220:223], 0
    ds_read_b128 a[188:191], v7 offset:22784
    s_waitcnt lgkmcnt(6)
    v_mfma_f32_16x16x32_bf16 v[76:79], a[192:195], v[140:143], v[76:79]
    v_mfma_f32_16x16x32_bf16 v[104:107], a[192:195], v[144:147], v[104:107]
    buffer_load_dwordx4 v[200:203], v251, s[40:43], s62 offen offset:0 sc1
    v_mfma_f32_16x16x32_bf16 v[124:127], a[192:195], v[220:223], 0
    ds_read_b128 a[192:195], v7 offset:23808
    s_waitcnt lgkmcnt(6)
    v_mfma_f32_16x16x32_bf16 v[80:83], v[140:143], a[196:199], v[80:83]
    s_waitcnt vmcnt(13)
    v_max3_u32 v240, v148, v152, v224
    v_mfma_f32_16x16x32_bf16 v[108:111], v[144:147], a[196:199], v[108:111]
    v_cmp_eq_u32 vcc, -1, v240
    v_mfma_f32_16x16x32_bf16 v[128:131], v[220:223], a[196:199], 0
    ds_read_b128 a[196:199], v7 offset:24832
    s_waitcnt lgkmcnt(6)
    v_mfma_f32_16x16x32_bf16 v[84:87], v[140:143], a[200:203], v[84:87]
    s_cbranch_vccnz L_xs11_n
L_xr11_n:
    v_mfma_f32_16x16x32_bf16 v[112:115], v[144:147], a[200:203], v[112:115]
    v_mfma_f32_16x16x32_bf16 v[132:135], v[220:223], a[200:203], 0
    ds_read_b128 a[200:203], v7 offset:25856
    s_waitcnt lgkmcnt(6)
    v_mfma_f32_16x16x32_bf16 v[88:91], a[204:207], v[140:143], v[88:91]
    v_mfma_f32_16x16x32_bf16 v[116:119], a[204:207], v[144:147], v[116:119]
    v_mfma_f32_16x16x32_bf16 v[136:139], a[204:207], v[220:223], 0
    ds_read_b128 a[204:207], v39 offset:20736
    s_waitcnt lgkmcnt(6)
    v_mfma_f32_16x16x32_bf16 v[64:67], a[180:183], v[148:151], v[64:67]
    v_mfma_f32_16x16x32_bf16 v[92:95], a[180:183], v[152:155], v[92:95]
    ds_read_b128 a[180:183], v7 offset:27648
    s_waitcnt lgkmcnt(6)
    v_mfma_f32_16x16x32_bf16 v[68:71], a[184:187], v[148:151], v[68:71]
    v_mfma_f32_16x16x32_bf16 v[96:99], a[184:187], v[152:155], v[96:99]
    ds_read_b128 a[184:187], v7 offset:28672
    s_waitcnt lgkmcnt(6)
    v_mfma_f32_16x16x32_bf16 v[72:75], a[188:191], v[148:151], v[72:75]
    v_mfma_f32_16x16x32_bf16 v[100:103], a[188:191], v[152:155], v[100:103]
    v_mfma_f32_16x16x32_bf16 v[120:123], a[188:191], v[224:227], v[120:123]
    ds_read_b128 a[188:191], v7 offset:29696
    s_waitcnt lgkmcnt(6)
    v_mfma_f32_16x16x32_bf16 v[76:79], a[192:195], v[148:151], v[76:79]
    v_mfma_f32_16x16x32_bf16 v[104:107], a[192:195], v[152:155], v[104:107]
    v_mfma_f32_16x16x32_bf16 v[124:127], a[192:195], v[224:227], v[124:127]
    ds_read_b128 a[192:195], v7 offset:30720
    s_waitcnt lgkmcnt(6)
    v_mfma_f32_16x16x32_bf16 v[80:83], v[148:151], a[196:199], v[80:83]
    s_waitcnt vmcnt(10)
    v_max3_u32 v240, v156, v160, v228
    v_mfma_f32_16x16x32_bf16 v[108:111], v[152:155], a[196:199], v[108:111]
    v_cmp_eq_u32 vcc, -1, v240
    v_mfma_f32_16x16x32_bf16 v[128:131], v[224:227], a[196:199], v[128:131]
    ds_read_b128 a[196:199], v7 offset:31744
    s_waitcnt lgkmcnt(6)
    v_mfma_f32_16x16x32_bf16 v[84:87], v[148:151], a[200:203], v[84:87]
    s_cbranch_vccnz L_xs12_n
L_xr12_n:
    v_mfma_f32_16x16x32_bf16 v[112:115], v[152:155], a[200:203], v[112:115]
    v_mfma_f32_16x16x32_bf16 v[132:135], v[224:227], a[200:203], v[132:135]
    ds_read_b128 a[200:203], v7 offset:32768
    s_waitcnt lgkmcnt(6)
    v_mfma_f32_16x16x32_bf16 v[88:91], a[204:207], v[148:151], v[88:91]
    v_mfma_f32_16x16x32_bf16 v[116:119], a[204:207], v[152:155], v[116:119]
    v_mfma_f32_16x16x32_bf16 v[136:139], a[204:207], v[224:227], v[136:139]
    ds_read_b128 a[204:207], v39 offset:27648
    s_waitcnt lgkmcnt(6)
    v_mfma_f32_16x16x32_bf16 v[64:67], a[180:183], v[156:159], v[64:67]
    v_mfma_f32_16x16x32_bf16 v[92:95], a[180:183], v[160:163], v[92:95]
    v_add_u32 v7, s55, v27
    v_add_u32 v39, s55, v8
    ds_read_b128 a[180:183], v7 offset:0
    s_waitcnt lgkmcnt(6)
    v_mfma_f32_16x16x32_bf16 v[68:71], a[184:187], v[156:159], v[68:71]
    v_mfma_f32_16x16x32_bf16 v[96:99], a[184:187], v[160:163], v[96:99]
    ds_read_b128 a[184:187], v7 offset:1024
    s_waitcnt lgkmcnt(6)
    v_mfma_f32_16x16x32_bf16 v[72:75], a[188:191], v[156:159], v[72:75]
    v_mfma_f32_16x16x32_bf16 v[100:103], a[188:191], v[160:163], v[100:103]
    v_mfma_f32_16x16x32_bf16 v[120:123], a[188:191], v[228:231], v[120:123]
    ds_read_b128 a[188:191], v7 offset:2048
    s_waitcnt lgkmcnt(6)
    v_mfma_f32_16x16x32_bf16 v[76:79], a[192:195], v[156:159], v[76:79]
    v_mfma_f32_16x16x32_bf16 v[104:107], a[192:195], v[160:163], v[104:107]
    v_mfma_f32_16x16x32_bf16 v[124:127], a[192:195], v[228:231], v[124:127]
    ds_read_b128 a[192:195], v7 offset:3072
    s_waitcnt lgkmcnt(6)
    v_mfma_f32_16x16x32_bf16 v[80:83], v[156:159], a[196:199], v[80:83]
    s_waitcnt vmcnt(8)
    v_max3_u32 v240, v164, v168, v232
    v_mfma_f32_16x16x32_bf16 v[108:111], v[160:163], a[196:199], v[108:111]
    v_cmp_eq_u32 vcc, -1, v240
    v_mfma_f32_16x16x32_bf16 v[128:131], v[228:231], a[196:199], v[128:131]
    ds_read_b128 a[196:199], v7 offset:4096
    s_waitcnt lgkmcnt(6)
    v_mfma_f32_16x16x32_bf16 v[84:87], v[156:159], a[200:203], v[84:87]
    s_cbranch_vccnz L_xs13_n
L_xr13_n:
    v_mfma_f32_16x16x32_bf16 v[112:115], v[160:163], a[200:203], v[112:115]
    v_mfma_f32_16x16x32_bf16 v[132:135], v[228:231], a[200:203], v[132:135]
    ds_read_b128 a[200:203], v7 offset:5120
    s_waitcnt lgkmcnt(6)
    v_mfma_f32_16x16x32_bf16 v[88:91], a[204:207], v[156:159], v[88:91]
    v_mfma_f32_16x16x32_bf16 v[116:119], a[204:207], v[160:163], v[116:119]
    v_mfma_f32_16x16x32_bf16 v[136:139], a[204:207], v[228:231], v[136:139]
    ds_read_b128 a[204:207], v39 offset:0
    s_waitcnt lgkmcnt(6)
    v_mfma_f32_16x16x32_bf16 v[64:67], a[180:183], v[164:167], v[64:67]
    v_mfma_f32_16x16x32_bf16 v[92:95], a[180:183], v[168:171], v[92:95]
    ds_read_b128 a[180:183], v7 offset:6912
    s_waitcnt lgkmcnt(6)
    v_mfma_f32_16x16x32_bf16 v[68:71], a[184:187], v[164:167], v[68:71]
    v_mfma_f32_16x16x32_bf16 v[96:99], a[184:187], v[168:171], v[96:99]
    ds_read_b128 a[184:187], v7 offset:7936
    s_waitcnt lgkmcnt(6)
    v_mfma_f32_16x16x32_bf16 v[72:75], a[188:191], v[164:167], v[72:75]
    v_mfma_f32_16x16x32_bf16 v[100:103], a[188:191], v[168:171], v[100:103]
    v_mfma_f32_16x16x32_bf16 v[120:123], a[188:191], v[232:235], v[120:123]
    ds_read_b128 a[188:191], v7 offset:8960
    s_waitcnt lgkmcnt(6)
    v_mfma_f32_16x16x32_bf16 v[76:79], a[192:195], v[164:167], v[76:79]
    v_mfma_f32_16x16x32_bf16 v[104:107], a[192:195], v[168:171], v[104:107]
    v_mfma_f32_16x16x32_bf16 v[124:127], a[192:195], v[232:235], v[124:127]
    ds_read_b128 a[192:195], v7 offset:9984
    s_waitcnt lgkmcnt(6)
    v_mfma_f32_16x16x32_bf16 v[80:83], v[164:167], a[196:199], v[80:83]
    s_waitcnt vmcnt(6)
    v_max3_u32 v240, v172, v176, v236
    v_mfma_f32_16x16x32_bf16 v[108:111], v[168:171], a[196:199], v[108:111]
    v_cmp_eq_u32 vcc, -1, v240
    v_mfma_f32_16x16x32_bf16 v[128:131], v[232:235], a[196:199], v[128:131]
    ds_read_b128 a[196:199], v7 offset:11008
    s_waitcnt lgkmcnt(6)
    v_mfma_f32_16x16x32_bf16 v[84:87], v[164:167], a[200:203], v[84:87]
    s_cbranch_vccnz L_xs14_n
L_xr14_n:
    v_mfma_f32_16x16x32_bf16 v[112:115], v[168:171], a[200:203], v[112:115]
    v_mfma_f32_16x16x32_bf16 v[132:135], v[232:235], a[200:203], v[132:135]
    ds_read_b128 a[200:203], v7 offset:12032
    s_waitcnt lgkmcnt(6)
    v_mfma_f32_16x16x32_bf16 v[88:91], a[204:207], v[164:167], v[88:91]
    v_mfma_f32_16x16x32_bf16 v[116:119], a[204:207], v[168:171], v[116:119]
    v_mfma_f32_16x16x32_bf16 v[136:139], a[204:207], v[232:235], v[136:139]
    ds_read_b128 a[204:207], v39 offset:6912
    s_waitcnt lgkmcnt(6)
    v_mfma_f32_16x16x32_bf16 v[64:67], a[180:183], v[172:175], v[64:67]
    v_mfma_f32_16x16x32_bf16 v[92:95], a[180:183], v[176:179], v[92:95]
    ds_read_b128 a[180:183], v7 offset:13824
    s_waitcnt lgkmcnt(6)
    v_mfma_f32_16x16x32_bf16 v[68:71], a[184:187], v[172:175], v[68:71]
    v_mfma_f32_16x16x32_bf16 v[96:99], a[184:187], v[176:179], v[96:99]
    ds_read_b128 a[184:187], v7 offset:14848
    s_waitcnt lgkmcnt(6)
    v_mfma_f32_16x16x32_bf16 v[72:75], a[188:191], v[172:175], v[72:75]
    v_mfma_f32_16x16x32_bf16 v[100:103], a[188:191], v[176:179], v[100:103]
    v_mfma_f32_16x16x32_bf16 v[120:123], a[188:191], v[236:239], v[120:123]
    ds_read_b128 a[188:191], v7 offset:15872
    s_waitcnt lgkmcnt(6)
    v_mfma_f32_16x16x32_bf16 v[76:79], a[192:195], v[172:175], v[76:79]
    v_mfma_f32_16x16x32_bf16 v[104:107], a[192:195], v[176:179], v[104:107]
    v_mfma_f32_16x16x32_bf16 v[124:127], a[192:195], v[236:239], v[124:127]
    ds_read_b128 a[192:195], v7 offset:16896
    s_waitcnt lgkmcnt(6)
    v_mfma_f32_16x16x32_bf16 v[80:83], v[172:175], a[196:199], v[80:83]
    s_waitcnt vmcnt(4)
    v_max_u32 v240, v180, v184
    v_mfma_f32_16x16x32_bf16 v[108:111], v[176:179], a[196:199], v[108:111]
    v_cmp_eq_u32 vcc, -1, v240
    v_mfma_f32_16x16x32_bf16 v[128:131], v[236:239], a[196:199], v[128:131]
    ds_read_b128 a[196:199], v7 offset:17920
    s_waitcnt lgkmcnt(6)
    v_mfma_f32_16x16x32_bf16 v[84:87], v[172:175], a[200:203], v[84:87]
    s_cbranch_vccnz L_xs15_n
L_xr15_n:
    v_mfma_f32_16x16x32_bf16 v[112:115], v[176:179], a[200:203], v[112:115]
    v_mfma_f32_16x16x32_bf16 v[132:135], v[236:239], a[200:203], v[132:135]
    ds_read_b128 a[200:203], v7 offset:18944
    s_waitcnt lgkmcnt(6)
    v_mfma_f32_16x16x32_bf16 v[88:91], a[204:207], v[172:175], v[88:91]
    v_mfma_f32_16x16x32_bf16 v[116:119], a[204:207], v[176:179], v[116:119]
    v_mfma_f32_16x16x32_bf16 v[136:139], a[204:207], v[236:239], v[136:139]
    ds_read_b128 a[204:207], v39 offset:13824
    s_waitcnt lgkmcnt(6)
    v_mfma_f32_16x16x32_bf16 v[64:67], a[180:183], v[180:183], v[64:67]
    ds_write_b128 v36, v[120:123] offset:0
    v_mfma_f32_16x16x32_bf16 v[92:95], a[180:183], v[184:187], v[92:95]
    ds_read_b128 a[180:183], v7 offset:20736
    s_waitcnt lgkmcnt(7)
    v_mfma_f32_16x16x32_bf16 v[68:71], a[184:187], v[180:183], v[68:71]
    ds_write_b128 v36, v[124:127] offset:4096
    v_mfma_f32_16x16x32_bf16 v[96:99], a[184:187], v[184:187], v[96:99]
    ds_read_b128 a[184:187], v7 offset:21760
    s_waitcnt lgkmcnt(8)
    v_mfma_f32_16x16x32_bf16 v[72:75], a[188:191], v[180:183], v[72:75]
    ds_write_b128 v36, v[128:131] offset:8192
    v_mfma_f32_16x16x32_bf16 v[100:103], a[188:191], v[184:187], v[100:103]
    ds_read_b128 a[188:191], v7 offset:22784
    s_waitcnt lgkmcnt(9)
    v_mfma_f32_16x16x32_bf16 v[76:79], a[192:195], v[180:183], v[76:79]
    ds_write_b128 v36, v[132:135] offset:12288
    v_mfma_f32_16x16x32_bf16 v[104:107], a[192:195], v[184:187], v[104:107]
    ds_read_b128 a[192:195], v7 offset:23808
    s_waitcnt lgkmcnt(10)
    v_mfma_f32_16x16x32_bf16 v[80:83], v[180:183], a[196:199], v[80:83]
    ds_write_b128 v36, v[136:139] offset:16384
    s_waitcnt vmcnt(2)
    v_mfma_f32_16x16x32_bf16 v[108:111], v[184:187], a[196:199], v[108:111]
    ds_read_b128 a[196:199], v7 offset:24832
    s_waitcnt lgkmcnt(11)
    v_mfma_f32_16x16x32_bf16 v[84:87], v[180:183], a[200:203], v[84:87]
    v_max_u32 v240, v188, v192
    v_cmp_eq_u32 vcc, -1, v240
    v_mfma_f32_16x16x32_bf16 v[112:115], v[184:187], a[200:203], v[112:115]
    ds_read_b128 a[200:203], v7 offset:25856
    s_waitcnt lgkmcnt(11)
    v_mfma_f32_16x16x32_bf16 v[88:91], a[204:207], v[180:183], v[88:91]
    s_cbranch_vccnz L_xs16_n
L_xr16_n:
    v_mfma_f32_16x16x32_bf16 v[116:119], a[204:207], v[184:187], v[116:119]
    ds_read_b128 a[204:207], v39 offset:20736
    s_waitcnt lgkmcnt(10)
    v_mfma_f32_16x16x32_bf16 v[64:67], a[180:183], v[188:191], v[64:67]
    s_waitcnt lgkmcnt(3)
    s_barrier
    v_mfma_f32_16x16x32_bf16 v[92:95], a[180:183], v[192:195], v[92:95]
    ds_read_b128 a[180:183], v7 offset:27648
    v_mfma_f32_16x16x32_bf16 v[68:71], a[184:187], v[188:191], v[68:71]
    ds_read_b128 v[120:123], v12 offset:0
    v_mfma_f32_16x16x32_bf16 v[96:99], a[184:187], v[192:195], v[96:99]
    ds_read_b128 a[184:187], v7 offset:28672
    v_mfma_f32_16x16x32_bf16 v[72:75], a[188:191], v[188:191], v[72:75]
    ds_read_b128 v[124:127], v12 offset:1024
    v_mfma_f32_16x16x32_bf16 v[100:103], a[188:191], v[192:195], v[100:103]
    ds_read_b128 a[188:191], v7 offset:29696
    v_mfma_f32_16x16x32_bf16 v[76:79], a[192:195], v[188:191], v[76:79]
    ds_read_b128 v[128:131], v12 offset:2048
    v_mfma_f32_16x16x32_bf16 v[104:107], a[192:195], v[192:195], v[104:107]
    ds_read_b128 a[192:195], v7 offset:30720
    s_waitcnt lgkmcnt(9)
    v_mfma_f32_16x16x32_bf16 v[80:83], v[188:191], a[196:199], v[80:83]
    ds_read_b128 v[132:135], v12 offset:3072
    v_mfma_f32_16x16x32_bf16 v[108:111], v[192:195], a[196:199], v[108:111]
    ds_read_b128 a[196:199], v7 offset:31744
    s_waitcnt lgkmcnt(10)
    v_mfma_f32_16x16x32_bf16 v[84:87], v[188:191], a[200:203], v[84:87]
    ds_read_b128 v[220:223], v14 offset:0
    v_mfma_f32_16x16x32_bf16 v[112:115], v[192:195], a[200:203], v[112:115]
    ds_read_b128 a[200:203], v7 offset:32768
    s_waitcnt lgkmcnt(11)
    v_mfma_f32_16x16x32_bf16 v[88:91], a[204:207], v[188:191], v[88:91]
    ds_read_b128 v[224:227], v14 offset:1024
    v_mfma_f32_16x16x32_bf16 v[116:119], a[204:207], v[192:195], v[116:119]
    ds_read_b128 a[204:207], v39 offset:27648
    ds_read_b128 v[228:231], v14 offset:2048
    ds_read_b128 v[232:235], v14 offset:3072
    s_waitcnt vmcnt(0)
    v_max_u32 v240, v196, v200
    v_cmp_eq_u32 vcc, -1, v240
    s_cbranch_vccnz L_xs17_n
L_xr17_n:
    s_waitcnt lgkmcnt(14)
    v_mfma_f32_16x16x32_bf16 v[64:67], a[180:183], v[196:199], v[64:67]
    s_waitcnt lgkmcnt(0)
    v_pk_add_f32 v[120:121], v[120:121], v[124:125]
    v_mfma_f32_16x16x32_bf16 v[92:95], a[180:183], v[200:203], v[92:95]
    v_pk_add_f32 v[128:129], v[128:129], v[132:133]
    v_mfma_f32_16x16x32_bf16 v[68:71], a[184:187], v[196:199], v[68:71]
    v_pk_add_f32 v[122:123], v[122:123], v[126:127]
    v_pk_add_f32 v[130:131], v[130:131], v[134:135]
    v_mfma_f32_16x16x32_bf16 v[96:99], a[184:187], v[200:203], v[96:99]
    v_pk_add_f32 v[220:221], v[220:221], v[224:225]
    v_mfma_f32_16x16x32_bf16 v[72:75], a[188:191], v[196:199], v[72:75]
    v_pk_add_f32 v[228:229], v[228:229], v[232:233]
    v_mfma_f32_16x16x32_bf16 v[100:103], a[188:191], v[200:203], v[100:103]
    v_pk_add_f32 v[222:223], v[222:223], v[226:227]
    v_pk_add_f32 v[230:231], v[230:231], v[234:235]
    v_mfma_f32_16x16x32_bf16 v[76:79], a[192:195], v[196:199], v[76:79]
    v_pk_add_f32 v[120:121], v[120:121], v[128:129]
    v_pk_add_f32 v[122:123], v[122:123], v[130:131]
    v_mfma_f32_16x16x32_bf16 v[104:107], a[192:195], v[200:203], v[104:107]
    v_pk_add_f32 v[220:221], v[220:221], v[228:229]
    v_pk_add_f32 v[222:223], v[222:223], v[230:231]
    v_mfma_f32_16x16x32_bf16 v[80:83], v[196:199], a[196:199], v[80:83]
    v_cvt_pk_bf16_f32 v124, v120, v121
    v_cvt_pk_bf16_f32 v125, v122, v123
    v_mfma_f32_16x16x32_bf16 v[108:111], v[200:203], a[196:199], v[108:111]
    v_cvt_pk_bf16_f32 v244, v220, v221
    v_cvt_pk_bf16_f32 v245, v222, v223
    v_mfma_f32_16x16x32_bf16 v[84:87], v[196:199], a[200:203], v[84:87]
    ds_write_b64 v35, v[124:125]
    v_mfma_f32_16x16x32_bf16 v[112:115], v[200:203], a[200:203], v[112:115]
    v_mfma_f32_16x16x32_bf16 v[88:91], a[204:207], v[196:199], v[88:91]
    v_mfma_f32_16x16x32_bf16 v[116:119], a[204:207], v[200:203], v[116:119]
    s_nop 3
L_attn_n:
    v_mov_b32 v196, v244
    v_mov_b32 v197, v245
    v_mov_b32 v190, 0
    v_mov_b32 v191, 0
    v_mov_b32 v194, 0
    v_mov_b32 v195, 0
    v_mov_b32 v198, 0
    v_mov_b32 v199, 0
    v_cvt_pk_bf16_f32 v192, v116, v117
    v_cvt_pk_bf16_f32 v193, v118, v119
    v_cvt_pk_bf16_f32 v188, v88, v89
    v_cvt_pk_bf16_f32 v189, v90, v91
    v_mfma_f32_16x16x32_bf16 v[216:219], v[196:199], v[40:43], 0
    v_mfma_f32_16x16x32_bf16 v[212:215], v[192:195], v[40:43], 0
    v_mfma_f32_16x16x32_bf16 v[208:211], v[188:191], v[40:43], 0
    s_cmp_lg_u32 s98, 0
    s_cbranch_scc1 L_wo21_n
    s_add_u32 s8, s51, 0
    buffer_load_dwordx4 a[40:43], v27, s[40:43], s8 offen offset:1024
    s_add_u32 s8, s51, 0
    buffer_load_dwordx4 a[44:47], v27, s[40:43], s8 offen offset:2048
    s_add_u32 s8, s51, 0
    buffer_load_dwordx4 a[48:51], v27, s[40:43], s8 offen offset:3072
    s_add_u32 s8, s51, 4096
    buffer_load_dwordx4 a[52:55], v27, s[40:43], s8 offen offset:0
L_wo21_n:
    v_cvt_pk_bf16_f32 v136, v92, v93
    v_cvt_pk_bf16_f32 v137, v94, v95
    v_cvt_pk_bf16_f32 v160, v100, v101
    v_cvt_pk_bf16_f32 v161, v102, v103
    v_mov_b32 v138, v192
    v_mov_b32 v162, v192
    s_nop 1
    v_permlane16_swap_b32 v138, v162
    v_cndmask_b32 v138, 0, v138, s[90:91]
    v_mov_b32 v139, 0
    v_mov_b32 v163, 0
    v_cvt_pk_bf16_f32 v172, v108, v109
    v_cvt_pk_bf16_f32 v173, v110, v111
    s_cmp_lg_u32 s98, 0
    s_cbranch_scc1 L_wo22_n
    s_add_u32 s8, s51, 4096
    buffer_load_dwordx4 a[56:59], v27, s[40:43], s8 offen offset:1024
    s_add_u32 s8, s51, 4096
    buffer_load_dwordx4 a[60:63], v27, s[40:43], s8 offen offset:2048
    s_add_u32 s8, s51, 4096
    buffer_load_dwordx4 a[64:67], v27, s[40:43], s8 offen offset:3072
    s_add_u32 s8, s51, 8192
    buffer_load_dwordx4 a[68:71], v27, s[40:43], s8 offen offset:0
L_wo22_n:
    v_cvt_pk_bf16_f32 v140, v96, v97
    v_cvt_pk_bf16_f32 v141, v98, v99
    v_cvt_pk_bf16_f32 v164, v104, v105
    v_cvt_pk_bf16_f32 v165, v106, v107
    v_mov_b32 v142, v193
    v_mov_b32 v166, v193
    s_nop 1
    v_permlane16_swap_b32 v142, v166
    v_cndmask_b32 v142, 0, v142, s[90:91]
    v_mov_b32 v143, 0
    v_mov_b32 v167, 0
    v_cvt_pk_bf16_f32 v178, v112, v113
    v_cvt_pk_bf16_f32 v179, v114, v115
    v_mov_b32 v204, v196
    v_mov_b32 v202, v196
    s_nop 1
    v_permlane16_swap_b32 v204, v202
    v_mov_b32 v147, 0
    v_mov_b32 v205, v197
    v_mov_b32 v203, v197
    s_nop 1
    v_permlane16_swap_b32 v205, v203
    v_mov_b32 v151, 0
    v_cvt_pk_bf16_f32 v184, v212, v213
    v_cvt_pk_bf16_f32 v185, v214, v215
    v_cvt_pk_bf16_f32 v216, v216, v217
    v_cvt_pk_bf16_f32 v217, v218, v219
    v_mov_b32 v204, v162
    v_mov_b32 v205, v166
    ds_write_b64 v34, v[160:161] offset:0
    ds_write_b64 v34, v[164:165] offset:512
    ds_write_b64 v34, v[172:173] offset:1024
    ds_write_b64 v34, v[178:179] offset:1536
    ds_write_b64 v34, v[184:185] offset:2048
    ds_write_b64 v34, v[204:205] offset:2560
    ds_write_b64 v37, v[216:217] offset:2048
    ds_write_b64 v37, v[202:203] offset:2560
    s_cmp_lg_u32 s98, 0
    s_cbranch_scc1 L_wo23_n
    s_add_u32 s8, s50, 16384
    buffer_load_dwordx4 a[72:75], v27, s[40:43], s8 offen offset:2048
    s_add_u32 s8, s50, 16384
    buffer_load_dwordx4 a[76:79], v27, s[40:43], s8 offen offset:3072
    s_add_u32 s8, s50, 20480
    buffer_load_dwordx4 a[80:83], v27, s[40:43], s8 offen offset:0
    s_add_u32 s8, s50, 20480
    buffer_load_dwordx4 a[84:87], v27, s[40:43], s8 offen offset:1024
L_wo23_n:
    v_cvt_pk_bf16_f32 v128, v64, v65
    v_cvt_pk_bf16_f32 v129, v66, v67
    v_cvt_pk_bf16_f32 v152, v72, v73
    v_cvt_pk_bf16_f32 v153, v74, v75
    v_mov_b32 v130, v188
    v_mov_b32 v154, v188
    s_nop 1
    v_permlane16_swap_b32 v130, v154
    v_cndmask_b32 v130, 0, v130, s[90:91]
    v_mov_b32 v131, 0
    v_mov_b32 v155, 0
    v_cvt_pk_bf16_f32 v170, v80, v81
    v_cvt_pk_bf16_f32 v171, v82, v83
    s_cmp_lg_u32 s98, 0
    s_cbranch_scc1 L_wo24_n
    s_add_u32 s8, s50, 20480
    buffer_load_dwordx4 a[88:91], v27, s[40:43], s8 offen offset:2048
    s_add_u32 s8, s50, 20480
    buffer_load_dwordx4 a[92:95], v27, s[40:43], s8 offen offset:3072
    s_add_u32 s8, s50, 24576
    buffer_load_dwordx4 a[96:99], v27, s[40:43], s8 offen offset:0
    s_add_u32 s8, s50, 24576
    buffer_load_dwordx4 a[100:103], v27, s[40:43], s8 offen offset:1024
L_wo24_n:
    v_cvt_pk_bf16_f32 v132, v68, v69
    v_cvt_pk_bf16_f32 v133, v70, v71
    v_cvt_pk_bf16_f32 v156, v76, v77
    v_cvt_pk_bf16_f32 v157, v78, v79
    v_mov_b32 v134, v189
    v_mov_b32 v158, v189
    s_nop 1
    v_permlane16_swap_b32 v134, v158
    v_cndmask_b32 v134, 0, v134, s[90:91]
    v_mov_b32 v135, 0
    v_mov_b32 v159, 0
    v_cvt_pk_bf16_f32 v176, v84, v85
    v_cvt_pk_bf16_f32 v177, v86, v87
    v_cvt_pk_bf16_f32 v182, v208, v209
    v_cvt_pk_bf16_f32 v183, v210, v211
    v_mfma_f32_16x16x32_bf16 v[84:87], v[160:163], v[136:139], 0
    v_mfma_f32_16x16x32_bf16 v[92:95], v[164:167], v[140:143], 0
    v_mfma_f32_16x16x32_bf16 v[68:71], v[152:155], v[128:131], 0
    v_mfma_f32_16x16x32_bf16 v[76:79], v[156:159], v[132:135], 0
    v_mfma_f32_16x16x32_bf16 v[80:83], v[152:155], v[136:139], 0
    v_mfma_f32_16x16x32_bf16 v[88:91], v[156:159], v[140:143], 0
    s_cmp_lg_u32 s98, 0
    s_cbranch_scc1 L_wo25_n
    s_add_u32 s8, s50, 24576
    buffer_load_dwordx4 a[104:107], v27, s[40:43], s8 offen offset:2048
    s_add_u32 s8, s51, 16384
    buffer_load_dwordx4 a[108:111], v27, s[40:43], s8 offen offset:2048
    s_add_u32 s8, s51, 16384
    buffer_load_dwordx4 a[112:115], v27, s[40:43], s8 offen offset:3072
    s_add_u32 s8, s51, 20480
    buffer_load_dwordx4 a[116:119], v27, s[40:43], s8 offen offset:0
L_wo25_n:
    s_waitcnt lgkmcnt(0)
    s_barrier
    ds_read_b64 v[144:145], v38 offset:0
    ds_read_b64 v[148:149], v38 offset:512
    ds_read_b64 v[204:205], v38 offset:2560
    ds_read_b64 v[168:169], v38 offset:1024
    ds_read_b64 v[174:175], v38 offset:1536
    ds_read_b64 v[180:181], v38 offset:2048
    v_mov_b32 v100, 0xf149f2ca
    v_accvgpr_read_b32 v120, a252
    v_accvgpr_read_b32 v121, a253
    v_accvgpr_read_b32 v122, a254
    v_accvgpr_read_b32 v123, a255
    s_waitcnt lgkmcnt(3)
    v_mov_b32 v146, v204
    v_mov_b32 v150, v205
    s_nop 0
    v_mfma_f32_16x16x32_bf16 v[64:67], v[144:147], v[128:131], 0
    v_mfma_f32_16x16x32_bf16 v[72:75], v[148:151], v[132:135], 0
    v_cndmask_b32 v84, v100, v84, s[16:17]
    v_cndmask_b32 v85, v100, v85, s[18:19]
    v_cndmask_b32 v86, v100, v86, s[20:21]
    v_cndmask_b32 v87, v100, v87, s[22:23]
    v_cndmask_b32 v92, v100, v92, s[16:17]
    v_cndmask_b32 v93, v100, v93, s[18:19]
    v_cndmask_b32 v94, v100, v94, s[20:21]
    v_cndmask_b32 v95, v100, v95, s[22:23]
    v_cndmask_b32 v84, v84, v80, s[24:25]
    v_cndmask_b32 v85, v85, v81, s[26:27]
    v_cndmask_b32 v86, v86, v82, s[28:29]
    v_cndmask_b32 v87, v87, v83, s[30:31]
    v_cndmask_b32 v92, v92, v88, s[24:25]
    v_cndmask_b32 v93, v93, v89, s[26:27]
    v_cndmask_b32 v94, v94, v90, s[28:29]
    v_cndmask_b32 v95, v95, v91, s[30:31]
    v_cvt_pk_bf16_f32 v84, 0, v84
    v_cvt_pk_bf16_f32 v85, 0, v85
    v_cvt_pk_bf16_f32 v86, 0, v86
    v_cvt_pk_bf16_f32 v87, 0, v87
    v_cvt_pk_bf16_f32 v92, 0, v92
    v_cvt_pk_bf16_f32 v93, 0, v93
    v_cvt_pk_bf16_f32 v94, 0, v94
    v_cvt_pk_bf16_f32 v95, 0, v95
    v_pk_mul_f32 v[84:85], v[84:85], s[96:97]
    v_pk_mul_f32 v[86:87], v[86:87], s[96:97]
    v_pk_mul_f32 v[92:93], v[92:93], s[96:97]
    v_pk_mul_f32 v[94:95], v[94:95], s[96:97]
    v_cvt_pk_bf16_f32 v84, 0, v84
    v_cvt_pk_bf16_f32 v85, 0, v85
    v_cvt_pk_bf16_f32 v86, 0, v86
    v_cvt_pk_bf16_f32 v87, 0, v87
    v_cvt_pk_bf16_f32 v92, 0, v92
    v_cvt_pk_bf16_f32 v93, 0, v93
    v_cvt_pk_bf16_f32 v94, 0, v94
    v_cvt_pk_bf16_f32 v95, 0, v95
    v_max3_f32 v102, v84, v85, v86
    v_max3_f32 v108, v92, v93, v94
    v_max_f32 v102, v102, v87
    v_max_f32 v108, v108, v95
    s_nop 1
    v_permlane16_swap_b32 v102, v108
    v_max_f32 v102, v102, v108
    v_mov_b32 v108, v102
    s_nop 1
    v_permlane32_swap_b32 v102, v108
    v_max_f32 v102, v102, v108
    v_mul_f32 v102, -s94, v102
    v_mov_b32 v108, v102
    s_nop 1
    v_permlane16_swap_b32 v102, v108
    v_pk_fma_f32 v[84:85], v[84:85], s[94:95], v[102:103] op_sel_hi:[1,1,0]
    v_pk_fma_f32 v[86:87], v[86:87], s[94:95], v[102:103] op_sel_hi:[1,1,0]
    v_pk_fma_f32 v[92:93], v[92:93], s[94:95], v[108:109] op_sel_hi:[1,1,0]
    v_pk_fma_f32 v[94:95], v[94:95], s[94:95], v[108:109] op_sel_hi:[1,1,0]
    v_exp_f32 v84, v84
    v_exp_f32 v85, v85
    v_exp_f32 v86, v86
    v_exp_f32 v87, v87
    v_exp_f32 v92, v92
    v_exp_f32 v93, v93
    v_exp_f32 v94, v94
    v_exp_f32 v95, v95
    v_pk_add_f32 v[102:103], v[84:85], v[86:87]
    v_pk_add_f32 v[108:109], v[92:93], v[94:95]
    v_add_f32 v102, v102, v103
    v_add_f32 v108, v108, v109
    s_nop 1
    v_permlane16_swap_b32 v102, v108
    v_add_f32 v102, v102, v108
    v_mov_b32 v108, v102
    s_nop 1
    v_permlane32_swap_b32 v102, v108
    v_add_f32 v102, v102, v108
    v_rcp_f32 v102, v102
    s_nop 0
    v_mov_b32 v108, v102
    s_nop 1
    v_permlane16_swap_b32 v102, v108
    v_pk_mul_f32 v[84:85], v[84:85], v[102:103] op_sel_hi:[1,0]
    v_pk_mul_f32 v[86:87], v[86:87], v[102:103] op_sel_hi:[1,0]
    v_pk_mul_f32 v[92:93], v[92:93], v[108:109] op_sel_hi:[1,0]
    v_pk_mul_f32 v[94:95], v[94:95], v[108:109] op_sel_hi:[1,0]
    v_cvt_pk_bf16_f32 v218, v84, v85
    v_cvt_pk_bf16_f32 v219, v86, v87
    v_cvt_pk_bf16_f32 v222, v92, v93
    v_cvt_pk_bf16_f32 v223, v94, v95
    v_and_b32 v216, v122, v218
    v_and_b32 v217, v123, v219
    v_and_b32 v220, v122, v222
    v_and_b32 v221, v123, v223
    v_bfi_b32 v218, v122, 0, v218
    v_bfi_b32 v219, v123, 0, v219
    v_bfi_b32 v222, v122, 0, v222
    v_bfi_b32 v223, v123, 0, v223
    s_cmp_lg_u32 s98, 0
    s_cbranch_scc1 L_fc_ni_n
    buffer_load_dwordx4 v[54:57], v15, s[40:43], s85 offen sc1
    buffer_load_dwordx4 v[58:61], v15, s[40:43], s85 offen offset:16 sc1
L_fc_ni_n:
    v_mfma_f32_16x16x32_bf16 v[232:235], v[170:173], v[216:219], 0
    v_mfma_f32_16x16x32_bf16 v[112:115], v[182:185], v[216:219], 0
    v_mfma_f32_16x16x32_bf16 v[236:239], v[176:179], v[220:223], 0
    v_mfma_f32_16x16x32_bf16 v[116:119], v[182:185], v[220:223], 0
    s_nop 4
    v_cvt_pk_bf16_f32 v246, v232, v233
    v_cvt_pk_bf16_f32 v247, v234, v235
    v_cvt_pk_bf16_f32 v248, v236, v237
    v_cvt_pk_bf16_f32 v249, v238, v239
    s_nop 0
    v_permlane16_swap_b32 v246, v248
    v_permlane16_swap_b32 v247, v249
    buffer_store_dwordx4 v[246:249], v32, s[40:43], s49 offen offset:2048 sc1
    v_cvt_pk_bf16_f32 v250, v112, v113
    v_cvt_pk_bf16_f32 v251, v118, v119
    s_mov_b64 exec, s[90:91]
    buffer_store_dwordx2 v[250:251], v33, s[40:43], s49 offen offset:256 sc1
    s_mov_b64 exec, -1
    s_waitcnt lgkmcnt(0)
    v_cndmask_b32 v68, v100, v68, s[16:17]
    v_cndmask_b32 v69, v100, v69, s[18:19]
    v_cndmask_b32 v70, v100, v70, s[20:21]
    v_cndmask_b32 v71, v100, v71, s[22:23]
    v_cndmask_b32 v76, v100, v76, s[16:17]
    v_cndmask_b32 v77, v100, v77, s[18:19]
    v_cndmask_b32 v78, v100, v78, s[20:21]
    v_cndmask_b32 v79, v100, v79, s[22:23]
    v_cndmask_b32 v68, v68, v64, s[32:33]
    v_cndmask_b32 v69, v69, v65, s[34:35]
    v_cndmask_b32 v70, v70, v66, s[36:37]
    v_cndmask_b32 v71, v71, v67, s[38:39]
    v_cndmask_b32 v76, v76, v72, s[32:33]
    v_cndmask_b32 v77, v77, v73, s[34:35]
    v_cndmask_b32 v78, v78, v74, s[36:37]
    v_cndmask_b32 v79, v79, v75, s[38:39]
    v_cvt_pk_bf16_f32 v68, 0, v68
    v_cvt_pk_bf16_f32 v69, 0, v69
    v_cvt_pk_bf16_f32 v70, 0, v70
    v_cvt_pk_bf16_f32 v71, 0, v71
    v_cvt_pk_bf16_f32 v76, 0, v76
    v_cvt_pk_bf16_f32 v77, 0, v77
    v_cvt_pk_bf16_f32 v78, 0, v78
    v_cvt_pk_bf16_f32 v79, 0, v79
    v_pk_mul_f32 v[68:69], v[68:69], s[96:97]
    v_pk_mul_f32 v[70:71], v[70:71], s[96:97]
    v_pk_mul_f32 v[76:77], v[76:77], s[96:97]
    v_pk_mul_f32 v[78:79], v[78:79], s[96:97]
    v_cvt_pk_bf16_f32 v68, 0, v68
    v_cvt_pk_bf16_f32 v69, 0, v69
    v_cvt_pk_bf16_f32 v70, 0, v70
    v_cvt_pk_bf16_f32 v71, 0, v71
    v_cvt_pk_bf16_f32 v76, 0, v76
    v_cvt_pk_bf16_f32 v77, 0, v77
    v_cvt_pk_bf16_f32 v78, 0, v78
    v_cvt_pk_bf16_f32 v79, 0, v79
    v_max3_f32 v102, v68, v69, v70
    v_max3_f32 v108, v76, v77, v78
    v_max_f32 v102, v102, v71
    v_max_f32 v108, v108, v79
    s_nop 1
    v_permlane16_swap_b32 v102, v108
    v_max_f32 v102, v102, v108
    v_mov_b32 v108, v102
    s_nop 1
    v_permlane32_swap_b32 v102, v108
    v_max_f32 v102, v102, v108
    v_mul_f32 v102, -s94, v102
    v_mov_b32 v108, v102
    s_nop 1
    v_permlane16_swap_b32 v102, v108
    v_pk_fma_f32 v[68:69], v[68:69], s[94:95], v[102:103] op_sel_hi:[1,1,0]
    v_pk_fma_f32 v[70:71], v[70:71], s[94:95], v[102:103] op_sel_hi:[1,1,0]
    v_pk_fma_f32 v[76:77], v[76:77], s[94:95], v[108:109] op_sel_hi:[1,1,0]
    v_pk_fma_f32 v[78:79], v[78:79], s[94:95], v[108:109] op_sel_hi:[1,1,0]
    v_exp_f32 v68, v68
    v_exp_f32 v69, v69
    v_exp_f32 v70, v70
    v_exp_f32 v71, v71
    v_exp_f32 v76, v76
    v_exp_f32 v77, v77
    v_exp_f32 v78, v78
    v_exp_f32 v79, v79
    v_pk_add_f32 v[102:103], v[68:69], v[70:71]
    v_pk_add_f32 v[108:109], v[76:77], v[78:79]
    v_add_f32 v102, v102, v103
    v_add_f32 v108, v108, v109
    s_nop 1
    v_permlane16_swap_b32 v102, v108
    v_add_f32 v102, v102, v108
    v_mov_b32 v108, v102
    s_nop 1
    v_permlane32_swap_b32 v102, v108
    v_add_f32 v102, v102, v108
    v_rcp_f32 v102, v102
    s_nop 0
    v_mov_b32 v108, v102
    s_nop 1
    v_permlane16_swap_b32 v102, v108
    v_pk_mul_f32 v[68:69], v[68:69], v[102:103] op_sel_hi:[1,0]
    v_pk_mul_f32 v[70:71], v[70:71], v[102:103] op_sel_hi:[1,0]
    v_pk_mul_f32 v[76:77], v[76:77], v[108:109] op_sel_hi:[1,0]
    v_pk_mul_f32 v[78:79], v[78:79], v[108:109] op_sel_hi:[1,0]
    v_cvt_pk_bf16_f32 v210, v68, v69
    v_cvt_pk_bf16_f32 v211, v70, v71
    v_cvt_pk_bf16_f32 v214, v76, v77
    v_cvt_pk_bf16_f32 v215, v78, v79
    v_and_b32 v208, v120, v210
    v_and_b32 v209, v121, v211
    v_and_b32 v212, v120, v214
    v_and_b32 v213, v121, v215
    v_bfi_b32 v210, v120, 0, v210
    v_bfi_b32 v211, v121, 0, v211
    v_bfi_b32 v214, v120, 0, v214
    v_bfi_b32 v215, v121, 0, v215
    v_mfma_f32_16x16x32_bf16 v[224:227], v[168:171], v[208:211], 0
    v_mfma_f32_16x16x32_bf16 v[112:115], v[180:183], v[208:211], 0
    v_mfma_f32_16x16x32_bf16 v[228:231], v[174:177], v[212:215], 0
    v_mfma_f32_16x16x32_bf16 v[116:119], v[180:183], v[212:215], 0
    s_nop 4
    v_cvt_pk_bf16_f32 v240, v224, v225
    v_cvt_pk_bf16_f32 v241, v226, v227
    v_cvt_pk_bf16_f32 v242, v228, v229
    v_cvt_pk_bf16_f32 v243, v230, v231
    s_nop 0
    v_permlane16_swap_b32 v240, v242
    v_permlane16_swap_b32 v241, v243
    buffer_store_dwordx4 v[240:243], v32, s[40:43], s49 offen offset:0 sc1
    v_cvt_pk_bf16_f32 v244, v112, v113
    v_cvt_pk_bf16_f32 v245, v118, v119
    s_mov_b64 exec, s[90:91]
    buffer_store_dwordx2 v[244:245], v33, s[40:43], s49 offen offset:0 sc1
    s_mov_b64 exec, -1
    s_cmp_lg_u32 s98, 0
    s_cbranch_scc1 L_fc_done_n
    s_waitcnt vmcnt(4)
    v_cmp_ne_u64 vcc, v[30:31], v[54:55]
    v_cmp_ne_u64 s[10:11], v[30:31], v[56:57]
    v_cmp_ne_u64 s[12:13], v[30:31], v[58:59]
    v_cmp_ne_u64 s[14:15], v[30:31], v[60:61]
    s_or_b64 s[10:11], s[10:11], vcc
    s_or_b64 s[12:13], s[12:13], s[14:15]
    s_or_b64 vcc, s[10:11], s[12:13]
    s_cmp_eq_u64 vcc, 0
    s_cbranch_scc1 L_pd27_n
    s_mov_b32 s93, 0
    s_nop 1
L_pl26_n:
    s_sleep 8
    buffer_load_dwordx4 v[54:57], v15, s[40:43], s85 offen sc1
    buffer_load_dwordx4 v[58:61], v15, s[40:43], s85 offen offset:16 sc1
    s_waitcnt vmcnt(0)
    v_cmp_ne_u64 vcc, v[30:31], v[54:55]
    v_cmp_ne_u64 s[10:11], v[30:31], v[56:57]
    v_cmp_ne_u64 s[12:13], v[30:31], v[58:59]
    v_cmp_ne_u64 s[14:15], v[30:31], v[60:61]
    s_or_b64 s[10:11], s[10:11], vcc
    s_or_b64 s[12:13], s[12:13], s[14:15]
    s_or_b64 vcc, s[10:11], s[12:13]
    s_cmp_eq_u64 vcc, 0
    s_cbranch_scc1 L_pd27_n
    s_add_u32 s93, s93, 1
    s_cmp_lt_u32 s93, 30000
    s_cbranch_scc1 L_pl26_n
L_pd27_n:
    s_nop 0
L_fc_done_n:
    s_nop 1
    s_lshl_b32 s8, s3, 12
    s_add_u32 s8, s8, 124416
    v_add_u32 v100, s8, v27
    s_mul_i32 s8, s6, 18432
    s_lshl_b32 s9, s7, 10
    s_add_u32 s9, s9, s8
    s_add_u32 s9, s9, 140800
    v_add_u32 v101, s9, v27
    s_mul_i32 s9, s7, 9216
    s_sub_u32 s10, 9216, s9
    s_sub_u32 s11, 18432, s8
    s_add_u32 s8, s8, 124416
    s_add_u32 s11, s11, 124416
    s_add_u32 s12, s8, s9
    v_add_u32 v102, s12, v27
    s_add_u32 s12, s11, s9
    v_add_u32 v103, s12, v27
    s_add_u32 s12, s8, s10
    v_add_u32 v104, s12, v27
    s_add_u32 s12, s11, s10
    v_add_u32 v105, s12, v27
    s_lshl_b32 s12, s6, 10
    s_add_u32 s12, s12, 161280
    v_add_u32 v106, s12, v27
    s_mov_b32 s93, 0
    s_barrier
L_p2r_n:
    s_add_u32 s8, s49, 0
    buffer_load_dwordx4 v[64:67], v25, s[40:43], s8 offen offset:0 sc1
    buffer_load_dwordx4 v[68:71], v25, s[40:43], s8 offen offset:1024 sc1
    s_add_u32 s8, s49, 36864
    buffer_load_dwordx4 v[72:75], v25, s[40:43], s8 offen offset:0 sc1
    buffer_load_dwordx4 v[76:79], v25, s[40:43], s8 offen offset:1024 sc1
    s_add_u32 s8, s49, 73728
    buffer_load_dwordx4 v[80:83], v25, s[40:43], s8 offen offset:0 sc1
    buffer_load_dwordx4 v[84:87], v25, s[40:43], s8 offen offset:1024 sc1
    s_add_u32 s8, s49, 110592
    buffer_load_dwordx4 v[88:91], v25, s[40:43], s8 offen offset:0 sc1
    buffer_load_dwordx4 v[92:95], v25, s[40:43], s8 offen offset:1024 sc1
    buffer_load_dwordx2 v[96:97], v26, s[40:43], s49 offen sc1
    s_add_u32 s8, s49, 36864
    buffer_load_dwordx2 v[98:99], v26, s[40:43], s8 offen sc1
    s_waitcnt vmcnt(9)
    ds_write_b128 v100, v[64:67] offset:0
    v_max3_u32 v107, v64, v65, v66
    v_max_u32 v107, v107, v67
    s_waitcnt vmcnt(8)
    ds_write_b128 v100, v[68:71] offset:18432
    v_max3_u32 v107, v107, v68, v69
    v_max3_u32 v107, v107, v70, v71
    s_waitcnt vmcnt(7)
    ds_write_b128 v100, v[72:75] offset:1024
    v_max3_u32 v107, v107, v72, v73
    v_max3_u32 v107, v107, v74, v75
    s_waitcnt vmcnt(6)
    ds_write_b128 v100, v[76:79] offset:19456
    v_max3_u32 v107, v107, v76, v77
    v_max3_u32 v107, v107, v78, v79
    s_waitcnt vmcnt(5)
    ds_write_b128 v100, v[80:83] offset:2048
    v_max3_u32 v107, v107, v80, v81
    v_max3_u32 v107, v107, v82, v83
    s_waitcnt vmcnt(4)
    ds_write_b128 v100, v[84:87] offset:20480
    v_max3_u32 v107, v107, v84, v85
    v_max3_u32 v107, v107, v86, v87
    s_waitcnt vmcnt(3)
    ds_write_b128 v100, v[88:91] offset:3072
    v_max3_u32 v107, v107, v88, v89
    v_max3_u32 v107, v107, v90, v91
    s_waitcnt vmcnt(2)
    ds_write_b128 v100, v[92:95] offset:21504
    v_max3_u32 v107, v107, v92, v93
    v_max3_u32 v107, v107, v94, v95
    s_waitcnt vmcnt(0)
    ds_write_b128 v101, v[96:99]
    v_max3_u32 v107, v107, v96, v97
    v_max3_u32 v107, v107, v98, v99
    v_cmp_eq_u32 vcc, -1, v107
    s_nop 0
    s_cmp_eq_u64 vcc, 0
    s_cbranch_scc1 L_sd28_n
    s_add_u32 s93, s93, 1
    s_cmp_lt_u32 s93, 30000
    s_cbranch_scc1 L_p2r_n
L_sd28_n:
    s_nop 0
    s_cmp_lg_u32 s98, 0
    s_cbranch_scc1 L_noyl_n
    v_lshlrev_b32 v156, 14, v0
    v_cmp_gt_u32 vcc, 144, v0
    s_nop 1
    v_cndmask_b32 v156, v63, v156, vcc
    s_add_u32 s8, s86, 0
    buffer_load_dwordx4 v[140:143], v156, s[40:43], s8 offen sc1
    s_add_u32 s8, s86, 4096
    buffer_load_dwordx4 v[144:147], v156, s[40:43], s8 offen sc1
    s_add_u32 s8, s86, 8192
    buffer_load_dwordx4 v[148:151], v156, s[40:43], s8 offen sc1
    s_add_u32 s8, s86, 12288
    buffer_load_dwordx4 v[152:155], v156, s[40:43], s8 offen sc1
L_noyl_n:
    s_waitcnt lgkmcnt(0)
    s_barrier
    ds_read_b128 v[108:111], v102 offset:0
    ds_read_b128 v[112:115], v103 offset:0
    ds_read_b128 v[116:119], v102 offset:1024
    ds_read_b128 v[120:123], v103 offset:1024
    ds_read_b128 v[124:127], v102 offset:2048
    ds_read_b128 v[128:131], v103 offset:2048
    s_waitcnt lgkmcnt(4)
    v_mfma_f32_16x16x32_bf16 v[64:67], a[0:3], v[108:111], 0
    v_mfma_f32_16x16x32_bf16 v[68:71], a[72:75], v[108:111], 0
    ds_read_b128 v[132:135], v102 offset:3072
    v_mfma_f32_16x16x32_bf16 v[72:75], a[0:3], v[112:115], 0
    v_mfma_f32_16x16x32_bf16 v[76:79], a[72:75], v[112:115], 0
    ds_read_b128 v[136:139], v103 offset:3072
    v_mfma_f32_16x16x32_bf16 v[80:83], a[144:147], v[108:111], 0
    s_waitcnt lgkmcnt(4)
    v_mfma_f32_16x16x32_bf16 v[64:67], a[4:7], v[116:119], v[64:67]
    v_mfma_f32_16x16x32_bf16 v[68:71], a[76:79], v[116:119], v[68:71]
    ds_read_b128 v[108:111], v102 offset:4096
    v_mfma_f32_16x16x32_bf16 v[72:75], a[4:7], v[120:123], v[72:75]
    v_mfma_f32_16x16x32_bf16 v[76:79], a[76:79], v[120:123], v[76:79]
    ds_read_b128 v[112:115], v103 offset:4096
    v_mfma_f32_16x16x32_bf16 v[80:83], a[148:151], v[116:119], v[80:83]
    s_waitcnt lgkmcnt(4)
    v_mfma_f32_16x16x32_bf16 v[64:67], a[8:11], v[124:127], v[64:67]
    v_mfma_f32_16x16x32_bf16 v[68:71], a[80:83], v[124:127], v[68:71]
    ds_read_b128 v[116:119], v102 offset:5120
    v_mfma_f32_16x16x32_bf16 v[72:75], a[8:11], v[128:131], v[72:75]
    v_mfma_f32_16x16x32_bf16 v[76:79], a[80:83], v[128:131], v[76:79]
    ds_read_b128 v[120:123], v103 offset:5120
    v_mfma_f32_16x16x32_bf16 v[80:83], a[152:155], v[124:127], v[80:83]
    s_waitcnt lgkmcnt(4)
    v_mfma_f32_16x16x32_bf16 v[64:67], a[12:15], v[132:135], v[64:67]
    v_mfma_f32_16x16x32_bf16 v[68:71], a[84:87], v[132:135], v[68:71]
    ds_read_b128 v[124:127], v102 offset:6144
    v_mfma_f32_16x16x32_bf16 v[72:75], a[12:15], v[136:139], v[72:75]
    v_mfma_f32_16x16x32_bf16 v[76:79], a[84:87], v[136:139], v[76:79]
    ds_read_b128 v[128:131], v103 offset:6144
    v_mfma_f32_16x16x32_bf16 v[80:83], a[156:159], v[132:135], v[80:83]
    s_waitcnt lgkmcnt(4)
    v_mfma_f32_16x16x32_bf16 v[64:67], a[16:19], v[108:111], v[64:67]
    v_mfma_f32_16x16x32_bf16 v[68:71], a[88:91], v[108:111], v[68:71]
    ds_read_b128 v[132:135], v102 offset:7168
    v_mfma_f32_16x16x32_bf16 v[72:75], a[16:19], v[112:115], v[72:75]
    v_mfma_f32_16x16x32_bf16 v[76:79], a[88:91], v[112:115], v[76:79]
    ds_read_b128 v[136:139], v103 offset:7168
    v_mfma_f32_16x16x32_bf16 v[80:83], a[160:163], v[108:111], v[80:83]
    s_waitcnt lgkmcnt(4)
    v_mfma_f32_16x16x32_bf16 v[64:67], a[20:23], v[116:119], v[64:67]
    v_mfma_f32_16x16x32_bf16 v[68:71], a[92:95], v[116:119], v[68:71]
    ds_read_b128 v[108:111], v102 offset:8192
    v_mfma_f32_16x16x32_bf16 v[72:75], a[20:23], v[120:123], v[72:75]
    v_mfma_f32_16x16x32_bf16 v[76:79], a[92:95], v[120:123], v[76:79]
    ds_read_b128 v[112:115], v103 offset:8192
    v_mfma_f32_16x16x32_bf16 v[80:83], a[164:167], v[116:119], v[80:83]
    s_waitcnt lgkmcnt(4)
    v_mfma_f32_16x16x32_bf16 v[64:67], a[24:27], v[124:127], v[64:67]
    v_mfma_f32_16x16x32_bf16 v[68:71], a[96:99], v[124:127], v[68:71]
    ds_read_b128 v[116:119], v104 offset:0
    v_mfma_f32_16x16x32_bf16 v[72:75], a[24:27], v[128:131], v[72:75]
    v_mfma_f32_16x16x32_bf16 v[76:79], a[96:99], v[128:131], v[76:79]
    ds_read_b128 v[120:123], v105 offset:0
    v_mfma_f32_16x16x32_bf16 v[80:83], a[168:171], v[124:127], v[80:83]
    s_waitcnt lgkmcnt(4)
    v_mfma_f32_16x16x32_bf16 v[64:67], a[28:31], v[132:135], v[64:67]
    v_mfma_f32_16x16x32_bf16 v[68:71], a[100:103], v[132:135], v[68:71]
    ds_read_b128 v[124:127], v104 offset:1024
    v_mfma_f32_16x16x32_bf16 v[72:75], a[28:31], v[136:139], v[72:75]
    v_mfma_f32_16x16x32_bf16 v[76:79], a[100:103], v[136:139], v[76:79]
    ds_read_b128 v[128:131], v105 offset:1024
    v_mfma_f32_16x16x32_bf16 v[80:83], a[172:175], v[132:135], v[80:83]
    s_waitcnt lgkmcnt(4)
    v_mfma_f32_16x16x32_bf16 v[64:67], a[32:35], v[108:111], v[64:67]
    v_mfma_f32_16x16x32_bf16 v[68:71], a[104:107], v[108:111], v[68:71]
    ds_read_b128 v[132:135], v104 offset:2048
    v_mfma_f32_16x16x32_bf16 v[72:75], a[32:35], v[112:115], v[72:75]
    v_mfma_f32_16x16x32_bf16 v[76:79], a[104:107], v[112:115], v[76:79]
    ds_read_b128 v[136:139], v105 offset:2048
    v_mfma_f32_16x16x32_bf16 v[80:83], a[176:179], v[108:111], v[80:83]
    s_waitcnt lgkmcnt(4)
    v_mfma_f32_16x16x32_bf16 v[64:67], a[36:39], v[116:119], v[64:67]
    v_mfma_f32_16x16x32_bf16 v[68:71], a[108:111], v[116:119], v[68:71]
    ds_read_b128 v[108:111], v104 offset:3072
    v_mfma_f32_16x16x32_bf16 v[72:75], a[36:39], v[120:123], v[72:75]
    v_mfma_f32_16x16x32_bf16 v[76:79], a[108:111], v[120:123], v[76:79]
    ds_read_b128 v[112:115], v105 offset:3072
    s_waitcnt lgkmcnt(4)
    v_mfma_f32_16x16x32_bf16 v[64:67], a[40:43], v[124:127], v[64:67]
    v_mfma_f32_16x16x32_bf16 v[68:71], a[112:115], v[124:127], v[68:71]
    ds_read_b128 v[116:119], v104 offset:4096
    v_mfma_f32_16x16x32_bf16 v[72:75], a[40:43], v[128:131], v[72:75]
    v_mfma_f32_16x16x32_bf16 v[76:79], a[112:115], v[128:131], v[76:79]
    ds_read_b128 v[120:123], v105 offset:4096
    s_cmp_lt_u32 s3, 2
    s_cbranch_scc1 L_no9w_n
    ds_write_b128 v106, v[80:83]
L_no9w_n:
    s_waitcnt lgkmcnt(4)
    v_mfma_f32_16x16x32_bf16 v[64:67], a[44:47], v[132:135], v[64:67]
    v_mfma_f32_16x16x32_bf16 v[68:71], a[116:119], v[132:135], v[68:71]
    ds_read_b128 v[124:127], v104 offset:5120
    v_mfma_f32_16x16x32_bf16 v[72:75], a[44:47], v[136:139], v[72:75]
    v_mfma_f32_16x16x32_bf16 v[76:79], a[116:119], v[136:139], v[76:79]
    ds_read_b128 v[128:131], v105 offset:5120
    s_waitcnt lgkmcnt(4)
    v_mfma_f32_16x16x32_bf16 v[64:67], a[48:51], v[108:111], v[64:67]
    v_mfma_f32_16x16x32_bf16 v[68:71], a[120:123], v[108:111], v[68:71]
    ds_read_b128 v[132:135], v104 offset:6144
    v_mfma_f32_16x16x32_bf16 v[72:75], a[48:51], v[112:115], v[72:75]
    v_mfma_f32_16x16x32_bf16 v[76:79], a[120:123], v[112:115], v[76:79]
    ds_read_b128 v[136:139], v105 offset:6144
    s_waitcnt lgkmcnt(4)
    v_mfma_f32_16x16x32_bf16 v[64:67], a[52:55], v[116:119], v[64:67]
    v_mfma_f32_16x16x32_bf16 v[68:71], a[124:127], v[116:119], v[68:71]
    ds_read_b128 v[108:111], v104 offset:7168
    v_mfma_f32_16x16x32_bf16 v[72:75], a[52:55], v[120:123], v[72:75]
    v_mfma_f32_16x16x32_bf16 v[76:79], a[124:127], v[120:123], v[76:79]
    ds_read_b128 v[112:115], v105 offset:7168
    s_waitcnt lgkmcnt(4)
    v_mfma_f32_16x16x32_bf16 v[64:67], a[56:59], v[124:127], v[64:67]
    v_mfma_f32_16x16x32_bf16 v[68:71], a[128:131], v[124:127], v[68:71]
    ds_read_b128 v[116:119], v104 offset:8192
    v_mfma_f32_16x16x32_bf16 v[72:75], a[56:59], v[128:131], v[72:75]
    v_mfma_f32_16x16x32_bf16 v[76:79], a[128:131], v[128:131], v[76:79]
    ds_read_b128 v[120:123], v105 offset:8192
    s_waitcnt lgkmcnt(4)
    v_mfma_f32_16x16x32_bf16 v[64:67], a[60:63], v[132:135], v[64:67]
    v_mfma_f32_16x16x32_bf16 v[68:71], a[132:135], v[132:135], v[68:71]
    v_mfma_f32_16x16x32_bf16 v[72:75], a[60:63], v[136:139], v[72:75]
    v_mfma_f32_16x16x32_bf16 v[76:79], a[132:135], v[136:139], v[76:79]
    s_waitcnt lgkmcnt(2)
    v_mfma_f32_16x16x32_bf16 v[64:67], a[64:67], v[108:111], v[64:67]
    v_mfma_f32_16x16x32_bf16 v[68:71], a[136:139], v[108:111], v[68:71]
    v_mfma_f32_16x16x32_bf16 v[72:75], a[64:67], v[112:115], v[72:75]
    v_mfma_f32_16x16x32_bf16 v[76:79], a[136:139], v[112:115], v[76:79]
    s_waitcnt lgkmcnt(0)
    v_mfma_f32_16x16x32_bf16 v[64:67], a[68:71], v[116:119], v[64:67]
    v_mfma_f32_16x16x32_bf16 v[68:71], a[140:143], v[116:119], v[68:71]
    v_mfma_f32_16x16x32_bf16 v[72:75], a[68:71], v[120:123], v[72:75]
    v_mfma_f32_16x16x32_bf16 v[76:79], a[140:143], v[120:123], v[76:79]
    s_waitcnt lgkmcnt(0)
    s_barrier
    ds_read_b128 v[100:103], v106
    s_nop 1
    v_cvt_pk_bf16_f32 v88, v64, v65
    v_cvt_pk_bf16_f32 v89, v66, v67
    v_cvt_pk_bf16_f32 v90, v68, v69
    v_cvt_pk_bf16_f32 v91, v70, v71
    buffer_store_dwordx4 v[88:91], v28, s[40:43], s49 offen sc1
    v_cvt_pk_bf16_f32 v92, v72, v73
    v_cvt_pk_bf16_f32 v93, v74, v75
    v_cvt_pk_bf16_f32 v94, v76, v77
    v_cvt_pk_bf16_f32 v95, v78, v79
    buffer_store_dwordx4 v[92:95], v11, s[40:43], s49 offen sc1
    s_cmp_ge_u32 s3, 2
    s_cbranch_scc1 L_no9_n
    s_waitcnt lgkmcnt(0)
    v_pk_add_f32 v[80:81], v[80:81], v[100:101]
    v_pk_add_f32 v[82:83], v[82:83], v[102:103]
    v_cvt_pk_bf16_f32 v96, v80, v81
    v_cvt_pk_bf16_f32 v97, v82, v83
    buffer_store_dwordx2 v[96:97], v29, s[40:43], s49 offen sc1
    s_waitcnt vmcnt(3)
    s_nop 0
    s_branch L_no9b_n
L_no9_n:
    s_waitcnt vmcnt(2)
L_no9b_n:
    s_waitcnt lgkmcnt(0)
    s_cmp_lg_u32 s98, 0
    s_cbranch_scc1 L_y_done_n
    v_cmp_gt_u32 vcc, 144, v0
    v_lshlrev_b32 v157, 3, v0
    v_add_u32 v157, 124416, v157
    v_perm_b32 v160, v144, v140, s100
    v_perm_b32 v161, v152, v148, s100
    v_perm_b32 v162, v144, v140, s99
    v_perm_b32 v163, v152, v148, s99
    v_perm_b32 v164, v145, v141, s100
    v_perm_b32 v165, v153, v149, s100
    v_perm_b32 v166, v145, v141, s99
    v_perm_b32 v167, v153, v149, s99
    v_perm_b32 v168, v146, v142, s100
    v_perm_b32 v169, v154, v150, s100
    v_perm_b32 v170, v146, v142, s99
    v_perm_b32 v171, v154, v150, s99
    v_perm_b32 v172, v147, v143, s100
    v_perm_b32 v173, v155, v151, s100
    v_perm_b32 v174, v147, v143, s99
    v_perm_b32 v175, v155, v151, s99
    s_mov_b64 exec, vcc
    ds_write_b64 v157, v[160:161] offset:0
    ds_write_b64 v157, v[162:163] offset:1168
    ds_write_b64 v157, v[164:165] offset:2336
    ds_write_b64 v157, v[166:167] offset:3504
    ds_write_b64 v157, v[168:169] offset:4672
    ds_write_b64 v157, v[170:171] offset:5840
    ds_write_b64 v157, v[172:173] offset:7008
    ds_write_b64 v157, v[174:175] offset:8176
    s_mov_b64 exec, -1
    s_waitcnt lgkmcnt(0)
    s_barrier
    ds_read_b128 v[160:163], v21
    ds_read_b128 v[164:167], v21 offset:512
    ds_read_b32 v61, v22
    s_waitcnt lgkmcnt(0)
    v_mov_b32 v53, v160
    v_mov_b32 v54, v161
    v_mov_b32 v55, v162
    v_mov_b32 v56, v163
    v_mov_b32 v57, v164
    v_mov_b32 v58, v165
    v_mov_b32 v59, v166
    v_mov_b32 v60, v167
L_y_done_n:
    s_nop 1
    buffer_load_dwordx4 v[64:67], v18, s[40:43], s49 offen sc1
    buffer_load_dwordx4 v[68:71], v19, s[40:43], s49 offen sc1
    buffer_load_dword v72, v20, s[40:43], s49 offen sc1
    v_and_b32 v81, s101, v44
    v_lshlrev_b32 v80, 16, v44
    v_and_b32 v83, s101, v45
    v_lshlrev_b32 v82, 16, v45
    v_and_b32 v85, s101, v46
    v_lshlrev_b32 v84, 16, v46
    v_and_b32 v87, s101, v47
    v_lshlrev_b32 v86, 16, v47
    v_and_b32 v89, s101, v48
    v_lshlrev_b32 v88, 16, v48
    v_and_b32 v91, s101, v49
    v_lshlrev_b32 v90, 16, v49
    v_and_b32 v93, s101, v50
    v_lshlrev_b32 v92, 16, v50
    v_and_b32 v95, s101, v51
    v_lshlrev_b32 v94, 16, v51
    v_and_b32 v97, s101, v52
    v_lshlrev_b32 v96, 16, v52
    v_and_b32 v121, s101, v53
    v_lshlrev_b32 v120, 16, v53
    v_and_b32 v123, s101, v54
    v_lshlrev_b32 v122, 16, v54
    v_and_b32 v125, s101, v55
    v_lshlrev_b32 v124, 16, v55
    v_and_b32 v127, s101, v56
    v_lshlrev_b32 v126, 16, v56
    v_and_b32 v129, s101, v57
    v_lshlrev_b32 v128, 16, v57
    v_and_b32 v131, s101, v58
    v_lshlrev_b32 v130, 16, v58
    v_and_b32 v133, s101, v59
    v_lshlrev_b32 v132, 16, v59
    v_and_b32 v135, s101, v60
    v_lshlrev_b32 v134, 16, v60
    v_and_b32 v137, s101, v61
    v_lshlrev_b32 v136, 16, v61
    s_mov_b32 s93, 0
    s_nop 1
    s_branch L_ar2_n
L_ar_n:
    buffer_load_dwordx4 v[64:67], v18, s[40:43], s49 offen sc1
    buffer_load_dwordx4 v[68:71], v19, s[40:43], s49 offen sc1
    buffer_load_dword v72, v20, s[40:43], s49 offen sc1
L_ar2_n:
    s_waitcnt vmcnt(0)
    v_max3_u32 v74, v64, v65, v66
    v_max3_u32 v74, v74, v67, v68
    v_max3_u32 v74, v74, v69, v70
    v_max3_u32 v74, v74, v71, v72
    v_cmp_eq_u32 vcc, -1, v74
    s_nop 0
    s_cmp_eq_u64 vcc, 0
    s_cbranch_scc1 L_sd29_n
    s_add_u32 s93, s93, 1
    s_cmp_lt_u32 s93, 30000
    s_cbranch_scc1 L_ar_n
L_sd29_n:
    s_nop 0
    v_and_b32 v101, s101, v64
    v_lshlrev_b32 v100, 16, v64
    v_and_b32 v103, s101, v65
    v_lshlrev_b32 v102, 16, v65
    v_and_b32 v105, s101, v66
    v_lshlrev_b32 v104, 16, v66
    v_and_b32 v107, s101, v67
    v_lshlrev_b32 v106, 16, v67
    v_and_b32 v109, s101, v68
    v_lshlrev_b32 v108, 16, v68
    v_and_b32 v111, s101, v69
    v_lshlrev_b32 v110, 16, v69
    v_and_b32 v113, s101, v70
    v_lshlrev_b32 v112, 16, v70
    v_and_b32 v115, s101, v71
    v_lshlrev_b32 v114, 16, v71
    v_and_b32 v117, s101, v72
    v_lshlrev_b32 v116, 16, v72
    v_pk_add_f32 v[80:81], v[80:81], v[100:101]
    v_pk_add_f32 v[82:83], v[82:83], v[102:103]
    v_pk_add_f32 v[84:85], v[84:85], v[104:105]
    v_pk_add_f32 v[86:87], v[86:87], v[106:107]
    v_pk_add_f32 v[88:89], v[88:89], v[108:109]
    v_pk_add_f32 v[90:91], v[90:91], v[110:111]
    v_pk_add_f32 v[92:93], v[92:93], v[112:113]
    v_pk_add_f32 v[94:95], v[94:95], v[114:115]
    v_pk_add_f32 v[96:97], v[96:97], v[116:117]
    v_cvt_pk_bf16_f32 v80, 0, v80
    v_cvt_pk_bf16_f32 v81, 0, v81
    v_cvt_pk_bf16_f32 v82, 0, v82
    v_cvt_pk_bf16_f32 v83, 0, v83
    v_cvt_pk_bf16_f32 v84, 0, v84
    v_cvt_pk_bf16_f32 v85, 0, v85
    v_cvt_pk_bf16_f32 v86, 0, v86
    v_cvt_pk_bf16_f32 v87, 0, v87
    v_cvt_pk_bf16_f32 v88, 0, v88
    v_cvt_pk_bf16_f32 v89, 0, v89
    v_cvt_pk_bf16_f32 v90, 0, v90
    v_cvt_pk_bf16_f32 v91, 0, v91
    v_cvt_pk_bf16_f32 v92, 0, v92
    v_cvt_pk_bf16_f32 v93, 0, v93
    v_cvt_pk_bf16_f32 v94, 0, v94
    v_cvt_pk_bf16_f32 v95, 0, v95
    v_cvt_pk_bf16_f32 v96, 0, v96
    v_cvt_pk_bf16_f32 v97, 0, v97
    v_pk_mul_f32 v[146:147], v[80:81], v[80:81]
    v_pk_add_f32 v[144:145], v[80:81], v[82:83]
    v_pk_fma_f32 v[146:147], v[82:83], v[82:83], v[146:147]
    v_pk_add_f32 v[144:145], v[144:145], v[84:85]
    v_pk_fma_f32 v[146:147], v[84:85], v[84:85], v[146:147]
    v_pk_add_f32 v[144:145], v[144:145], v[86:87]
    v_pk_fma_f32 v[146:147], v[86:87], v[86:87], v[146:147]
    v_pk_add_f32 v[144:145], v[144:145], v[88:89]
    v_pk_fma_f32 v[146:147], v[88:89], v[88:89], v[146:147]
    v_pk_add_f32 v[144:145], v[144:145], v[90:91]
    v_pk_fma_f32 v[146:147], v[90:91], v[90:91], v[146:147]
    v_pk_add_f32 v[144:145], v[144:145], v[92:93]
    v_pk_fma_f32 v[146:147], v[92:93], v[92:93], v[146:147]
    v_pk_add_f32 v[144:145], v[144:145], v[94:95]
    v_pk_fma_f32 v[146:147], v[94:95], v[94:95], v[146:147]
    v_pk_add_f32 v[144:145], v[144:145], v[96:97]
    v_pk_fma_f32 v[146:147], v[96:97], v[96:97], v[146:147]
    v_add_f32 v144, v144, v145
    v_add_f32 v146, v146, v147
    s_nop 0
    v_add_f32_dpp v144, v144, v144 quad_perm:[1,0,3,2] row_mask:0xf bank_mask:0xf
    v_add_f32_dpp v146, v146, v146 quad_perm:[1,0,3,2] row_mask:0xf bank_mask:0xf
    s_nop 0
    v_add_f32_dpp v144, v144, v144 quad_perm:[2,3,0,1] row_mask:0xf bank_mask:0xf
    v_add_f32_dpp v146, v146, v146 quad_perm:[2,3,0,1] row_mask:0xf bank_mask:0xf
    s_nop 0
    v_add_f32_dpp v144, v144, v144 row_half_mirror row_mask:0xf bank_mask:0xf
    v_add_f32_dpp v146, v146, v146 row_half_mirror row_mask:0xf bank_mask:0xf
    s_nop 0
    v_add_f32_dpp v144, v144, v144 row_mirror row_mask:0xf bank_mask:0xf
    v_add_f32_dpp v146, v146, v146 row_mirror row_mask:0xf bank_mask:0xf
    v_mov_b32 v145, v144
    v_mov_b32 v147, v146
    s_nop 0
    v_permlane16_swap_b32 v144, v145
    v_permlane16_swap_b32 v146, v147
    v_add_f32 v144, v144, v145
    v_add_f32 v146, v146, v147
    v_mul_f32 v144, 0x3ae38e39, v144
    v_mul_f32 v146, 0x3ae38e39, v146
    v_fma_f32 v146, -v144, v144, v146
    v_max_f32 v146, 0, v146
    v_cvt_pk_bf16_f32 v148, v144, v146
    v_and_b32 v146, s101, v148
    v_lshlrev_b32 v144, 16, v148
    v_add_f32 v146, 0x3727c5ac, v146
    v_cvt_pk_bf16_f32 v148, v146, v146
    v_lshlrev_b32 v146, 16, v148
    v_sqrt_f32 v146, v146
    s_nop 0
    v_cvt_pk_bf16_f32 v148, v146, v146
    v_lshlrev_b32 v146, 16, v148
    v_rcp_f32 v142, v146
    v_sub_f32 v140, 0, v144
    v_sub_f32 v141, 0, v144
    v_fma_f32 v148, -v146, v142, 2.0
    v_mul_f32 v142, v142, v148
    v_mov_b32 v143, v142
    v_pk_add_f32 v[100:101], v[80:81], v[140:141]
    v_pk_add_f32 v[102:103], v[82:83], v[140:141]
    v_pk_add_f32 v[104:105], v[84:85], v[140:141]
    v_pk_add_f32 v[106:107], v[86:87], v[140:141]
    v_pk_add_f32 v[108:109], v[88:89], v[140:141]
    v_pk_add_f32 v[110:111], v[90:91], v[140:141]
    v_pk_add_f32 v[112:113], v[92:93], v[140:141]
    v_pk_add_f32 v[114:115], v[94:95], v[140:141]
    v_pk_add_f32 v[116:117], v[96:97], v[140:141]
    v_cvt_pk_bf16_f32 v100, 0, v100
    v_cvt_pk_bf16_f32 v101, 0, v101
    v_cvt_pk_bf16_f32 v102, 0, v102
    v_cvt_pk_bf16_f32 v103, 0, v103
    v_cvt_pk_bf16_f32 v104, 0, v104
    v_cvt_pk_bf16_f32 v105, 0, v105
    v_cvt_pk_bf16_f32 v106, 0, v106
    v_cvt_pk_bf16_f32 v107, 0, v107
    v_cvt_pk_bf16_f32 v108, 0, v108
    v_cvt_pk_bf16_f32 v109, 0, v109
    v_cvt_pk_bf16_f32 v110, 0, v110
    v_cvt_pk_bf16_f32 v111, 0, v111
    v_cvt_pk_bf16_f32 v112, 0, v112
    v_cvt_pk_bf16_f32 v113, 0, v113
    v_cvt_pk_bf16_f32 v114, 0, v114
    v_cvt_pk_bf16_f32 v115, 0, v115
    v_cvt_pk_bf16_f32 v116, 0, v116
    v_cvt_pk_bf16_f32 v117, 0, v117
    v_pk_mul_f32 v[100:101], v[100:101], v[142:143]
    v_pk_mul_f32 v[102:103], v[102:103], v[142:143]
    v_pk_mul_f32 v[104:105], v[104:105], v[142:143]
    v_pk_mul_f32 v[106:107], v[106:107], v[142:143]
    v_pk_mul_f32 v[108:109], v[108:109], v[142:143]
    v_pk_mul_f32 v[110:111], v[110:111], v[142:143]
    v_pk_mul_f32 v[112:113], v[112:113], v[142:143]
    v_pk_mul_f32 v[114:115], v[114:115], v[142:143]
    v_pk_mul_f32 v[116:117], v[116:117], v[142:143]
    v_cvt_pk_bf16_f32 v100, 0, v100
    v_cvt_pk_bf16_f32 v101, 0, v101
    v_cvt_pk_bf16_f32 v102, 0, v102
    v_cvt_pk_bf16_f32 v103, 0, v103
    v_cvt_pk_bf16_f32 v104, 0, v104
    v_cvt_pk_bf16_f32 v105, 0, v105
    v_cvt_pk_bf16_f32 v106, 0, v106
    v_cvt_pk_bf16_f32 v107, 0, v107
    v_cvt_pk_bf16_f32 v108, 0, v108
    v_cvt_pk_bf16_f32 v109, 0, v109
    v_cvt_pk_bf16_f32 v110, 0, v110
    v_cvt_pk_bf16_f32 v111, 0, v111
    v_cvt_pk_bf16_f32 v112, 0, v112
    v_cvt_pk_bf16_f32 v113, 0, v113
    v_cvt_pk_bf16_f32 v114, 0, v114
    v_cvt_pk_bf16_f32 v115, 0, v115
    v_cvt_pk_bf16_f32 v116, 0, v116
    v_cvt_pk_bf16_f32 v117, 0, v117
    v_pk_mul_f32 v[100:101], v[100:101], v[120:121]
    v_pk_mul_f32 v[102:103], v[102:103], v[122:123]
    v_pk_mul_f32 v[104:105], v[104:105], v[124:125]
    v_pk_mul_f32 v[106:107], v[106:107], v[126:127]
    v_pk_mul_f32 v[108:109], v[108:109], v[128:129]
    v_pk_mul_f32 v[110:111], v[110:111], v[130:131]
    v_pk_mul_f32 v[112:113], v[112:113], v[132:133]
    v_pk_mul_f32 v[114:115], v[114:115], v[134:135]
    v_pk_mul_f32 v[116:117], v[116:117], v[136:137]
    v_cvt_pk_bf16_f32 v100, 0, v100
    v_cvt_pk_bf16_f32 v101, 0, v101
    v_cvt_pk_bf16_f32 v102, 0, v102
    v_cvt_pk_bf16_f32 v103, 0, v103
    v_cvt_pk_bf16_f32 v104, 0, v104
    v_cvt_pk_bf16_f32 v105, 0, v105
    v_cvt_pk_bf16_f32 v106, 0, v106
    v_cvt_pk_bf16_f32 v107, 0, v107
    v_cvt_pk_bf16_f32 v108, 0, v108
    v_cvt_pk_bf16_f32 v109, 0, v109
    v_cvt_pk_bf16_f32 v110, 0, v110
    v_cvt_pk_bf16_f32 v111, 0, v111
    v_cvt_pk_bf16_f32 v112, 0, v112
    v_cvt_pk_bf16_f32 v113, 0, v113
    v_cvt_pk_bf16_f32 v114, 0, v114
    v_cvt_pk_bf16_f32 v115, 0, v115
    v_cvt_pk_bf16_f32 v116, 0, v116
    v_cvt_pk_bf16_f32 v117, 0, v117
    v_pk_add_f32 v[80:81], v[80:81], v[100:101]
    v_pk_add_f32 v[82:83], v[82:83], v[102:103]
    v_pk_add_f32 v[84:85], v[84:85], v[104:105]
    v_pk_add_f32 v[86:87], v[86:87], v[106:107]
    v_pk_add_f32 v[88:89], v[88:89], v[108:109]
    v_pk_add_f32 v[90:91], v[90:91], v[110:111]
    v_pk_add_f32 v[92:93], v[92:93], v[112:113]
    v_pk_add_f32 v[94:95], v[94:95], v[114:115]
    v_pk_add_f32 v[96:97], v[96:97], v[116:117]
    v_cvt_pk_bf16_f32 v44, v80, v81
    v_cvt_pk_bf16_f32 v45, v82, v83
    v_cvt_pk_bf16_f32 v46, v84, v85
    v_cvt_pk_bf16_f32 v47, v86, v87
    v_cvt_pk_bf16_f32 v48, v88, v89
    v_cvt_pk_bf16_f32 v49, v90, v91
    v_cvt_pk_bf16_f32 v50, v92, v93
    v_cvt_pk_bf16_f32 v51, v94, v95
    v_cvt_pk_bf16_f32 v52, v96, v97
    s_cmp_lg_u32 s98, 0
    s_cbranch_scc1 L_final_n
    v_and_b32 v81, s101, v44
    v_lshlrev_b32 v80, 16, v44
    v_and_b32 v83, s101, v45
    v_lshlrev_b32 v82, 16, v45
    v_and_b32 v85, s101, v46
    v_lshlrev_b32 v84, 16, v46
    v_and_b32 v87, s101, v47
    v_lshlrev_b32 v86, 16, v47
    v_and_b32 v89, s101, v48
    v_lshlrev_b32 v88, 16, v48
    v_and_b32 v91, s101, v49
    v_lshlrev_b32 v90, 16, v49
    v_and_b32 v93, s101, v50
    v_lshlrev_b32 v92, 16, v50
    v_and_b32 v95, s101, v51
    v_lshlrev_b32 v94, 16, v51
    v_and_b32 v97, s101, v52
    v_lshlrev_b32 v96, 16, v52
    v_pk_mul_f32 v[146:147], v[80:81], v[80:81]
    v_pk_add_f32 v[144:145], v[80:81], v[82:83]
    v_pk_fma_f32 v[146:147], v[82:83], v[82:83], v[146:147]
    v_pk_add_f32 v[144:145], v[144:145], v[84:85]
    v_pk_fma_f32 v[146:147], v[84:85], v[84:85], v[146:147]
    v_pk_add_f32 v[144:145], v[144:145], v[86:87]
    v_pk_fma_f32 v[146:147], v[86:87], v[86:87], v[146:147]
    v_pk_add_f32 v[144:145], v[144:145], v[88:89]
    v_pk_fma_f32 v[146:147], v[88:89], v[88:89], v[146:147]
    v_pk_add_f32 v[144:145], v[144:145], v[90:91]
    v_pk_fma_f32 v[146:147], v[90:91], v[90:91], v[146:147]
    v_pk_add_f32 v[144:145], v[144:145], v[92:93]
    v_pk_fma_f32 v[146:147], v[92:93], v[92:93], v[146:147]
    v_pk_add_f32 v[144:145], v[144:145], v[94:95]
    v_pk_fma_f32 v[146:147], v[94:95], v[94:95], v[146:147]
    v_pk_add_f32 v[144:145], v[144:145], v[96:97]
    v_pk_fma_f32 v[146:147], v[96:97], v[96:97], v[146:147]
    v_add_f32 v144, v144, v145
    v_add_f32 v146, v146, v147
    s_nop 0
    v_add_f32_dpp v144, v144, v144 quad_perm:[1,0,3,2] row_mask:0xf bank_mask:0xf
    v_add_f32_dpp v146, v146, v146 quad_perm:[1,0,3,2] row_mask:0xf bank_mask:0xf
    s_nop 0
    v_add_f32_dpp v144, v144, v144 quad_perm:[2,3,0,1] row_mask:0xf bank_mask:0xf
    v_add_f32_dpp v146, v146, v146 quad_perm:[2,3,0,1] row_mask:0xf bank_mask:0xf
    s_nop 0
    v_add_f32_dpp v144, v144, v144 row_half_mirror row_mask:0xf bank_mask:0xf
    v_add_f32_dpp v146, v146, v146 row_half_mirror row_mask:0xf bank_mask:0xf
    s_nop 0
    v_add_f32_dpp v144, v144, v144 row_mirror row_mask:0xf bank_mask:0xf
    v_add_f32_dpp v146, v146, v146 row_mirror row_mask:0xf bank_mask:0xf
    v_mov_b32 v145, v144
    v_mov_b32 v147, v146
    s_nop 0
    v_permlane16_swap_b32 v144, v145
    v_permlane16_swap_b32 v146, v147
    v_add_f32 v144, v144, v145
    v_add_f32 v146, v146, v147
    v_mul_f32 v144, 0x3ae38e39, v144
    v_mul_f32 v146, 0x3ae38e39, v146
    v_fma_f32 v146, -v144, v144, v146
    v_max_f32 v146, 0, v146
    v_cvt_pk_bf16_f32 v148, v144, v146
    v_and_b32 v146, s101, v148
    v_lshlrev_b32 v144, 16, v148
    v_add_f32 v146, 0x3727c5ac, v146
    v_cvt_pk_bf16_f32 v148, v146, v146
    v_lshlrev_b32 v146, 16, v148
    v_sqrt_f32 v146, v146
    s_nop 0
    v_cvt_pk_bf16_f32 v148, v146, v146
    v_lshlrev_b32 v146, 16, v148
    v_rcp_f32 v142, v146
    v_sub_f32 v140, 0, v144
    v_sub_f32 v141, 0, v144
    v_fma_f32 v148, -v146, v142, 2.0
    v_mul_f32 v142, v142, v148
    v_mov_b32 v143, v142
    v_pk_add_f32 v[80:81], v[80:81], v[140:141]
    v_pk_add_f32 v[82:83], v[82:83], v[140:141]
    v_pk_add_f32 v[84:85], v[84:85], v[140:141]
    v_pk_add_f32 v[86:87], v[86:87], v[140:141]
    v_pk_add_f32 v[88:89], v[88:89], v[140:141]
    v_pk_add_f32 v[90:91], v[90:91], v[140:141]
    v_pk_add_f32 v[92:93], v[92:93], v[140:141]
    v_pk_add_f32 v[94:95], v[94:95], v[140:141]
    v_pk_add_f32 v[96:97], v[96:97], v[140:141]
    v_cvt_pk_bf16_f32 v80, 0, v80
    v_cvt_pk_bf16_f32 v81, 0, v81
    v_cvt_pk_bf16_f32 v82, 0, v82
    v_cvt_pk_bf16_f32 v83, 0, v83
    v_cvt_pk_bf16_f32 v84, 0, v84
    v_cvt_pk_bf16_f32 v85, 0, v85
    v_cvt_pk_bf16_f32 v86, 0, v86
    v_cvt_pk_bf16_f32 v87, 0, v87
    v_cvt_pk_bf16_f32 v88, 0, v88
    v_cvt_pk_bf16_f32 v89, 0, v89
    v_cvt_pk_bf16_f32 v90, 0, v90
    v_cvt_pk_bf16_f32 v91, 0, v91
    v_cvt_pk_bf16_f32 v92, 0, v92
    v_cvt_pk_bf16_f32 v93, 0, v93
    v_cvt_pk_bf16_f32 v94, 0, v94
    v_cvt_pk_bf16_f32 v95, 0, v95
    v_cvt_pk_bf16_f32 v96, 0, v96
    v_cvt_pk_bf16_f32 v97, 0, v97
    v_pk_mul_f32 v[80:81], v[80:81], v[142:143]
    v_pk_mul_f32 v[82:83], v[82:83], v[142:143]
    v_pk_mul_f32 v[84:85], v[84:85], v[142:143]
    v_pk_mul_f32 v[86:87], v[86:87], v[142:143]
    v_pk_mul_f32 v[88:89], v[88:89], v[142:143]
    v_pk_mul_f32 v[90:91], v[90:91], v[142:143]
    v_pk_mul_f32 v[92:93], v[92:93], v[142:143]
    v_pk_mul_f32 v[94:95], v[94:95], v[142:143]
    v_pk_mul_f32 v[96:97], v[96:97], v[142:143]
    v_cvt_pk_bf16_f32 v64, v80, v81
    v_cvt_pk_bf16_f32 v65, v82, v83
    v_cvt_pk_bf16_f32 v66, v84, v85
    v_cvt_pk_bf16_f32 v67, v86, v87
    v_cvt_pk_bf16_f32 v68, v88, v89
    v_cvt_pk_bf16_f32 v69, v90, v91
    v_cvt_pk_bf16_f32 v70, v92, v93
    v_cvt_pk_bf16_f32 v71, v94, v95
    v_cvt_pk_bf16_f32 v72, v96, v97
    s_mov_b32 s8, 35913728
    ds_write_b128 v21, v[64:67]
    ds_write_b128 v21, v[68:71] offset:512
    ds_write_b32 v22, v72
    s_waitcnt lgkmcnt(0)
    s_barrier
    ds_read_b128 v[200:203], v23
    ds_read_b128 v[204:207], v23 offset:512
    ds_read_b128 v[208:211], v23 offset:1024
    s_add_u32 s9, s8, 8192
    s_add_u32 s10, s8, 16384
    s_waitcnt lgkmcnt(2)
    buffer_store_dwordx4 v[200:203], v24, s[40:43], s8 offen sc1
    s_waitcnt lgkmcnt(1)
    buffer_store_dwordx4 v[204:207], v24, s[40:43], s9 offen sc1
    s_waitcnt lgkmcnt(0)
    buffer_store_dwordx4 v[208:211], v9, s[40:43], s10 offen sc1
    s_cmp_eq_u32 s70, 0
    s_cbranch_scc1 L_xh30_n
    s_add_u32 s9, s69, 8192
    s_add_u32 s10, s69, 16384
    buffer_store_dwordx4 v[200:203], v24, s[40:43], s69 offen sc1
    buffer_store_dwordx4 v[204:207], v24, s[40:43], s9 offen sc1
    buffer_store_dwordx4 v[208:211], v9, s[40:43], s10 offen sc1
L_xh30_n:
    s_mov_b32 s98, 1
    s_mov_b32 s48, 0x2240000
    s_mov_b32 s49, 0x2004800
    s_mov_b32 s60, 0x2241000
    s_mov_b32 s61, 0x2249000
    s_mov_b32 s62, 0x224a000
    v_add_u32 v248, s72, v5
    s_nop 3
    s_branch L_layer1_n
L_final_n:
    buffer_store_dwordx4 v[44:47], v16, s[44:47], 0 offen sc1
    buffer_store_dwordx4 v[48:51], v16, s[44:47], 0 offen offset:512 sc1
    buffer_store_dword v52, v17, s[44:47], 0 offen sc1
    s_or_b32 s8, s2, s3
    s_cmp_lg_u32 s8, 0
    s_cbranch_scc1 L_noep_n
    s_memrealtime s[8:9]
    s_mov_b32 s10, 0x158e000
    s_waitcnt lgkmcnt(0)
    v_mov_b32 v64, s8
    v_mov_b32 v65, s9
    s_mov_b64 exec, 1
    buffer_store_dwordx2 v[64:65], off, s[40:43], s10 sc1
    s_mov_b64 exec, -1
L_noep_n:
    s_waitcnt vmcnt(0)
    s_endpgm
L_xs4_n:
    s_mov_b32 s93, 0
L_xl4_n:
    buffer_load_dwordx4 v[172:175], v249, s[40:43], s48 offen offset:0 sc1
    buffer_load_dwordx4 v[176:179], v249, s[40:43], s61 offen offset:0 sc1
    s_waitcnt vmcnt(0)
    v_max_u32 v240, v172, v176
    v_cmp_eq_u32 vcc, -1, v240
    s_nop 0
    s_cmp_eq_u64 vcc, 0
    s_nop 2
    s_cbranch_scc1 L_xr4_n
    s_add_u32 s93, s93, 1
    s_cmp_lt_u32 s93, 30000
    s_cbranch_scc1 L_xl4_n
    s_branch L_xr4_n
L_xs5_n:
    s_mov_b32 s93, 0
L_xl5_n:
    buffer_load_dwordx4 v[180:183], v249, s[40:43], s48 offen offset:1024 sc1
    buffer_load_dwordx4 v[184:187], v249, s[40:43], s61 offen offset:1024 sc1
    s_waitcnt vmcnt(0)
    v_max_u32 v240, v180, v184
    v_cmp_eq_u32 vcc, -1, v240
    s_nop 0
    s_cmp_eq_u64 vcc, 0
    s_nop 2
    s_cbranch_scc1 L_xr5_n
    s_add_u32 s93, s93, 1
    s_cmp_lt_u32 s93, 30000
    s_cbranch_scc1 L_xl5_n
    s_branch L_xr5_n
L_xs6_n:
    s_mov_b32 s93, 0
L_xl6_n:
    buffer_load_dwordx4 v[188:191], v249, s[40:43], s48 offen offset:2048 sc1
    buffer_load_dwordx4 v[192:195], v249, s[40:43], s61 offen offset:2048 sc1
    s_waitcnt vmcnt(0)
    v_max_u32 v240, v188, v192
    v_cmp_eq_u32 vcc, -1, v240
    s_nop 0
    s_cmp_eq_u64 vcc, 0
    s_nop 2
    s_cbranch_scc1 L_xr6_n
    s_add_u32 s93, s93, 1
    s_cmp_lt_u32 s93, 30000
    s_cbranch_scc1 L_xl6_n
    s_branch L_xr6_n
L_xs7_n:
    s_mov_b32 s93, 0
L_xl7_n:
    buffer_load_dwordx4 v[196:199], v249, s[40:43], s48 offen offset:3072 sc1
    buffer_load_dwordx4 v[200:203], v249, s[40:43], s61 offen offset:3072 sc1
    s_waitcnt vmcnt(0)
    v_max_u32 v240, v196, v200
    v_cmp_eq_u32 vcc, -1, v240
    s_nop 0
    s_cmp_eq_u64 vcc, 0
    s_nop 2
    s_cbranch_scc1 L_xr7_n
    s_add_u32 s93, s93, 1
    s_cmp_lt_u32 s93, 30000
    s_cbranch_scc1 L_xl7_n
    s_branch L_xr7_n
L_xs8_n:
    s_mov_b32 s93, 0
L_xl8_n:
    buffer_load_dwordx4 v[204:207], v250, s[40:43], s48 offen offset:0 sc1
    buffer_load_dwordx4 v[208:211], v250, s[40:43], s61 offen offset:0 sc1
    s_waitcnt vmcnt(0)
    v_max_u32 v240, v204, v208
    v_cmp_eq_u32 vcc, -1, v240
    s_nop 0
    s_cmp_eq_u64 vcc, 0
    s_nop 2
    s_cbranch_scc1 L_xr8_n
    s_add_u32 s93, s93, 1
    s_cmp_lt_u32 s93, 30000
    s_cbranch_scc1 L_xl8_n
    s_branch L_xr8_n
L_xs9_n:
    s_mov_b32 s93, 0
L_xl9_n:
    buffer_load_dwordx4 v[212:215], v250, s[40:43], s48 offen offset:1024 sc1
    buffer_load_dwordx4 v[216:219], v250, s[40:43], s61 offen offset:1024 sc1
    s_waitcnt vmcnt(0)
    v_max_u32 v240, v212, v216
    v_cmp_eq_u32 vcc, -1, v240
    s_nop 0
    s_cmp_eq_u64 vcc, 0
    s_nop 2
    s_cbranch_scc1 L_xr9_n
    s_add_u32 s93, s93, 1
    s_cmp_lt_u32 s93, 30000
    s_cbranch_scc1 L_xl9_n
    s_branch L_xr9_n
L_xs10_n:
    s_mov_b32 s93, 0
L_xl10_n:
    buffer_load_dwordx4 v[140:143], v250, s[40:43], s48 offen offset:2048 sc1
    buffer_load_dwordx4 v[144:147], v250, s[40:43], s61 offen offset:2048 sc1
    buffer_load_dwordx4 v[220:223], v6, s[40:43], s77 offen sc1
    s_waitcnt vmcnt(0)
    v_max3_u32 v240, v140, v144, v220
    v_cmp_eq_u32 vcc, -1, v240
    s_nop 0
    s_cmp_eq_u64 vcc, 0
    s_nop 2
    s_cbranch_scc1 L_xr10_n
    s_add_u32 s93, s93, 1
    s_cmp_lt_u32 s93, 30000
    s_cbranch_scc1 L_xl10_n
    s_branch L_xr10_n
L_xs11_n:
    s_mov_b32 s93, 0
L_xl11_n:
    buffer_load_dwordx4 v[148:151], v250, s[40:43], s48 offen offset:3072 sc1
    buffer_load_dwordx4 v[152:155], v250, s[40:43], s61 offen offset:3072 sc1
    buffer_load_dwordx4 v[224:227], v6, s[40:43], s78 offen sc1
    s_waitcnt vmcnt(0)
    v_max3_u32 v240, v148, v152, v224
    v_cmp_eq_u32 vcc, -1, v240
    s_nop 0
    s_cmp_eq_u64 vcc, 0
    s_nop 2
    s_cbranch_scc1 L_xr11_n
    s_add_u32 s93, s93, 1
    s_cmp_lt_u32 s93, 30000
    s_cbranch_scc1 L_xl11_n
    s_branch L_xr11_n
L_xs12_n:
    s_mov_b32 s93, 0
L_xl12_n:
    buffer_load_dwordx4 v[156:159], v250, s[40:43], s60 offen offset:0 sc1
    buffer_load_dwordx4 v[160:163], v250, s[40:43], s62 offen offset:0 sc1
    buffer_load_dwordx4 v[228:231], v6, s[40:43], s79 offen sc1
    s_waitcnt vmcnt(0)
    v_max3_u32 v240, v156, v160, v228
    v_cmp_eq_u32 vcc, -1, v240
    s_nop 0
    s_cmp_eq_u64 vcc, 0
    s_nop 2
    s_cbranch_scc1 L_xr12_n
    s_add_u32 s93, s93, 1
    s_cmp_lt_u32 s93, 30000
    s_cbranch_scc1 L_xl12_n
    s_branch L_xr12_n
L_xs13_n:
    s_mov_b32 s93, 0
L_xl13_n:
    buffer_load_dwordx4 v[164:167], v251, s[40:43], s48 offen offset:0 sc1
    buffer_load_dwordx4 v[168:171], v251, s[40:43], s61 offen offset:0 sc1
    buffer_load_dwordx4 v[232:235], v6, s[40:43], s80 offen sc1
    s_waitcnt vmcnt(0)
    v_max3_u32 v240, v164, v168, v232
    v_cmp_eq_u32 vcc, -1, v240
    s_nop 0
    s_cmp_eq_u64 vcc, 0
    s_nop 2
    s_cbranch_scc1 L_xr13_n
    s_add_u32 s93, s93, 1
    s_cmp_lt_u32 s93, 30000
    s_cbranch_scc1 L_xl13_n
    s_branch L_xr13_n
L_xs14_n:
    s_mov_b32 s93, 0
L_xl14_n:
    buffer_load_dwordx4 v[172:175], v251, s[40:43], s48 offen offset:1024 sc1
    buffer_load_dwordx4 v[176:179], v251, s[40:43], s61 offen offset:1024 sc1
    buffer_load_dwordx4 v[236:239], v10, s[40:43], s81 offen sc1
    s_waitcnt vmcnt(0)
    v_max3_u32 v240, v172, v176, v236
    v_cmp_eq_u32 vcc, -1, v240
    s_nop 0
    s_cmp_eq_u64 vcc, 0
    s_nop 2
    s_cbranch_scc1 L_xr14_n
    s_add_u32 s93, s93, 1
    s_cmp_lt_u32 s93, 30000
    s_cbranch_scc1 L_xl14_n
    s_branch L_xr14_n
L_xs15_n:
    s_mov_b32 s93, 0
L_xl15_n:
    buffer_load_dwordx4 v[180:183], v251, s[40:43], s48 offen offset:2048 sc1
    buffer_load_dwordx4 v[184:187], v251, s[40:43], s61 offen offset:2048 sc1
    s_waitcnt vmcnt(0)
    v_max_u32 v240, v180, v184
    v_cmp_eq_u32 vcc, -1, v240
    s_nop 0
    s_cmp_eq_u64 vcc, 0
    s_nop 2
    s_cbranch_scc1 L_xr15_n
    s_add_u32 s93, s93, 1
    s_cmp_lt_u32 s93, 30000
    s_cbranch_scc1 L_xl15_n
    s_branch L_xr15_n
L_xs16_n:
    s_mov_b32 s93, 0
L_xl16_n:
    buffer_load_dwordx4 v[188:191], v251, s[40:43], s48 offen offset:3072 sc1
    buffer_load_dwordx4 v[192:195], v251, s[40:43], s61 offen offset:3072 sc1
    s_waitcnt vmcnt(0)
    v_max_u32 v240, v188, v192
    v_cmp_eq_u32 vcc, -1, v240
    s_nop 0
    s_cmp_eq_u64 vcc, 0
    s_nop 2
    s_cbranch_scc1 L_xr16_n
    s_add_u32 s93, s93, 1
    s_cmp_lt_u32 s93, 30000
    s_cbranch_scc1 L_xl16_n
    s_branch L_xr16_n
L_xs17_n:
    s_mov_b32 s93, 0
L_xl17_n:
    buffer_load_dwordx4 v[196:199], v251, s[40:43], s60 offen offset:0 sc1
    buffer_load_dwordx4 v[200:203], v251, s[40:43], s62 offen offset:0 sc1
    s_waitcnt vmcnt(0)
    v_max_u32 v240, v196, v200
    v_cmp_eq_u32 vcc, -1, v240
    s_nop 0
    s_cmp_eq_u64 vcc, 0
    s_nop 2
    s_cbranch_scc1 L_xr17_n
    s_add_u32 s93, s93, 1
    s_cmp_lt_u32 s93, 30000
    s_cbranch_scc1 L_xl17_n
    s_branch L_xr17_n
.section .rodata,"a"
.p2align 6
.amdhsa_kernel interleave_layers__sliding_local_dilated__ssm_conv_h3__prompt_kernel
  .amdhsa_next_free_vgpr 512
  .amdhsa_next_free_sgpr 102
  .amdhsa_accum_offset 256
  .amdhsa_group_segment_fixed_size 0
  .amdhsa_kernarg_size 96
  .amdhsa_user_sgpr_count 2
  .amdhsa_user_sgpr_kernarg_segment_ptr 1
  .amdhsa_system_sgpr_workgroup_id_x 1
.end_amdhsa_kernel
```
